```python
import torch

def _softmax(x, axis=-1):
    return torch.softmax(x, dim=axis)
def _gelu(x):
    return torch.nn.functional.gelu(x, approximate="tanh")
def _silu(x):
    return torch.nn.functional.silu(x)
def _sigmoid(x):
    return torch.sigmoid(x)
def _layernorm(x, axis=-1, eps=1e-5):
    m = x.mean(dim=axis, keepdim=True)
    v = x.var(dim=axis, keepdim=True, unbiased=False)
    return (x - m) / torch.sqrt(v + eps)
def _scatter_add(tgt, idx, src, axis=0):
    return tgt.clone().index_add_(axis, idx, src)
def _segment_sum(src, seg, n):
    out = torch.zeros((n,) + src.shape[1:], dtype=src.dtype)
    return out.index_add_(0, seg, src)
def _pad(x, pw):
    flat = tuple(v for pair in reversed(pw) for v in pair)
    return torch.nn.functional.pad(x, flat)

kernel_name = 'interleave_layers__grouped_kv_mqa__dense_activation_silu__prompt'

def setup_inputs():

    _w = (lambda a: (lambda t: t.to(torch.bfloat16) if t.is_floating_point() else t)(torch.as_tensor(a)))
    def _A_setup():
        B, S, D, H = 1, 2048, 512, 32
        Dh = D // H
        return {
            "x": _w((lambda *s: torch.randn(*s, dtype=torch.bfloat16) * 0.05)(B, S, D)),
            "wq": _w((lambda *s: torch.randn(*s, dtype=torch.bfloat16) * 0.05)(D, H * Dh)),
            "wk": _w((lambda *s: torch.randn(*s, dtype=torch.bfloat16) * 0.05)(D, Dh)),
            "wv": _w((lambda *s: torch.randn(*s, dtype=torch.bfloat16) * 0.05)(D, Dh)),
            "wo": _w((lambda *s: torch.randn(*s, dtype=torch.bfloat16) * 0.05)(H * Dh, D)),
        }
    _A_in = _A_setup()

    def _B_setup():
        B, S, D, F = 1, 2048, 512, 1376
        return {
            "x": _w((lambda *s: torch.randn(*s, dtype=torch.bfloat16) * 0.05)(B, S, D)),
            "w1": _w((lambda *s: torch.randn(*s, dtype=torch.bfloat16) * 1.6)(D, F) * (D ** -0.5)),
            "w2": _w((lambda *s: torch.randn(*s, dtype=torch.bfloat16) * 0.2)(F, D) * (F ** -0.5)),
        }
    _B_in = _B_setup()

    return {
        "A_x": _A_in["x"],
        "A_wq": _A_in["wq"],
        "A_wk": _A_in["wk"],
        "A_wv": _A_in["wv"],
        "A_wo": _A_in["wo"],
        "B_x": _B_in["x"],
        "B_w1": _B_in["w1"],
        "B_w2": _B_in["w2"],
    }

def reference(A_x, A_wq, A_wk, A_wv, A_wo, B_x, B_w1, B_w2):
    def _A_ref(x, wq, wk, wv, wo):
        B, S, D = x.shape
        H = 32
        Dh = D // H
        q = (lambda x, *d: x.permute(*d))((x @ wq).reshape(B, S, H, Dh), 0, 2, 1, 3)
        k = x @ wk
        v = x @ wv
        scores = torch.einsum("bhqd,bkd->bhqk", q, k) * (Dh ** -0.5)
        p = _softmax(scores, axis=-1)
        o = torch.einsum("bhqk,bkd->bhqd", p, v)
        return (lambda x, *d: x.permute(*d))(o, 0, 2, 1, 3).reshape(B, S, H * Dh) @ wo

    def _B_ref(x, w1, w2):
        h = torch.einsum("bsd,df->bsf", x, w1)
        h = _silu(h)
        out = torch.einsum("bsf,fd->bsd", h, w2)
        return out

    x = A_x
    x = x + _A_ref(_layernorm(x, axis=-1), A_wq, A_wk, A_wv, A_wo)
    x = x + _B_ref(_layernorm(x, axis=-1), B_w1, B_w2)
    x = x + _A_ref(_layernorm(x, axis=-1), A_wq, A_wk, A_wv, A_wo)
    x = x + _B_ref(_layernorm(x, axis=-1), B_w1, B_w2)
    return x
```

```asm
; @launch grid=(256,1,1) block=(256,1,1) lds=163840
.amdgcn_target "amdgcn-amd-amdhsa--gfx950"
.text
.globl interleave_layers__grouped_kv_mqa__dense_activation_silu__prompt_kernel
.p2align 8
.type interleave_layers__grouped_kv_mqa__dense_activation_silu__prompt_kernel,@function
interleave_layers__grouped_kv_mqa__dense_activation_silu__prompt_kernel:
    s_cmp_ge_u32 s2, 256
    s_cbranch_scc1 MAIN_END
    s_load_dwordx2 s[4:5], s[0:1], 80
    v_lshrrev_b32 v4, 6, v0
    s_and_b32 s24, s2, 7
    s_lshr_b32 s25, s2, 3
    v_readfirstlane_b32 s14, v4
    s_and_b32 s13, s25, 7
    s_lshr_b32 s25, s25, 3
    s_lshl_b32 s12, s24, 2
    s_add_u32 s12, s12, s25
    v_and_b32 v23, 63, v0
    v_lshlrev_b32 v1, 4, v23
    v_and_b32 v2, 15, v23
    v_lshrrev_b32 v3, 4, v23
    s_mov_b32 s6, 25165824
    s_mov_b32 s7, 0x20000
    s_getpc_b64 s[24:25]
CPF_HERE:
    s_load_dwordx2 s[80:81], s[0:1], 0
    s_load_dwordx4 s[44:47], s[0:1], 16
    s_load_dwordx2 s[84:85], s[0:1], 8
    s_load_dwordx2 s[48:49], s[0:1], 32
    s_load_dwordx4 s[52:55], s[0:1], 48
    s_load_dwordx2 s[88:89], s[0:1], 72
    s_memrealtime s[60:61]
    s_mov_b32 s26, CODE_END-CPF_HERE
    s_mov_b32 s27, 0x20000
    s_lshr_b32 s28, s2, 3
    s_lshl_b32 s28, s28, 2
    s_add_u32 s28, s28, s14
    s_lshl_b32 s28, s28, 9
    v_lshlrev_b32 v9, 3, v1
    s_mov_b64 exec, 15
    buffer_load_dword v159, v9, s[24:27], s28 offen
    s_mov_b64 exec, -1
    s_and_b32 s24, s12, 3
    s_lshl_b32 s24, s24, 1
    s_add_u32 s24, s24, s13
    s_lshl_b32 s24, s24, 1
    s_and_b32 s78, s24, 15
    s_lshl_b32 s79, s12, 16
    s_lshl_b32 s25, s14, 14
    s_add_u32 s79, s79, s25
    s_add_u32 s98, s25, 65536
    v_lshrrev_b32 v11, 3, v23
    v_lshlrev_b32 v10, 10, v11
    v_and_b32 v20, 7, v23
    v_xor_b32 v8, v20, v11
    v_lshl_add_u32 v8, v8, 4, v10
    v_add_u32 v8, s79, v8
    v_add_u32 v242, 7168, v8
    s_lshl_b32 s79, s78, 6
    s_mov_b32 s82, 2097152
    s_mov_b32 s83, 0x20000
    s_mov_b32 s94, 16384
    s_mov_b32 s95, 0x20000
    s_lshl_b32 s76, s14, 12
    v_bfe_u32 v11, v23, 1, 2
    v_and_b32 v9, 1, v3
    s_and_b32 s25, s14, 1
    s_lshl_b32 s25, s25, 1
    v_or_b32 v9, s25, v9
    v_xor_b32 v11, v11, v9
    v_lshl_add_u32 v9, v11, 5, v10
    v_and_b32 v11, 1, v23
    v_lshl_add_u32 v9, v11, 4, v9
    s_lshl_b32 s96, s14, 13
    s_lshl_b32 s25, s13, 7
    s_add_u32 s96, s96, s25
    v_add_u32 v9, s96, v9
    s_sub_u32 s96, s78, 1
    s_lshl_b32 s96, s96, 15
    s_lshl_b32 s97, s14, 10
    s_mov_b32 s86, 524288
    s_mov_b32 s87, 0x20000
    s_waitcnt lgkmcnt(0)
    s_lshl_b32 s60, s60, 4
    s_or_b32 s60, s60, 8
    s_mov_b32 s90, 256
    s_mov_b32 s91, 0x20000
    s_or_b32 s24, s2, s14
    s_cmp_lg_u32 s24, 0
    s_cbranch_scc1 P0_NOTAG
    v_mov_b32 v12, s60
    s_mov_b64 exec, 1
    buffer_store_dword v12, off, s[88:91], 0 sc1
    s_mov_b64 exec, -1
P0_NOTAG:
    s_add_u32 m0, s98, 0
    s_nop 0
    buffer_load_dwordx4 v8, s[80:83], s79 offen lds
    buffer_load_dwordx4 v242, s[80:83], s79 offen offset:1024 lds
    s_bitcmp1_b32 s13, 0
    s_cselect_b32 s92, s46, s44
    s_cselect_b32 s93, s47, s45
    s_lshl_b32 s24, s14, 2
    s_add_u32 s24, s24, s78
    s_add_u32 m0, s76, 131072
    s_and_b32 s25, s24, 15
    s_lshl_b32 s25, s25, 10
    buffer_load_dwordx4 v1, s[92:95], s25 offen lds
    s_add_u32 s24, s24, 1
    s_add_u32 m0, m0, 1024
    s_and_b32 s25, s24, 15
    s_lshl_b32 s25, s25, 10
    buffer_load_dwordx4 v1, s[92:95], s25 offen lds
    s_add_u32 s24, s24, 1
    s_add_u32 m0, m0, 1024
    s_and_b32 s25, s24, 15
    s_lshl_b32 s25, s25, 10
    buffer_load_dwordx4 v1, s[92:95], s25 offen lds
    s_add_u32 s24, s24, 1
    s_add_u32 m0, m0, 1024
    s_and_b32 s25, s24, 15
    s_lshl_b32 s25, s25, 10
    buffer_load_dwordx4 v1, s[92:95], s25 offen lds
    s_add_u32 m0, s98, 2048
    s_add_u32 s79, s79, 128
    s_and_b32 s79, s79, 1023
    buffer_load_dwordx4 v8, s[80:83], s79 offen lds
    buffer_load_dwordx4 v242, s[80:83], s79 offen offset:1024 lds
    s_add_u32 m0, s98, 4096
    s_add_u32 s79, s79, 128
    s_and_b32 s79, s79, 1023
    buffer_load_dwordx4 v8, s[80:83], s79 offen lds
    buffer_load_dwordx4 v242, s[80:83], s79 offen offset:1024 lds
    s_mov_b32 s86, 524288
    s_mov_b32 s87, 0x20000
    s_lshl_b32 s27, s14, 15
    s_lshl_b32 s26, s12, 10
    s_add_u32 s27, s27, s26
    s_add_u32 s27, s27, 4325376
    s_and_b32 s26, s2, 7
    s_lshl_b32 s26, s26, 7
    s_add_u32 s26, s26, 4390912
    s_cmp_ge_u32 s14, 2
    s_cselect_b32 s27, s26, s27
    s_cselect_b32 s26, 6, 3
    v_lshlrev_b32 v241, s26, v1
    s_mov_b64 exec, 0xff
    s_cselect_b32 exec_lo, 15, exec_lo
    buffer_load_dword v241, v241, s[4:7], s27 offen sc1
    s_mov_b64 exec, -1
    s_lshl_b32 s56, s2, 2
    s_add_u32 s56, s56, s14
    s_mov_b32 s58, 3
    s_mov_b32 s57, 1024
    s_mov_b32 s100, 1024
    s_mov_b32 s101, 0
    s_mov_b32 s59, 0x100408
    s_mov_b32 s11, 0x20000
    s_cmp_ge_u32 s56, 352
    s_cbranch_scc1 P0_J1
    s_mov_b32 s8, s54
    s_mov_b32 s9, s55
    s_mov_b32 s10, 1409024
    s_mul_i32 s24, s56, 5958
    s_lshr_b32 s24, s24, 16
    s_mul_i32 s25, s24, 11
    s_sub_u32 s25, s56, s25
    s_lshr_b32 s28, s24, 2
    s_and_b32 s27, s24, 3
    s_lshl_b32 s95, s56, 12
    s_add_u32 s95, s95, 2621440
    s_mul_i32 s27, s27, 22
    s_lshr_b32 s26, s25, 2
    s_mul_i32 s26, s26, 11
    s_and_b32 s24, s25, 3
    s_mul_i32 s24, s24, 3
    s_add_u32 s92, s26, s24
    s_add_u32 s93, s92, 1
    s_cmp_eq_u32 s25, 8
    s_cselect_b32 s92, 2, s92
    s_cselect_b32 s93, 5, s93
    s_cmp_eq_u32 s25, 9
    s_cselect_b32 s92, 8, s92
    s_cselect_b32 s93, 13, s93
    s_cmp_eq_u32 s25, 10
    s_cselect_b32 s92, 16, s92
    s_cselect_b32 s93, 19, s93
    s_add_u32 s92, s92, s27
    s_add_u32 s93, s93, s27
    s_cmp_ge_u32 s25, 8
    s_cselect_b32 s59, 0x040810, s59
    s_branch P0_JGO
P0_J1:
    s_cmp_ge_u32 s56, 704
    s_cbranch_scc1 P0_J2
    s_mov_b32 s8, s52
    s_mov_b32 s9, s53
    s_mov_b32 s10, 1409024
    s_mov_b32 s57, 2752
    s_sub_u32 s24, s56, 352
    s_lshr_b32 s28, s24, 4
    s_and_b32 s26, s24, 15
    s_lshl_b32 s95, s28, 16
    s_lshl_b32 s25, s26, 10
    s_add_u32 s95, s95, s25
    s_add_u32 s95, s95, 1179648
    s_mov_b32 s100, 16384
    s_lshl_b32 s92, s26, 1
    s_add_u32 s93, s92, 1
    s_branch P0_JGO
P0_J2:
    s_cmp_ge_u32 s56, 960
    s_cbranch_scc1 P0_J3
    s_sub_u32 s24, s56, 704
    s_and_b32 s27, s24, 127
    s_lshr_b32 s28, s27, 4
    s_lshl_b32 s26, s28, 1
    s_add_u32 s26, s26, s27
    s_and_b32 s26, s26, 15
    s_lshl_b32 s92, s26, 1
    s_add_u32 s93, s92, 1
    s_mov_b32 s10, 524288
    s_lshl_b32 s95, s27, 12
    s_add_u32 s95, s95, 655360
    s_mul_i32 s25, s27, 5120
    s_add_u32 s25, s25, 0
    s_cmp_ge_u32 s24, 128
    s_cselect_b32 s8, s84, s48
    s_cselect_b32 s9, s85, s49
    s_cselect_b32 s95, s25, s95
    s_cselect_b32 s59, s59, 0x080410
    s_branch P0_JGO
P0_J3:
    s_sub_u32 s24, s2, 240
    s_bitcmp1_b32 s24, 0
    s_cselect_b32 s8, s46, s44
    s_cselect_b32 s9, s47, s45
    s_mul_i32 s95, s24, 81920
    s_add_u32 s95, s95, 4096
    s_cmp_lt_u32 s24, 8
    s_cselect_b32 s10, 16384, 0
    s_cselect_b32 s95, s95, 25165824
    s_mov_b32 s58, 1
    s_mov_b32 s57, 32
    s_mov_b32 s100, 5120
    s_lshl_b32 s24, s24, 1
    s_lshl_b32 s101, s14, 2
    s_sub_u32 s101, s101, s24
    s_lshl_b32 s92, s14, 3
    s_add_u32 s93, s92, 4
    s_mov_b32 s28, 0
P0_JGO:
    s_lshl_b32 s24, s57, 4
    s_lshl_b32 s28, s28, 7
    s_mul_i32 s92, s92, s24
    s_add_u32 s92, s92, s28
    s_mul_i32 s93, s93, s24
    s_add_u32 s93, s93, s28
    s_sub_u32 s24, 6, s58
    s_lshl_b32 s94, s57, s24
    v_lshrrev_b32 v10, s58, v23
    v_mul_lo_u32 v10, v10, s57
    s_lshl_b32 s24, 1, s58
    s_sub_u32 s24, s24, 1
    v_and_b32 v11, s24, v23
    v_lshl_add_u32 v10, v11, 4, v10
    s_and_b32 s24, s59, 0xff
    s_bfe_u32 s25, s59, 0x80008
    s_lshr_b32 s59, s59, 16
    v_lshrrev_b32 v12, 1, v3
    v_mul_lo_u32 v12, v12, s24
    v_and_b32 v13, 1, v3
    v_mul_lo_u32 v13, v13, s25
    v_add_u32 v12, v12, v13
    v_lshrrev_b32 v13, 2, v2
    v_add_u32 v12, v12, v13
    s_add_u32 s24, s58, 4
    v_lshlrev_b32 v12, s24, v12
    v_and_b32 v13, 3, v23
    v_lshl_add_u32 v12, v13, 3, v12
    s_add_u32 s25, s76, 147456
    v_add_u32 v233, s25, v12
    s_lshl_b32 s59, s59, s24
    v_add_u32 v234, s59, v233
    s_cmp_eq_u32 s58, 1
    s_cselect_b32 s24, 1024, 32
    v_add_u32 v235, s24, v233
    v_add_u32 v236, s24, v234
    v_add_u32 v237, s24, v235
    v_add_u32 v238, s24, v236
    v_add_u32 v239, s24, v237
    v_add_u32 v240, s24, v238
    v_mov_b32 v28, 0x3f803f80
    v_mov_b32 v29, 0x3f803f80
    v_mov_b32 v30, 0x3f803f80
    v_mov_b32 v31, 0x3f803f80
    v_lshlrev_b32 v22, 8, v3
    v_lshl_add_u32 v22, v2, 3, v22
    v_add_u32 v22, 131072, v22
    v_lshlrev_b32 v21, 7, v2
    v_add_u32 v21, s98, v21
    v_xor_b32 v24, v3, v20
    v_xor_b32 v25, 4, v24
    v_lshl_add_u32 v24, v24, 4, v21
    v_lshl_add_u32 v25, v25, 4, v21
    s_lshr_b32 s24, s78, 1
    s_sub_u32 s24, s13, s24
    s_and_b32 s24, s24, 7
    s_lshl_b32 s24, s24, 11
    v_add_u32 v21, s24, v21
    v_and_b32 v18, 1, v3
    v_lshl_add_u32 v21, v18, 3, v21
    v_lshrrev_b32 v18, 1, v3
    v_xor_b32 v18, v18, v20
    v_xor_b32 v19, 0, v18
    v_lshl_add_u32 v14, v19, 4, v21
    v_xor_b32 v19, 2, v18
    v_lshl_add_u32 v15, v19, 4, v21
    v_xor_b32 v19, 4, v18
    v_lshl_add_u32 v16, v19, 4, v21
    v_xor_b32 v19, 6, v18
    v_lshl_add_u32 v17, v19, 4, v21
    v_lshrrev_b32 v12, 2, v2
    v_lshl_add_u32 v12, v3, 3, v12
    v_lshlrev_b32 v12, 7, v12
    v_and_b32 v13, 3, v23
    v_lshl_add_u32 v12, v13, 3, v12
    v_bfe_u32 v13, v23, 3, 1
    v_and_b32 v18, 1, v3
    v_lshl_add_u32 v13, v18, 1, v13
    v_xor_b32 v18, s14, v13
    v_lshl_add_u32 v228, v18, 5, v12
    s_add_u32 s24, s14, 1
    s_and_b32 s24, s24, 3
    s_sub_u32 s24, s24, s14
    s_lshl_b32 s24, s24, 14
    v_add_u32 v96, s24, v24
    v_add_u32 v97, s24, v25
    s_add_u32 s24, s14, 2
    s_and_b32 s24, s24, 3
    s_sub_u32 s24, s24, s14
    s_lshl_b32 s24, s24, 14
    v_add_u32 v98, s24, v24
    v_add_u32 v99, s24, v25
    s_add_u32 s24, s14, 3
    s_and_b32 s24, s24, 3
    s_sub_u32 s24, s24, s14
    s_lshl_b32 s24, s24, 14
    v_add_u32 v100, s24, v24
    v_add_u32 v101, s24, v25
    v_lshrrev_b32 v19, 1, v3
    v_and_b32 v21, 1, v3
    v_lshlrev_b32 v12, 9, v19
    v_lshl_add_u32 v12, v2, 4, v12
    v_lshl_add_u32 v12, v21, 3, v12
    v_lshlrev_b32 v13, 8, v21
    v_lshl_add_u32 v13, v2, 4, v13
    v_lshl_add_u32 v13, v19, 3, v13
    v_lshlrev_b32 v18, 4, v3
    s_mov_b32 s3, 0
    s_mul_i32 s15, s3, 0
    s_mul_i32 s24, s12, 524288
    s_add_u32 s15, s15, s24
    s_add_u32 s15, s15, 8388608
    s_add_u32 s16, s15, 0
    s_mul_i32 s17, s3, 131072
    s_add_u32 s17, s17, 4063232
    s_add_u32 s18, s17, 131072
    s_lshl_b32 s26, s14, 14
    s_lshl_b32 s27, s13, 11
    s_add_u32 s44, s27, s26
    s_add_u32 s27, s27, 2048
    s_and_b32 s27, s27, 0x3fff
    s_add_u32 s45, s27, s26
    s_add_u32 s27, s27, 2048
    s_and_b32 s27, s27, 0x3fff
    s_add_u32 s46, s27, s26
    s_add_u32 s27, s27, 2048
    s_and_b32 s27, s27, 0x3fff
    s_add_u32 s47, s27, s26
    s_add_u32 s27, s27, 2048
    s_and_b32 s27, s27, 0x3fff
    s_add_u32 s48, s27, s26
    s_add_u32 s27, s27, 2048
    s_and_b32 s27, s27, 0x3fff
    s_add_u32 s49, s27, s26
    s_add_u32 s27, s27, 2048
    s_and_b32 s27, s27, 0x3fff
    s_add_u32 s50, s27, s26
    s_add_u32 s27, s27, 2048
    s_and_b32 s27, s27, 0x3fff
    s_add_u32 s51, s27, s26
    s_lshl_b32 s76, s14, 12
    s_lshl_b32 s24, s13, 16
    s_lshl_b32 s25, s14, 14
    s_add_u32 s24, s24, s25
    s_add_u32 s72, s24, 655360
    s_mul_i32 s25, s13, 180224
    s_mul_i32 s26, s14, 49152
    s_add_u32 s25, s25, s26
    s_add_u32 s73, s25, 1183744
    s_mul_i32 s26, s13, 81920
    s_add_u32 s26, s26, s76
    s_add_u32 s74, s26, 0
    s_add_u32 s65, s74, 65536
    s_mul_i32 s28, s13, 180224
    s_mul_i32 s29, s14, 45056
    s_add_u32 s28, s28, s29
    s_add_u32 s75, s28, 2624512
    s_add_u32 s64, s75, 37888
    s_mov_b32 s40, 0x21800000
    s_mov_b32 s41, 0x5d800000
    s_mov_b32 s42, 0x7b800000
    s_mov_b32 s20, 0xffff
    s_mov_b32 s21, 0xffff
    s_lshl_b32 s24, s3, 15
    s_lshl_b32 s29, s12, 10
    s_add_u32 s24, s24, s29
    s_add_u32 s22, s24, 4325376
    s_lshl_b32 s29, s13, 2
    s_add_u32 s19, s22, s29
    s_lshl_b32 s24, s14, 7
    s_add_u32 s24, s24, s16
    s_add_u32 s67, s24, 442368
    s_lshl_b32 s24, s14, 14
    s_lshl_b32 s25, s13, 11
    s_add_u32 s24, s24, s25
    s_add_u32 s24, s24, s15
    s_add_u32 s52, s24, 0
    s_lshl_b32 s25, s13, 9
    s_lshl_b32 s26, s14, 7
    s_add_u32 s25, s25, s26
    s_add_u32 s25, s25, s15
    s_add_u32 s53, s25, 442368
    s_lshl_b32 s24, s13, 4
    s_lshl_b32 s25, s14, 2
    s_add_u32 s24, s24, s25
    s_add_u32 s54, s24, s22
    s_lshl_b32 s24, s13, 1
    s_and_b32 s25, s14, 1
    s_add_u32 s24, s24, s25
    s_lshl_b32 s24, s24, 10
    s_lshr_b32 s25, s14, 1
    s_lshl_b32 s25, s25, 9
    s_add_u32 s24, s24, s25
    s_add_u32 s24, s24, s15
    s_add_u32 s36, s24, 131072
    s_add_u32 s37, s36, 32768
    s_lshr_b32 s24, s13, 1
    s_mul_i32 s24, s24, 11
    s_and_b32 s25, s13, 1
    s_lshl_b32 s26, s25, 2
    s_add_u32 s26, s26, s14
    s_add_u32 s26, s26, s24
    s_lshl_b32 s26, s26, 10
    s_add_u32 s27, s15, 262144
    s_add_u32 s56, s26, s27
    s_mul_i32 s25, s25, 3
    s_add_u32 s25, s25, s14
    s_lshl_b32 s25, s25, 9
    s_add_u32 s24, s24, 8
    s_lshl_b32 s24, s24, 10
    s_add_u32 s24, s24, s25
    s_add_u32 s24, s24, s27
    s_cmp_eq_u32 s14, 3
    s_cselect_b32 s57, 25165824, s24
    s_mul_i32 s24, s14, 11264
    s_add_u32 s58, s24, s27
    s_lshl_b32 s25, s14, 12
    s_add_u32 s26, s25, s15
    s_add_u32 s59, s26, 0
    s_lshl_b32 s25, s14, 10
    s_add_u32 s26, s25, s15
    s_add_u32 s66, s26, 442368
    s_and_b32 s24, s2, 7
    s_lshl_b32 s24, s24, 7
    s_lshl_b32 s25, s3, 11
    s_add_u32 s24, s24, s25
    s_add_u32 s39, s24, 4390912
    s_add_u32 s69, s39, 1024
    s_lshr_b32 s25, s2, 3
    s_lshl_b32 s25, s25, 2
    s_add_u32 s68, s39, s25
    s_lshl_b32 s24, s12, 1
    s_lshr_b32 s25, s14, 1
    s_add_u32 s24, s24, s25
    s_lshl_b32 s24, s24, 11
    s_add_u32 s24, s24, s17
    s_and_b32 s25, s14, 1
    s_lshl_b32 s26, s25, 8
    s_lshl_b32 s27, s25, 9
    s_add_u32 s27, s27, 1024
    s_bitcmp1_b32 s13, 0
    s_cselect_b32 s26, s27, s26
    s_add_u32 s24, s24, s26
    s_lshr_b32 s25, s13, 1
    s_cmp_eq_u32 s25, s14
    s_cselect_b32 s62, s24, 25165824
    s_lshr_b32 s24, s14, 1
    s_lshl_b32 s24, s24, 10
    s_and_b32 s25, s14, 1
    s_lshl_b32 s25, s25, 8
    s_add_u32 s24, s24, s25
    s_add_u32 s60, s24, 155648
    s_load_dword s43, s[88:89], 0
    s_lshr_b32 s26, s14, 1
    s_lshl_b32 s25, s26, 11
    s_add_u32 s31, s25, s17
    s_and_b32 s30, s2, 7
    s_lshl_b32 s30, s30, 14
    s_and_b32 s25, s13, 3
    s_lshl_b32 s25, s25, 2
    s_add_u32 s25, s25, s14
    s_lshl_b32 s25, s25, 13
    s_add_u32 s99, s25, s17
    s_add_u32 s31, s31, s4
    s_addc_u32 s38, s5, 0
    v_bfe_u32 v26, v1, 2, 7
    v_lshrrev_b32 v4, 1, v3
    v_lshlrev_b32 v4, 8, v4
    v_lshl_add_u32 v7, v2, 4, v4
    v_and_b32 v4, 432, v1
    v_cmp_eq_u32 vcc, 256, v4
    v_mov_b32 v4, 0x3f803f80
    s_nop 0
    v_cndmask_b32 v4, 0, v4, vcc
    v_mov_b32 v132, v4
    v_mov_b32 v133, v4
    v_mov_b32 v134, v4
    v_mov_b32 v135, v4
    v_mov_b32 v136, v4
    v_mov_b32 v137, v4
    v_mov_b32 v138, v4
    v_mov_b32 v139, v4
    v_mov_b32 v144, v4
    v_mov_b32 v145, v4
    v_mov_b32 v146, v4
    v_mov_b32 v147, v4
    v_mov_b32 v148, v4
    v_mov_b32 v149, v4
    v_mov_b32 v150, v4
    v_mov_b32 v151, v4
    s_add_u32 s32, s30, s31
    s_addc_u32 s33, s38, 0
    s_mov_b32 s23, 1
    s_add_u32 s77, s19, 33536
    v_lshrrev_b32 v156, 1, v23
    v_lshlrev_b32 v156, 10, v156
    v_and_b32 v19, 1, v23
    v_lshl_add_u32 v156, v19, 4, v156
    v_add_u32 v156, 4358912, v156
    v_bfe_u32 v158, v23, 3, 2
    v_lshlrev_b32 v158, 7, v158
    v_lshl_add_u32 v158, v20, 2, v158
    v_lshlrev_b32 v231, 3, v2
    v_add_u32 v231, 131072, v231
    s_lshl_b32 s24, s14, 7
    v_add_u32 v232, s24, v231
    s_lshl_b32 s24, s14, 11
    s_add_u32 s24, s24, 135168
    v_add_u32 v243, s24, v12
    v_and_b32 v19, 3, v2
    s_add_u32 s24, s14, 0
    s_and_b32 s25, s24, 1
    s_lshl_b32 s25, s25, 8
    s_and_b32 s24, s24, 2
    s_lshl_b32 s24, s24, 9
    s_add_u32 s24, s24, s25
    v_add_u32 v102, s24, v243
    s_add_u32 s24, s14, 1
    s_and_b32 s25, s24, 1
    s_lshl_b32 s25, s25, 8
    s_and_b32 s24, s24, 2
    s_lshl_b32 s24, s24, 9
    s_add_u32 s24, s24, s25
    v_add_u32 v103, s24, v243
    s_add_u32 s24, s14, 2
    s_and_b32 s25, s24, 1
    s_lshl_b32 s25, s25, 8
    s_and_b32 s24, s24, 2
    s_lshl_b32 s24, s24, 9
    s_add_u32 s24, s24, s25
    v_add_u32 v229, s24, v243
    s_add_u32 s24, s14, 3
    s_and_b32 s25, s24, 1
    s_lshl_b32 s25, s25, 8
    s_and_b32 s24, s24, 2
    s_lshl_b32 s24, s24, 9
    s_add_u32 s24, s24, s25
    v_add_u32 v230, s24, v243
    v_mov_b32 v243, v10
    s_waitcnt lgkmcnt(0)
    s_cmp_eq_u32 s43, 0
    s_cbranch_scc1 TAG_SLOW
TAG_OK:
    s_getreg_b32 s24, hwreg(HW_REG_XCC_ID, 0, 3)
    s_add_u32 s61, s43, s24
    s_lshl_b32 s24, s12, 7
    s_lshl_b32 s25, s13, 2
    s_add_u32 s24, s24, s25
    s_add_u32 s90, s24, 4395008
    v_mov_b32 v254, s61
    v_mov_b32 v157, s43
    s_add_u32 m0, s98, 6144
    s_add_u32 s79, s79, 128
    s_and_b32 s79, s79, 1023
    buffer_load_dwordx4 v8, s[80:83], s79 offen lds
    buffer_load_dwordx4 v242, s[80:83], s79 offen offset:1024 lds
    s_add_u32 m0, s98, 8192
    s_add_u32 s79, s79, 128
    s_and_b32 s79, s79, 1023
    buffer_load_dwordx4 v8, s[80:83], s79 offen lds
    buffer_load_dwordx4 v242, s[80:83], s79 offen offset:1024 lds
    s_add_u32 m0, s98, 10240
    s_add_u32 s79, s79, 128
    s_and_b32 s79, s79, 1023
    buffer_load_dwordx4 v8, s[80:83], s79 offen lds
    buffer_load_dwordx4 v242, s[80:83], s79 offen offset:1024 lds
    s_add_u32 m0, s98, 12288
    s_add_u32 s79, s79, 128
    s_and_b32 s79, s79, 1023
    buffer_load_dwordx4 v8, s[80:83], s79 offen lds
    buffer_load_dwordx4 v242, s[80:83], s79 offen offset:1024 lds
    s_add_u32 m0, s98, 14336
    s_add_u32 s79, s79, 128
    s_and_b32 s79, s79, 1023
    buffer_load_dwordx4 v8, s[80:83], s79 offen lds
    buffer_load_dwordx4 v242, s[80:83], s79 offen offset:1024 lds
    s_and_b32 s71, s12, 3
    s_lshl_b32 s71, s71, 2
    s_add_u32 s71, s71, s14
    s_lshl_b32 s71, s71, 8
    s_add_u32 s71, s71, s13
    s_lshl_b32 s71, s71, 7
    v_and_b32 v255, 31, v23
    v_lshlrev_b32 v255, 10, v255
    buffer_load_dword v255, v255, s[84:87], s71 offen
    s_waitcnt vmcnt(16)
    s_barrier
    s_bitcmp1_b32 s13, 0
    s_cbranch_scc1 P0_S1V
    ds_read_b128 v[32:35], v24 offset:0
    ds_read_b64_tr_b16 v[184:185], v22 offset:0
    ds_read_b64_tr_b16 v[186:187], v22 offset:128
    ds_read_b128 v[36:39], v25 offset:0
    ds_read_b64_tr_b16 v[188:189], v22 offset:1024
    ds_read_b64_tr_b16 v[190:191], v22 offset:1152
    s_waitcnt vmcnt(14)
    ds_read_b128 v[40:43], v24 offset:2048
    ds_read_b64_tr_b16 v[192:193], v22 offset:2048
    ds_read_b64_tr_b16 v[194:195], v22 offset:2176
    s_waitcnt lgkmcnt(6)
    v_mfma_f32_16x16x32_bf16 v[112:115], v[184:187], v[32:35], 0
    ds_read_b128 v[44:47], v25 offset:2048
    ds_read_b64_tr_b16 v[196:197], v22 offset:3072
    ds_read_b64_tr_b16 v[198:199], v22 offset:3200
    v_mfma_f32_16x16x32_bf16 v[116:119], v[184:187], v[28:31], 0
    v_mfma_f32_16x16x32_bf16 v[120:123], v[28:31], v[32:35], 0
    v_mfma_f32_16x16x32_bf16 v[124:127], v[32:35], v[32:35], 0
    s_waitcnt lgkmcnt(6)
    v_mfma_f32_16x16x32_bf16 v[112:115], v[188:191], v[36:39], v[112:115]
    s_waitcnt vmcnt(12)
    ds_read_b128 v[48:51], v24 offset:4096
    ds_read_b64_tr_b16 v[184:185], v22 offset:4096
    ds_read_b64_tr_b16 v[186:187], v22 offset:4224
    v_mfma_f32_16x16x32_bf16 v[116:119], v[188:191], v[28:31], v[116:119]
    v_mfma_f32_16x16x32_bf16 v[120:123], v[28:31], v[36:39], v[120:123]
    v_mfma_f32_16x16x32_bf16 v[124:127], v[36:39], v[36:39], v[124:127]
    s_waitcnt lgkmcnt(6)
    v_mfma_f32_16x16x32_bf16 v[112:115], v[192:195], v[40:43], v[112:115]
    ds_read_b128 v[52:55], v25 offset:4096
    ds_read_b64_tr_b16 v[188:189], v22 offset:5120
    ds_read_b64_tr_b16 v[190:191], v22 offset:5248
    v_mfma_f32_16x16x32_bf16 v[116:119], v[192:195], v[28:31], v[116:119]
    v_mfma_f32_16x16x32_bf16 v[120:123], v[28:31], v[40:43], v[120:123]
    v_mfma_f32_16x16x32_bf16 v[124:127], v[40:43], v[40:43], v[124:127]
    s_waitcnt lgkmcnt(6)
    v_mfma_f32_16x16x32_bf16 v[112:115], v[196:199], v[44:47], v[112:115]
    s_waitcnt vmcnt(9)
    ds_read_b128 v[56:59], v24 offset:6144
    ds_read_b64_tr_b16 v[192:193], v22 offset:6144
    ds_read_b64_tr_b16 v[194:195], v22 offset:6272
    v_mfma_f32_16x16x32_bf16 v[116:119], v[196:199], v[28:31], v[116:119]
    v_mfma_f32_16x16x32_bf16 v[120:123], v[28:31], v[44:47], v[120:123]
    v_mfma_f32_16x16x32_bf16 v[124:127], v[44:47], v[44:47], v[124:127]
    s_waitcnt lgkmcnt(6)
    v_mfma_f32_16x16x32_bf16 v[112:115], v[184:187], v[48:51], v[112:115]
    ds_read_b128 v[60:63], v25 offset:6144
    ds_read_b64_tr_b16 v[196:197], v22 offset:7168
    ds_read_b64_tr_b16 v[198:199], v22 offset:7296
    v_mfma_f32_16x16x32_bf16 v[116:119], v[184:187], v[28:31], v[116:119]
    v_mfma_f32_16x16x32_bf16 v[120:123], v[28:31], v[48:51], v[120:123]
    v_mfma_f32_16x16x32_bf16 v[124:127], v[48:51], v[48:51], v[124:127]
    s_waitcnt lgkmcnt(6)
    v_mfma_f32_16x16x32_bf16 v[112:115], v[188:191], v[52:55], v[112:115]
    s_waitcnt vmcnt(7)
    ds_read_b128 v[64:67], v24 offset:8192
    ds_read_b64_tr_b16 v[184:185], v22 offset:8192
    ds_read_b64_tr_b16 v[186:187], v22 offset:8320
    v_mfma_f32_16x16x32_bf16 v[116:119], v[188:191], v[28:31], v[116:119]
    v_mfma_f32_16x16x32_bf16 v[120:123], v[28:31], v[52:55], v[120:123]
    v_mfma_f32_16x16x32_bf16 v[124:127], v[52:55], v[52:55], v[124:127]
    s_waitcnt lgkmcnt(6)
    v_mfma_f32_16x16x32_bf16 v[112:115], v[192:195], v[56:59], v[112:115]
    ds_read_b128 v[68:71], v25 offset:8192
    ds_read_b64_tr_b16 v[188:189], v22 offset:9216
    ds_read_b64_tr_b16 v[190:191], v22 offset:9344
    v_mfma_f32_16x16x32_bf16 v[116:119], v[192:195], v[28:31], v[116:119]
    v_mfma_f32_16x16x32_bf16 v[120:123], v[28:31], v[56:59], v[120:123]
    v_mfma_f32_16x16x32_bf16 v[124:127], v[56:59], v[56:59], v[124:127]
    s_waitcnt lgkmcnt(6)
    v_mfma_f32_16x16x32_bf16 v[112:115], v[196:199], v[60:63], v[112:115]
    s_waitcnt vmcnt(5)
    ds_read_b128 v[72:75], v24 offset:10240
    ds_read_b64_tr_b16 v[192:193], v22 offset:10240
    ds_read_b64_tr_b16 v[194:195], v22 offset:10368
    v_mfma_f32_16x16x32_bf16 v[116:119], v[196:199], v[28:31], v[116:119]
    v_mfma_f32_16x16x32_bf16 v[120:123], v[28:31], v[60:63], v[120:123]
    v_mfma_f32_16x16x32_bf16 v[124:127], v[60:63], v[60:63], v[124:127]
    s_waitcnt lgkmcnt(6)
    v_mfma_f32_16x16x32_bf16 v[112:115], v[184:187], v[64:67], v[112:115]
    s_add_u32 m0, s97, 0
    ds_read_b128 v[76:79], v25 offset:10240
    ds_read_b64_tr_b16 v[196:197], v22 offset:11264
    ds_read_b64_tr_b16 v[198:199], v22 offset:11392
    v_mfma_f32_16x16x32_bf16 v[116:119], v[184:187], v[28:31], v[116:119]
    s_add_u32 s96, s96, 32768
    s_and_b32 s96, s96, 0x7ffff
    v_mfma_f32_16x16x32_bf16 v[120:123], v[28:31], v[64:67], v[120:123]
    buffer_load_dwordx4 v9, s[84:87], s96 offen lds
    v_mfma_f32_16x16x32_bf16 v[124:127], v[64:67], v[64:67], v[124:127]
    s_waitcnt lgkmcnt(6)
    v_mfma_f32_16x16x32_bf16 v[112:115], v[188:191], v[68:71], v[112:115]
    s_add_u32 m0, s97, 4096
    s_waitcnt vmcnt(4)
    ds_read_b128 v[80:83], v24 offset:12288
    ds_read_b64_tr_b16 v[184:185], v22 offset:12288
    ds_read_b64_tr_b16 v[186:187], v22 offset:12416
    v_mfma_f32_16x16x32_bf16 v[116:119], v[188:191], v[28:31], v[116:119]
    s_add_u32 s96, s96, 32768
    s_and_b32 s96, s96, 0x7ffff
    v_mfma_f32_16x16x32_bf16 v[120:123], v[28:31], v[68:71], v[120:123]
    buffer_load_dwordx4 v9, s[84:87], s96 offen lds
    v_mfma_f32_16x16x32_bf16 v[124:127], v[68:71], v[68:71], v[124:127]
    s_waitcnt lgkmcnt(6)
    v_mfma_f32_16x16x32_bf16 v[112:115], v[192:195], v[72:75], v[112:115]
    s_add_u32 m0, s97, 8192
    ds_read_b128 v[84:87], v25 offset:12288
    ds_read_b64_tr_b16 v[188:189], v22 offset:13312
    ds_read_b64_tr_b16 v[190:191], v22 offset:13440
    v_mfma_f32_16x16x32_bf16 v[116:119], v[192:195], v[28:31], v[116:119]
    s_add_u32 s96, s96, 32768
    s_and_b32 s96, s96, 0x7ffff
    v_mfma_f32_16x16x32_bf16 v[120:123], v[28:31], v[72:75], v[120:123]
    buffer_load_dwordx4 v9, s[84:87], s96 offen lds
    v_mfma_f32_16x16x32_bf16 v[124:127], v[72:75], v[72:75], v[124:127]
    s_waitcnt lgkmcnt(6)
    v_mfma_f32_16x16x32_bf16 v[112:115], v[196:199], v[76:79], v[112:115]
    s_add_u32 m0, s97, 12288
    s_waitcnt vmcnt(4)
    ds_read_b128 v[88:91], v24 offset:14336
    ds_read_b64_tr_b16 v[192:193], v22 offset:14336
    ds_read_b64_tr_b16 v[194:195], v22 offset:14464
    v_mfma_f32_16x16x32_bf16 v[116:119], v[196:199], v[28:31], v[116:119]
    s_add_u32 s96, s96, 32768
    s_and_b32 s96, s96, 0x7ffff
    v_mfma_f32_16x16x32_bf16 v[120:123], v[28:31], v[76:79], v[120:123]
    buffer_load_dwordx4 v9, s[84:87], s96 offen lds
    v_mfma_f32_16x16x32_bf16 v[124:127], v[76:79], v[76:79], v[124:127]
    s_waitcnt lgkmcnt(6)
    v_mfma_f32_16x16x32_bf16 v[112:115], v[184:187], v[80:83], v[112:115]
    s_add_u32 m0, s97, 16384
    ds_read_b128 v[92:95], v25 offset:14336
    ds_read_b64_tr_b16 v[196:197], v22 offset:15360
    ds_read_b64_tr_b16 v[198:199], v22 offset:15488
    v_mfma_f32_16x16x32_bf16 v[116:119], v[184:187], v[28:31], v[116:119]
    s_add_u32 s96, s96, 32768
    s_and_b32 s96, s96, 0x7ffff
    v_mfma_f32_16x16x32_bf16 v[120:123], v[28:31], v[80:83], v[120:123]
    buffer_load_dwordx4 v9, s[84:87], s96 offen lds
    v_mfma_f32_16x16x32_bf16 v[124:127], v[80:83], v[80:83], v[124:127]
    s_waitcnt lgkmcnt(6)
    v_mfma_f32_16x16x32_bf16 v[112:115], v[188:191], v[84:87], v[112:115]
    s_add_u32 m0, s97, 20480
    v_mfma_f32_16x16x32_bf16 v[116:119], v[188:191], v[28:31], v[116:119]
    s_add_u32 s96, s96, 32768
    s_and_b32 s96, s96, 0x7ffff
    v_mfma_f32_16x16x32_bf16 v[120:123], v[28:31], v[84:87], v[120:123]
    buffer_load_dwordx4 v9, s[84:87], s96 offen lds
    v_mfma_f32_16x16x32_bf16 v[124:127], v[84:87], v[84:87], v[124:127]
    s_waitcnt lgkmcnt(3)
    v_mfma_f32_16x16x32_bf16 v[112:115], v[192:195], v[88:91], v[112:115]
    s_add_u32 m0, s97, 24576
    v_mfma_f32_16x16x32_bf16 v[116:119], v[192:195], v[28:31], v[116:119]
    s_add_u32 s96, s96, 32768
    s_and_b32 s96, s96, 0x7ffff
    v_mfma_f32_16x16x32_bf16 v[120:123], v[28:31], v[88:91], v[120:123]
    buffer_load_dwordx4 v9, s[84:87], s96 offen lds
    v_mfma_f32_16x16x32_bf16 v[124:127], v[88:91], v[88:91], v[124:127]
    s_waitcnt lgkmcnt(0)
    v_mfma_f32_16x16x32_bf16 v[112:115], v[196:199], v[92:95], v[112:115]
    s_add_u32 m0, s97, 28672
    v_mfma_f32_16x16x32_bf16 v[116:119], v[196:199], v[28:31], v[116:119]
    s_add_u32 s96, s96, 32768
    s_and_b32 s96, s96, 0x7ffff
    v_mfma_f32_16x16x32_bf16 v[120:123], v[28:31], v[92:95], v[120:123]
    buffer_load_dwordx4 v9, s[84:87], s96 offen lds
    v_mfma_f32_16x16x32_bf16 v[124:127], v[92:95], v[92:95], v[124:127]
    s_branch P0_S1J
P0_S1V:
    ds_read_b128 v[32:35], v24 offset:0
    ds_read_b64_tr_b16 v[184:185], v22 offset:0
    ds_read_b64_tr_b16 v[186:187], v22 offset:128
    ds_read_b128 v[36:39], v25 offset:0
    ds_read_b64_tr_b16 v[188:189], v22 offset:1024
    ds_read_b64_tr_b16 v[190:191], v22 offset:1152
    s_waitcnt vmcnt(14)
    ds_read_b128 v[40:43], v24 offset:2048
    ds_read_b64_tr_b16 v[192:193], v22 offset:2048
    ds_read_b64_tr_b16 v[194:195], v22 offset:2176
    s_waitcnt lgkmcnt(6)
    v_mfma_f32_16x16x32_bf16 v[112:115], v[32:35], v[184:187], 0
    ds_read_b128 v[44:47], v25 offset:2048
    ds_read_b64_tr_b16 v[196:197], v22 offset:3072
    ds_read_b64_tr_b16 v[198:199], v22 offset:3200
    v_mfma_f32_16x16x32_bf16 v[116:119], v[28:31], v[184:187], 0
    v_mfma_f32_16x16x32_bf16 v[120:123], v[28:31], v[32:35], 0
    v_mfma_f32_16x16x32_bf16 v[124:127], v[32:35], v[32:35], 0
    s_waitcnt lgkmcnt(6)
    v_mfma_f32_16x16x32_bf16 v[112:115], v[36:39], v[188:191], v[112:115]
    s_waitcnt vmcnt(12)
    ds_read_b128 v[48:51], v24 offset:4096
    ds_read_b64_tr_b16 v[184:185], v22 offset:4096
    ds_read_b64_tr_b16 v[186:187], v22 offset:4224
    v_mfma_f32_16x16x32_bf16 v[116:119], v[28:31], v[188:191], v[116:119]
    v_mfma_f32_16x16x32_bf16 v[120:123], v[28:31], v[36:39], v[120:123]
    v_mfma_f32_16x16x32_bf16 v[124:127], v[36:39], v[36:39], v[124:127]
    s_waitcnt lgkmcnt(6)
    v_mfma_f32_16x16x32_bf16 v[112:115], v[40:43], v[192:195], v[112:115]
    ds_read_b128 v[52:55], v25 offset:4096
    ds_read_b64_tr_b16 v[188:189], v22 offset:5120
    ds_read_b64_tr_b16 v[190:191], v22 offset:5248
    v_mfma_f32_16x16x32_bf16 v[116:119], v[28:31], v[192:195], v[116:119]
    v_mfma_f32_16x16x32_bf16 v[120:123], v[28:31], v[40:43], v[120:123]
    v_mfma_f32_16x16x32_bf16 v[124:127], v[40:43], v[40:43], v[124:127]
    s_waitcnt lgkmcnt(6)
    v_mfma_f32_16x16x32_bf16 v[112:115], v[44:47], v[196:199], v[112:115]
    s_waitcnt vmcnt(9)
    ds_read_b128 v[56:59], v24 offset:6144
    ds_read_b64_tr_b16 v[192:193], v22 offset:6144
    ds_read_b64_tr_b16 v[194:195], v22 offset:6272
    v_mfma_f32_16x16x32_bf16 v[116:119], v[28:31], v[196:199], v[116:119]
    v_mfma_f32_16x16x32_bf16 v[120:123], v[28:31], v[44:47], v[120:123]
    v_mfma_f32_16x16x32_bf16 v[124:127], v[44:47], v[44:47], v[124:127]
    s_waitcnt lgkmcnt(6)
    v_mfma_f32_16x16x32_bf16 v[112:115], v[48:51], v[184:187], v[112:115]
    ds_read_b128 v[60:63], v25 offset:6144
    ds_read_b64_tr_b16 v[196:197], v22 offset:7168
    ds_read_b64_tr_b16 v[198:199], v22 offset:7296
    v_mfma_f32_16x16x32_bf16 v[116:119], v[28:31], v[184:187], v[116:119]
    v_mfma_f32_16x16x32_bf16 v[120:123], v[28:31], v[48:51], v[120:123]
    v_mfma_f32_16x16x32_bf16 v[124:127], v[48:51], v[48:51], v[124:127]
    s_waitcnt lgkmcnt(6)
    v_mfma_f32_16x16x32_bf16 v[112:115], v[52:55], v[188:191], v[112:115]
    s_waitcnt vmcnt(7)
    ds_read_b128 v[64:67], v24 offset:8192
    ds_read_b64_tr_b16 v[184:185], v22 offset:8192
    ds_read_b64_tr_b16 v[186:187], v22 offset:8320
    v_mfma_f32_16x16x32_bf16 v[116:119], v[28:31], v[188:191], v[116:119]
    v_mfma_f32_16x16x32_bf16 v[120:123], v[28:31], v[52:55], v[120:123]
    v_mfma_f32_16x16x32_bf16 v[124:127], v[52:55], v[52:55], v[124:127]
    s_waitcnt lgkmcnt(6)
    v_mfma_f32_16x16x32_bf16 v[112:115], v[56:59], v[192:195], v[112:115]
    ds_read_b128 v[68:71], v25 offset:8192
    ds_read_b64_tr_b16 v[188:189], v22 offset:9216
    ds_read_b64_tr_b16 v[190:191], v22 offset:9344
    v_mfma_f32_16x16x32_bf16 v[116:119], v[28:31], v[192:195], v[116:119]
    v_mfma_f32_16x16x32_bf16 v[120:123], v[28:31], v[56:59], v[120:123]
    v_mfma_f32_16x16x32_bf16 v[124:127], v[56:59], v[56:59], v[124:127]
    s_waitcnt lgkmcnt(6)
    v_mfma_f32_16x16x32_bf16 v[112:115], v[60:63], v[196:199], v[112:115]
    s_waitcnt vmcnt(5)
    ds_read_b128 v[72:75], v24 offset:10240
    ds_read_b64_tr_b16 v[192:193], v22 offset:10240
    ds_read_b64_tr_b16 v[194:195], v22 offset:10368
    v_mfma_f32_16x16x32_bf16 v[116:119], v[28:31], v[196:199], v[116:119]
    v_mfma_f32_16x16x32_bf16 v[120:123], v[28:31], v[60:63], v[120:123]
    v_mfma_f32_16x16x32_bf16 v[124:127], v[60:63], v[60:63], v[124:127]
    s_waitcnt lgkmcnt(6)
    v_mfma_f32_16x16x32_bf16 v[112:115], v[64:67], v[184:187], v[112:115]
    s_add_u32 m0, s97, 0
    ds_read_b128 v[76:79], v25 offset:10240
    ds_read_b64_tr_b16 v[196:197], v22 offset:11264
    ds_read_b64_tr_b16 v[198:199], v22 offset:11392
    v_mfma_f32_16x16x32_bf16 v[116:119], v[28:31], v[184:187], v[116:119]
    s_add_u32 s96, s96, 32768
    s_and_b32 s96, s96, 0x7ffff
    v_mfma_f32_16x16x32_bf16 v[120:123], v[28:31], v[64:67], v[120:123]
    buffer_load_dwordx4 v9, s[84:87], s96 offen lds
    v_mfma_f32_16x16x32_bf16 v[124:127], v[64:67], v[64:67], v[124:127]
    s_waitcnt lgkmcnt(6)
    v_mfma_f32_16x16x32_bf16 v[112:115], v[68:71], v[188:191], v[112:115]
    s_add_u32 m0, s97, 4096
    s_waitcnt vmcnt(4)
    ds_read_b128 v[80:83], v24 offset:12288
    ds_read_b64_tr_b16 v[184:185], v22 offset:12288
    ds_read_b64_tr_b16 v[186:187], v22 offset:12416
    v_mfma_f32_16x16x32_bf16 v[116:119], v[28:31], v[188:191], v[116:119]
    s_add_u32 s96, s96, 32768
    s_and_b32 s96, s96, 0x7ffff
    v_mfma_f32_16x16x32_bf16 v[120:123], v[28:31], v[68:71], v[120:123]
    buffer_load_dwordx4 v9, s[84:87], s96 offen lds
    v_mfma_f32_16x16x32_bf16 v[124:127], v[68:71], v[68:71], v[124:127]
    s_waitcnt lgkmcnt(6)
    v_mfma_f32_16x16x32_bf16 v[112:115], v[72:75], v[192:195], v[112:115]
    s_add_u32 m0, s97, 8192
    ds_read_b128 v[84:87], v25 offset:12288
    ds_read_b64_tr_b16 v[188:189], v22 offset:13312
    ds_read_b64_tr_b16 v[190:191], v22 offset:13440
    v_mfma_f32_16x16x32_bf16 v[116:119], v[28:31], v[192:195], v[116:119]
    s_add_u32 s96, s96, 32768
    s_and_b32 s96, s96, 0x7ffff
    v_mfma_f32_16x16x32_bf16 v[120:123], v[28:31], v[72:75], v[120:123]
    buffer_load_dwordx4 v9, s[84:87], s96 offen lds
    v_mfma_f32_16x16x32_bf16 v[124:127], v[72:75], v[72:75], v[124:127]
    s_waitcnt lgkmcnt(6)
    v_mfma_f32_16x16x32_bf16 v[112:115], v[76:79], v[196:199], v[112:115]
    s_add_u32 m0, s97, 12288
    s_waitcnt vmcnt(4)
    ds_read_b128 v[88:91], v24 offset:14336
    ds_read_b64_tr_b16 v[192:193], v22 offset:14336
    ds_read_b64_tr_b16 v[194:195], v22 offset:14464
    v_mfma_f32_16x16x32_bf16 v[116:119], v[28:31], v[196:199], v[116:119]
    s_add_u32 s96, s96, 32768
    s_and_b32 s96, s96, 0x7ffff
    v_mfma_f32_16x16x32_bf16 v[120:123], v[28:31], v[76:79], v[120:123]
    buffer_load_dwordx4 v9, s[84:87], s96 offen lds
    v_mfma_f32_16x16x32_bf16 v[124:127], v[76:79], v[76:79], v[124:127]
    s_waitcnt lgkmcnt(6)
    v_mfma_f32_16x16x32_bf16 v[112:115], v[80:83], v[184:187], v[112:115]
    s_add_u32 m0, s97, 16384
    ds_read_b128 v[92:95], v25 offset:14336
    ds_read_b64_tr_b16 v[196:197], v22 offset:15360
    ds_read_b64_tr_b16 v[198:199], v22 offset:15488
    v_mfma_f32_16x16x32_bf16 v[116:119], v[28:31], v[184:187], v[116:119]
    s_add_u32 s96, s96, 32768
    s_and_b32 s96, s96, 0x7ffff
    v_mfma_f32_16x16x32_bf16 v[120:123], v[28:31], v[80:83], v[120:123]
    buffer_load_dwordx4 v9, s[84:87], s96 offen lds
    v_mfma_f32_16x16x32_bf16 v[124:127], v[80:83], v[80:83], v[124:127]
    s_waitcnt lgkmcnt(6)
    v_mfma_f32_16x16x32_bf16 v[112:115], v[84:87], v[188:191], v[112:115]
    s_add_u32 m0, s97, 20480
    v_mfma_f32_16x16x32_bf16 v[116:119], v[28:31], v[188:191], v[116:119]
    s_add_u32 s96, s96, 32768
    s_and_b32 s96, s96, 0x7ffff
    v_mfma_f32_16x16x32_bf16 v[120:123], v[28:31], v[84:87], v[120:123]
    buffer_load_dwordx4 v9, s[84:87], s96 offen lds
    v_mfma_f32_16x16x32_bf16 v[124:127], v[84:87], v[84:87], v[124:127]
    s_waitcnt lgkmcnt(3)
    v_mfma_f32_16x16x32_bf16 v[112:115], v[88:91], v[192:195], v[112:115]
    s_add_u32 m0, s97, 24576
    v_mfma_f32_16x16x32_bf16 v[116:119], v[28:31], v[192:195], v[116:119]
    s_add_u32 s96, s96, 32768
    s_and_b32 s96, s96, 0x7ffff
    v_mfma_f32_16x16x32_bf16 v[120:123], v[28:31], v[88:91], v[120:123]
    buffer_load_dwordx4 v9, s[84:87], s96 offen lds
    v_mfma_f32_16x16x32_bf16 v[124:127], v[88:91], v[88:91], v[124:127]
    s_waitcnt lgkmcnt(0)
    v_mfma_f32_16x16x32_bf16 v[112:115], v[92:95], v[196:199], v[112:115]
    s_add_u32 m0, s97, 28672
    v_mfma_f32_16x16x32_bf16 v[116:119], v[28:31], v[196:199], v[116:119]
    s_add_u32 s96, s96, 32768
    s_and_b32 s96, s96, 0x7ffff
    v_mfma_f32_16x16x32_bf16 v[120:123], v[28:31], v[92:95], v[120:123]
    buffer_load_dwordx4 v9, s[84:87], s96 offen lds
    v_mfma_f32_16x16x32_bf16 v[124:127], v[92:95], v[92:95], v[124:127]
P0_S1J:
    ds_read_b64 v[244:245], v14
    ds_read_b64 v[246:247], v15
    ds_read_b64 v[248:249], v16
    ds_read_b64 v[250:251], v17
    v_lshrrev_b32 v21, 2, v2
    v_cmp_eq_u32 s[24:25], v21, v3
    v_cmp_eq_u32 s[26:27], 1, v19
    v_cmp_eq_u32 s[28:29], 2, v19
    v_cmp_eq_u32 vcc, 3, v19
    v_mul_f32 v120, 0x3b000000, v120
    v_cndmask_b32 v124, v124, v125, s[26:27]
    v_cndmask_b32 v124, v124, v126, s[28:29]
    v_cndmask_b32 v124, v124, v127, vcc
    v_cndmask_b32 v124, 0, v124, s[24:25]
    v_mov_b32 v125, v124
    s_nop 1
    v_permlane32_swap_b32 v124, v125
    v_add_f32 v124, v124, v125
    v_mov_b32 v125, v124
    s_nop 1
    v_permlane16_swap_b32 v124, v125
    v_add_f32 v124, v124, v125
    v_mul_f32 v124, 0x3b000000, v124
    v_fma_f32 v124, -v120, v120, v124
    v_max_f32 v124, 0, v124
    v_add_f32 v124, 0x3727c5ac, v124
    v_rsq_f32 v252, v124
    s_nop 0
    v_mul_f32 v253, v120, v252
    s_bitcmp1_b32 s13, 0
    s_cbranch_scc1 P0_EV
    v_mul_f32 v112, v112, v252
    v_fma_f32 v112, -v116, v253, v112
    v_mul_f32 v113, v113, v252
    v_fma_f32 v113, -v117, v253, v113
    v_mul_f32 v114, v114, v252
    v_fma_f32 v114, -v118, v253, v114
    v_mul_f32 v115, v115, v252
    v_fma_f32 v115, -v119, v253, v115
    v_cvt_pk_bf16_f32 v112, v112, v113
    v_cvt_pk_bf16_f32 v113, v114, v115
    buffer_store_dwordx2 v[112:113], v12, s[4:7], s62 offen sc1
    s_branch P0_EJ
P0_EV:
    ds_bpermute_b32 v184, v18, v252 offset:0
    ds_bpermute_b32 v188, v18, v253 offset:0
    ds_bpermute_b32 v185, v18, v252 offset:4
    ds_bpermute_b32 v189, v18, v253 offset:4
    ds_bpermute_b32 v186, v18, v252 offset:8
    ds_bpermute_b32 v190, v18, v253 offset:8
    ds_bpermute_b32 v187, v18, v252 offset:12
    ds_bpermute_b32 v191, v18, v253 offset:12
    s_waitcnt lgkmcnt(0)
    v_mul_f32 v112, v112, v184
    v_fma_f32 v112, -v116, v188, v112
    v_mul_f32 v113, v113, v185
    v_fma_f32 v113, -v116, v189, v113
    v_mul_f32 v114, v114, v186
    v_fma_f32 v114, -v116, v190, v114
    v_mul_f32 v115, v115, v187
    v_fma_f32 v115, -v116, v191, v115
    v_cvt_pk_bf16_f32 v112, v112, v113
    v_cvt_pk_bf16_f32 v113, v114, v115
    buffer_store_dwordx2 v[112:113], v13, s[4:7], s62 offen sc1
P0_EJ:
    s_add_u32 m0, s97, 32768
    s_add_u32 s96, s96, 32768
    s_and_b32 s96, s96, 0x7ffff
    buffer_load_dwordx4 v9, s[84:87], s96 offen lds
    s_add_u32 m0, s97, 36864
    s_add_u32 s96, s96, 32768
    s_and_b32 s96, s96, 0x7ffff
    buffer_load_dwordx4 v9, s[84:87], s96 offen lds
    s_waitcnt lgkmcnt(0)
    s_lshl_b32 s24, s13, 13
    s_add_u32 s24, s24, s15
    s_add_u32 s79, s24, 65536
    v_mul_f32 v252, 0x3eb8aa3b, v252
    v_mul_f32 v253, 0x3eb8aa3b, v253
    s_waitcnt vmcnt(7)
    s_barrier
    ds_write_b64 v232, v[252:253]
    ds_write_b64 v232, v[252:253] offset:512
    ds_read_b64_tr_b16 v[160:161], v228 offset:0
    ds_read_b64_tr_b16 v[162:163], v228 offset:512
    ds_read_b128 v[164:167], v96 offset:0
    ds_read_b128 v[168:171], v98 offset:0
    ds_read_b128 v[172:175], v100 offset:0
    ds_read_b64_tr_b16 v[176:177], v228 offset:4096
    ds_read_b64_tr_b16 v[178:179], v228 offset:4608
    ds_read_b128 v[180:183], v97 offset:0
    ds_read_b128 v[184:187], v99 offset:0
    ds_read_b128 v[188:191], v101 offset:0
    s_waitcnt lgkmcnt(5)
    v_mfma_f32_16x16x32_bf16 v[208:211], v[160:163], v[32:35], 0
    ds_read_b64_tr_b16 v[192:193], v228 offset:8192
    ds_read_b64_tr_b16 v[194:195], v228 offset:8704
    v_mfma_f32_16x16x32_bf16 v[212:215], v[160:163], v[164:167], 0
    ds_read_b128 v[196:199], v96 offset:2048
    s_add_u32 m0, s97, 40960
    s_add_u32 s96, s96, 32768
    s_and_b32 s96, s96, 0x7ffff
    buffer_load_dwordx4 v9, s[84:87], s96 offen lds
    v_mfma_f32_16x16x32_bf16 v[216:219], v[160:163], v[168:171], 0
    ds_read_b128 v[200:203], v98 offset:2048
    v_mfma_f32_16x16x32_bf16 v[220:223], v[160:163], v[172:175], 0
    ds_read_b128 v[204:207], v100 offset:2048
    v_mfma_f32_16x16x32_bf16 v[224:227], v[160:163], v[28:31], 0
    s_waitcnt lgkmcnt(5)
    v_mfma_f32_16x16x32_bf16 v[208:211], v[176:179], v[36:39], v[208:211]
    ds_read_b64_tr_b16 v[160:161], v228 offset:12288
    ds_read_b64_tr_b16 v[162:163], v228 offset:12800
    v_mfma_f32_16x16x32_bf16 v[212:215], v[176:179], v[180:183], v[212:215]
    ds_read_b128 v[164:167], v97 offset:2048
    s_add_u32 m0, s97, 45056
    s_add_u32 s96, s96, 32768
    s_and_b32 s96, s96, 0x7ffff
    buffer_load_dwordx4 v9, s[84:87], s96 offen lds
    v_mfma_f32_16x16x32_bf16 v[216:219], v[176:179], v[184:187], v[216:219]
    ds_read_b128 v[168:171], v99 offset:2048
    v_mfma_f32_16x16x32_bf16 v[220:223], v[176:179], v[188:191], v[220:223]
    ds_read_b128 v[172:175], v101 offset:2048
    v_mfma_f32_16x16x32_bf16 v[224:227], v[176:179], v[28:31], v[224:227]
    s_waitcnt lgkmcnt(5)
    v_mfma_f32_16x16x32_bf16 v[208:211], v[192:195], v[40:43], v[208:211]
    s_waitcnt vmcnt(5)
    s_barrier
    ds_read_b64_tr_b16 v[176:177], v228 offset:16384
    ds_read_b64_tr_b16 v[178:179], v228 offset:16896
    v_mfma_f32_16x16x32_bf16 v[212:215], v[192:195], v[196:199], v[212:215]
    ds_read_b128 v[180:183], v96 offset:4096
    s_add_u32 m0, s97, 49152
    s_add_u32 s96, s96, 32768
    s_and_b32 s96, s96, 0x7ffff
    buffer_load_dwordx4 v9, s[84:87], s96 offen lds
    v_mfma_f32_16x16x32_bf16 v[216:219], v[192:195], v[200:203], v[216:219]
    ds_read_b128 v[184:187], v98 offset:4096
    v_mfma_f32_16x16x32_bf16 v[220:223], v[192:195], v[204:207], v[220:223]
    ds_read_b128 v[188:191], v100 offset:4096
    v_mfma_f32_16x16x32_bf16 v[224:227], v[192:195], v[28:31], v[224:227]
    s_waitcnt lgkmcnt(5)
    v_mfma_f32_16x16x32_bf16 v[208:211], v[160:163], v[44:47], v[208:211]
    ds_read_b64_tr_b16 v[192:193], v228 offset:20480
    ds_read_b64_tr_b16 v[194:195], v228 offset:20992
    v_mfma_f32_16x16x32_bf16 v[212:215], v[160:163], v[164:167], v[212:215]
    ds_read_b128 v[196:199], v97 offset:4096
    s_add_u32 m0, s97, 53248
    s_add_u32 s96, s96, 32768
    s_and_b32 s96, s96, 0x7ffff
    buffer_load_dwordx4 v9, s[84:87], s96 offen lds
    v_mfma_f32_16x16x32_bf16 v[216:219], v[160:163], v[168:171], v[216:219]
    ds_read_b128 v[200:203], v99 offset:4096
    v_mfma_f32_16x16x32_bf16 v[220:223], v[160:163], v[172:175], v[220:223]
    ds_read_b128 v[204:207], v101 offset:4096
    v_mfma_f32_16x16x32_bf16 v[224:227], v[160:163], v[28:31], v[224:227]
    s_waitcnt lgkmcnt(5)
    v_mfma_f32_16x16x32_bf16 v[208:211], v[176:179], v[48:51], v[208:211]
    ds_read_b64_tr_b16 v[160:161], v228 offset:24576
    ds_read_b64_tr_b16 v[162:163], v228 offset:25088
    v_mfma_f32_16x16x32_bf16 v[212:215], v[176:179], v[180:183], v[212:215]
    ds_read_b128 v[164:167], v96 offset:6144
    s_add_u32 m0, s97, 57344
    s_add_u32 s96, s96, 32768
    s_and_b32 s96, s96, 0x7ffff
    buffer_load_dwordx4 v9, s[84:87], s96 offen lds
    v_mfma_f32_16x16x32_bf16 v[216:219], v[176:179], v[184:187], v[216:219]
    ds_read_b128 v[168:171], v98 offset:6144
    v_mfma_f32_16x16x32_bf16 v[220:223], v[176:179], v[188:191], v[220:223]
    ds_read_b128 v[172:175], v100 offset:6144
    v_mfma_f32_16x16x32_bf16 v[224:227], v[176:179], v[28:31], v[224:227]
    s_waitcnt lgkmcnt(5)
    v_mfma_f32_16x16x32_bf16 v[208:211], v[192:195], v[52:55], v[208:211]
    ds_read_b64_tr_b16 v[176:177], v228 offset:28672
    ds_read_b64_tr_b16 v[178:179], v228 offset:29184
    v_mfma_f32_16x16x32_bf16 v[212:215], v[192:195], v[196:199], v[212:215]
    ds_read_b128 v[180:183], v97 offset:6144
    s_add_u32 m0, s97, 61440
    s_add_u32 s96, s96, 32768
    s_and_b32 s96, s96, 0x7ffff
    buffer_load_dwordx4 v9, s[84:87], s96 offen lds
    v_mfma_f32_16x16x32_bf16 v[216:219], v[192:195], v[200:203], v[216:219]
    ds_read_b128 v[184:187], v99 offset:6144
    v_mfma_f32_16x16x32_bf16 v[220:223], v[192:195], v[204:207], v[220:223]
    ds_read_b128 v[188:191], v101 offset:6144
    v_mfma_f32_16x16x32_bf16 v[224:227], v[192:195], v[28:31], v[224:227]
    s_waitcnt lgkmcnt(5)
    v_mfma_f32_16x16x32_bf16 v[208:211], v[160:163], v[56:59], v[208:211]
    s_waitcnt vmcnt(4)
    s_barrier
    ds_read_b64 v[104:105], v232 offset:0
    ds_read_b64 v[106:107], v232 offset:128
    ds_read_b64 v[108:109], v232 offset:256
    ds_read_b64 v[110:111], v232 offset:384
    s_cmp_eq_u32 s14, 0
    s_cselect_b32 s24, s68, 25165824
    s_cmp_eq_u32 s14, 2
    s_cselect_b32 s90, s90, 25165824
    s_mov_b64 exec, 1
    buffer_store_dword v157, off, s[4:7], s24
    s_mov_b64 exec, -1
    ds_read_b64_tr_b16 v[192:193], v228 offset:32768
    ds_read_b64_tr_b16 v[194:195], v228 offset:33280
    v_mfma_f32_16x16x32_bf16 v[212:215], v[160:163], v[164:167], v[212:215]
    ds_read_b128 v[196:199], v96 offset:8192
    v_mfma_f32_16x16x32_bf16 v[216:219], v[160:163], v[168:171], v[216:219]
    ds_read_b128 v[200:203], v98 offset:8192
    v_mfma_f32_16x16x32_bf16 v[220:223], v[160:163], v[172:175], v[220:223]
    ds_read_b128 v[204:207], v100 offset:8192
    v_mfma_f32_16x16x32_bf16 v[224:227], v[160:163], v[28:31], v[224:227]
    s_waitcnt lgkmcnt(9)
    v_mfma_f32_16x16x32_bf16 v[208:211], v[176:179], v[60:63], v[208:211]
    ds_read_b64_tr_b16 v[160:161], v228 offset:36864
    ds_read_b64_tr_b16 v[162:163], v228 offset:37376
    v_mfma_f32_16x16x32_bf16 v[212:215], v[176:179], v[180:183], v[212:215]
    ds_read_b128 v[164:167], v97 offset:8192
    v_mfma_f32_16x16x32_bf16 v[216:219], v[176:179], v[184:187], v[216:219]
    ds_read_b128 v[168:171], v99 offset:8192
    v_mfma_f32_16x16x32_bf16 v[220:223], v[176:179], v[188:191], v[220:223]
    ds_read_b128 v[172:175], v101 offset:8192
    v_mfma_f32_16x16x32_bf16 v[224:227], v[176:179], v[28:31], v[224:227]
    s_waitcnt lgkmcnt(5)
    v_mfma_f32_16x16x32_bf16 v[208:211], v[192:195], v[64:67], v[208:211]
    ds_read_b64_tr_b16 v[176:177], v228 offset:40960
    ds_read_b64_tr_b16 v[178:179], v228 offset:41472
    v_mfma_f32_16x16x32_bf16 v[212:215], v[192:195], v[196:199], v[212:215]
    ds_read_b128 v[180:183], v96 offset:10240
    v_mfma_f32_16x16x32_bf16 v[216:219], v[192:195], v[200:203], v[216:219]
    ds_read_b128 v[184:187], v98 offset:10240
    v_mfma_f32_16x16x32_bf16 v[220:223], v[192:195], v[204:207], v[220:223]
    ds_read_b128 v[188:191], v100 offset:10240
    v_mfma_f32_16x16x32_bf16 v[224:227], v[192:195], v[28:31], v[224:227]
    s_waitcnt lgkmcnt(5)
    v_mfma_f32_16x16x32_bf16 v[208:211], v[160:163], v[68:71], v[208:211]
    ds_read_b64_tr_b16 v[192:193], v228 offset:45056
    ds_read_b64_tr_b16 v[194:195], v228 offset:45568
    v_mfma_f32_16x16x32_bf16 v[212:215], v[160:163], v[164:167], v[212:215]
    ds_read_b128 v[196:199], v97 offset:10240
    v_mfma_f32_16x16x32_bf16 v[216:219], v[160:163], v[168:171], v[216:219]
    ds_read_b128 v[200:203], v99 offset:10240
    v_mfma_f32_16x16x32_bf16 v[220:223], v[160:163], v[172:175], v[220:223]
    ds_read_b128 v[204:207], v101 offset:10240
    v_mfma_f32_16x16x32_bf16 v[224:227], v[160:163], v[28:31], v[224:227]
    s_waitcnt lgkmcnt(5)
    v_mfma_f32_16x16x32_bf16 v[208:211], v[176:179], v[72:75], v[208:211]
    s_waitcnt vmcnt(1)
    s_barrier
    ds_read_b64_tr_b16 v[160:161], v228 offset:49152
    ds_read_b64_tr_b16 v[162:163], v228 offset:49664
    v_mfma_f32_16x16x32_bf16 v[212:215], v[176:179], v[180:183], v[212:215]
    ds_read_b128 v[164:167], v96 offset:12288
    v_mfma_f32_16x16x32_bf16 v[216:219], v[176:179], v[184:187], v[216:219]
    ds_read_b128 v[168:171], v98 offset:12288
    v_mfma_f32_16x16x32_bf16 v[220:223], v[176:179], v[188:191], v[220:223]
    ds_read_b128 v[172:175], v100 offset:12288
    v_mfma_f32_16x16x32_bf16 v[224:227], v[176:179], v[28:31], v[224:227]
    s_waitcnt lgkmcnt(5)
    v_mfma_f32_16x16x32_bf16 v[208:211], v[192:195], v[76:79], v[208:211]
    ds_read_b64_tr_b16 v[176:177], v228 offset:53248
    ds_read_b64_tr_b16 v[178:179], v228 offset:53760
    v_mfma_f32_16x16x32_bf16 v[212:215], v[192:195], v[196:199], v[212:215]
    ds_read_b128 v[180:183], v97 offset:12288
    v_mfma_f32_16x16x32_bf16 v[216:219], v[192:195], v[200:203], v[216:219]
    ds_read_b128 v[184:187], v99 offset:12288
    v_mfma_f32_16x16x32_bf16 v[220:223], v[192:195], v[204:207], v[220:223]
    ds_read_b128 v[188:191], v101 offset:12288
    v_mfma_f32_16x16x32_bf16 v[224:227], v[192:195], v[28:31], v[224:227]
    s_waitcnt lgkmcnt(5)
    v_mfma_f32_16x16x32_bf16 v[208:211], v[160:163], v[80:83], v[208:211]
    ds_read_b64_tr_b16 v[192:193], v228 offset:57344
    ds_read_b64_tr_b16 v[194:195], v228 offset:57856
    v_mfma_f32_16x16x32_bf16 v[212:215], v[160:163], v[164:167], v[212:215]
    ds_read_b128 v[196:199], v96 offset:14336
    v_mfma_f32_16x16x32_bf16 v[216:219], v[160:163], v[168:171], v[216:219]
    ds_read_b128 v[200:203], v98 offset:14336
    v_mfma_f32_16x16x32_bf16 v[220:223], v[160:163], v[172:175], v[220:223]
    ds_read_b128 v[204:207], v100 offset:14336
    v_mfma_f32_16x16x32_bf16 v[224:227], v[160:163], v[28:31], v[224:227]
    s_waitcnt lgkmcnt(5)
    v_mfma_f32_16x16x32_bf16 v[208:211], v[176:179], v[84:87], v[208:211]
    ds_read_b64_tr_b16 v[160:161], v228 offset:61440
    ds_read_b64_tr_b16 v[162:163], v228 offset:61952
    v_mfma_f32_16x16x32_bf16 v[212:215], v[176:179], v[180:183], v[212:215]
    ds_read_b128 v[164:167], v97 offset:14336
    buffer_load_dword v27, v26, s[4:7], s39 offen sc1
    v_mfma_f32_16x16x32_bf16 v[216:219], v[176:179], v[184:187], v[216:219]
    ds_read_b128 v[168:171], v99 offset:14336
    v_mfma_f32_16x16x32_bf16 v[220:223], v[176:179], v[188:191], v[220:223]
    ds_read_b128 v[172:175], v101 offset:14336
    v_mfma_f32_16x16x32_bf16 v[224:227], v[176:179], v[28:31], v[224:227]
    s_waitcnt lgkmcnt(5)
    v_mfma_f32_16x16x32_bf16 v[208:211], v[192:195], v[88:91], v[208:211]
    v_mfma_f32_16x16x32_bf16 v[212:215], v[192:195], v[196:199], v[212:215]
    v_mfma_f32_16x16x32_bf16 v[216:219], v[192:195], v[200:203], v[216:219]
    v_mfma_f32_16x16x32_bf16 v[220:223], v[192:195], v[204:207], v[220:223]
    v_mfma_f32_16x16x32_bf16 v[224:227], v[192:195], v[28:31], v[224:227]
    s_waitcnt lgkmcnt(0)
    v_mfma_f32_16x16x32_bf16 v[208:211], v[160:163], v[92:95], v[208:211]
    v_mfma_f32_16x16x32_bf16 v[212:215], v[160:163], v[164:167], v[212:215]
    v_mfma_f32_16x16x32_bf16 v[216:219], v[160:163], v[168:171], v[216:219]
    v_mfma_f32_16x16x32_bf16 v[220:223], v[160:163], v[172:175], v[220:223]
    v_mfma_f32_16x16x32_bf16 v[224:227], v[160:163], v[28:31], v[224:227]
    s_waitcnt vmcnt(0)
    v_cmp_ne_u32 vcc, s43, v27
    s_nop 1
    s_cbranch_vccnz XL0_SLOW
XL0_OK:
    global_load_dwordx4 v[128:131], v1, s[32:33]
    s_mov_b64 exec, s[20:21]
    global_load_dwordx4 v[132:135], v7, s[32:33] offset:1024
    global_load_dwordx4 v[136:139], v7, s[32:33] offset:1536
    s_mov_b64 exec, -1
    s_add_u32 s30, s30, 4096
    s_and_b32 s30, s30, 0x1ffff
    s_add_u32 s32, s30, s31
    s_addc_u32 s33, s38, 0
    global_load_dwordx4 v[140:143], v1, s[32:33]
    s_cmp_lg_u32 s14, 1
    s_cbranch_scc1 XP0_SKIP
    s_cmp_ge_u32 s2, 8
    s_cbranch_scc1 XP0_SKIP
    s_lshl_b32 s25, s2, 2
    s_add_u32 s24, s25, 4391936
    v_lshlrev_b32 v27, 3, v1
    v_mov_b32 v5, s43
    s_mov_b64 exec, 0xff
    buffer_store_dword v5, v27, s[4:7], s24 offen sc1
    s_mov_b64 exec, -1
XP0_SKIP:
    v_mov_b32 v164, v144
    v_mov_b32 v165, v144
    v_mov_b32 v166, v144
    v_mov_b32 v167, v144
    v_mov_b32 v168, v144
    v_mov_b32 v169, v144
    v_mov_b32 v170, v144
    v_mov_b32 v171, v144
    v_mov_b32 v176, v144
    v_mov_b32 v177, v144
    v_mov_b32 v178, v144
    v_mov_b32 v179, v144
    v_mov_b32 v180, v144
    v_mov_b32 v181, v144
    v_mov_b32 v182, v144
    v_mov_b32 v183, v144
    s_load_dwordx2 s[80:81], s[0:1], 64
    v_pk_mul_f32 v[208:209], v[208:209], v[104:105] op_sel_hi:[1,0]
    v_pk_mul_f32 v[210:211], v[210:211], v[104:105] op_sel_hi:[1,0]
    v_pk_fma_f32 v[208:209], v[224:225], v[104:105], v[208:209] op_sel:[0,1,0] op_sel_hi:[1,1,1] neg_lo:[1,0,0] neg_hi:[1,0,0]
    v_pk_fma_f32 v[210:211], v[226:227], v[104:105], v[210:211] op_sel:[0,1,0] op_sel_hi:[1,1,1] neg_lo:[1,0,0] neg_hi:[1,0,0]
    v_cvt_pk_bf16_f32 v208, v208, v209
    v_cvt_pk_bf16_f32 v209, v210, v211
    ds_write_b64 v102, v[208:209]
    v_pk_mul_f32 v[212:213], v[212:213], v[106:107] op_sel_hi:[1,0]
    v_pk_mul_f32 v[214:215], v[214:215], v[106:107] op_sel_hi:[1,0]
    v_pk_fma_f32 v[212:213], v[224:225], v[106:107], v[212:213] op_sel:[0,1,0] op_sel_hi:[1,1,1] neg_lo:[1,0,0] neg_hi:[1,0,0]
    v_pk_fma_f32 v[214:215], v[226:227], v[106:107], v[214:215] op_sel:[0,1,0] op_sel_hi:[1,1,1] neg_lo:[1,0,0] neg_hi:[1,0,0]
    v_cvt_pk_bf16_f32 v212, v212, v213
    v_cvt_pk_bf16_f32 v213, v214, v215
    ds_write_b64 v103, v[212:213]
    v_pk_mul_f32 v[216:217], v[216:217], v[108:109] op_sel_hi:[1,0]
    v_pk_mul_f32 v[218:219], v[218:219], v[108:109] op_sel_hi:[1,0]
    v_pk_fma_f32 v[216:217], v[224:225], v[108:109], v[216:217] op_sel:[0,1,0] op_sel_hi:[1,1,1] neg_lo:[1,0,0] neg_hi:[1,0,0]
    v_pk_fma_f32 v[218:219], v[226:227], v[108:109], v[218:219] op_sel:[0,1,0] op_sel_hi:[1,1,1] neg_lo:[1,0,0] neg_hi:[1,0,0]
    v_cvt_pk_bf16_f32 v216, v216, v217
    v_cvt_pk_bf16_f32 v217, v218, v219
    ds_write_b64 v229, v[216:217]
    v_pk_mul_f32 v[220:221], v[220:221], v[110:111] op_sel_hi:[1,0]
    v_pk_mul_f32 v[222:223], v[222:223], v[110:111] op_sel_hi:[1,0]
    v_pk_fma_f32 v[220:221], v[224:225], v[110:111], v[220:221] op_sel:[0,1,0] op_sel_hi:[1,1,1] neg_lo:[1,0,0] neg_hi:[1,0,0]
    v_pk_fma_f32 v[222:223], v[226:227], v[110:111], v[222:223] op_sel:[0,1,0] op_sel_hi:[1,1,1] neg_lo:[1,0,0] neg_hi:[1,0,0]
    v_cvt_pk_bf16_f32 v220, v220, v221
    v_cvt_pk_bf16_f32 v221, v222, v223
    ds_write_b64 v230, v[220:221]
    s_waitcnt lgkmcnt(0)
    s_barrier
    s_lshr_b32 s26, s14, 1
    s_and_b32 s27, s14, 1
    s_lshl_b32 s24, s27, 12
    s_add_u32 s24, s24, 135168
    s_lshl_b32 s25, s26, 11
    s_xor_b32 s28, s25, 2048
    s_add_u32 s25, s25, s24
    s_add_u32 s28, s28, s24
    v_add_u32 v24, s28, v1
    v_add_u32 v25, s25, v1
    ds_read_b128 v[8:11], v24 offset:0
    ds_read_b128 v[12:15], v24 offset:1024
    ds_read_b128 v[16:19], v25 offset:0
    ds_read_b128 v[20:23], v25 offset:1024
    s_lshl_b32 s29, s14, 13
    s_add_u32 s29, s29, 131072
    v_add_u32 v4, s29, v1
    v_bfe_u32 v6, v1, 2, 5
    v_mov_b32 v204, v116
    v_mov_b32 v205, v117
    v_mov_b32 v206, v118
    v_mov_b32 v207, v119
    v_mov_b32 v242, v26
    s_add_u32 s91, s79, s97
    s_waitcnt vmcnt(3) lgkmcnt(0)
    v_mfma_f32_32x32x16_bf16 v[24:39], v[128:131], v[8:11], 0
    s_nop 7
    v_mfma_f32_32x32x16_bf16 v[40:55], v[128:131], v[12:15], 0
    s_waitcnt vmcnt(1)
    s_mov_b64 exec, s[20:21]
    global_load_dwordx4 v[144:147], v7, s[32:33] offset:1024
    global_load_dwordx4 v[148:151], v7, s[32:33] offset:1536
    s_mov_b64 exec, -1
    v_exp_f32 v24, v24
    v_exp_f32 v25, v25
    v_exp_f32 v26, v26
    v_exp_f32 v27, v27
    v_cvt_pk_bf16_f32 v56, v24, v25
    v_exp_f32 v28, v28
    s_add_u32 s30, s30, 4096
    s_and_b32 s30, s30, 0x1ffff
    s_add_u32 s32, s30, s31
    s_addc_u32 s33, s38, 0
    global_load_dwordx4 v[160:163], v1, s[32:33]
    s_mov_b64 exec, s[20:21]
    global_load_dwordx4 v[164:167], v7, s[32:33] offset:1024
    global_load_dwordx4 v[168:171], v7, s[32:33] offset:1536
    s_mov_b64 exec, -1
    v_exp_f32 v29, v29
    v_cvt_pk_bf16_f32 v57, v26, v27
    v_exp_f32 v30, v30
    v_exp_f32 v31, v31
    v_cvt_pk_bf16_f32 v58, v28, v29
    v_exp_f32 v32, v32
    v_cvt_pk_bf16_f32 v59, v30, v31
    v_exp_f32 v33, v33
    v_exp_f32 v34, v34
    v_mfma_f32_32x32x16_bf16 v[64:79], v[132:135], v[56:59], 0
    s_add_u32 s30, s30, 4096
    s_and_b32 s30, s30, 0x1ffff
    s_add_u32 s32, s30, s31
    s_addc_u32 s33, s38, 0
    global_load_dwordx4 v[172:175], v1, s[32:33]
    s_mov_b64 exec, s[20:21]
    global_load_dwordx4 v[176:179], v7, s[32:33] offset:1024
    global_load_dwordx4 v[180:183], v7, s[32:33] offset:1536
    s_mov_b64 exec, -1
    v_cvt_pk_bf16_f32 v60, v32, v33
    v_exp_f32 v35, v35
    v_exp_f32 v36, v36
    v_cvt_pk_bf16_f32 v61, v34, v35
    v_exp_f32 v37, v37
    v_exp_f32 v38, v38
    v_exp_f32 v39, v39
    v_cvt_pk_bf16_f32 v62, v36, v37
    v_cvt_pk_bf16_f32 v63, v38, v39
    v_mfma_f32_32x32x16_bf16 v[24:39], v[128:131], v[16:19], 0
    s_add_u32 m0, s76, 147456
    s_nop 0
    buffer_load_dwordx4 v243, s[8:11], s92 offen lds
    s_add_u32 m0, s76, 148480
    s_add_u32 s92, s92, s94
    buffer_load_dwordx4 v243, s[8:11], s92 offen lds
    v_exp_f32 v40, v40
    v_exp_f32 v41, v41
    v_exp_f32 v42, v42
    v_exp_f32 v43, v43
    v_cvt_pk_bf16_f32 v56, v40, v41
    v_exp_f32 v44, v44
    v_mfma_f32_32x32x16_bf16 v[64:79], v[136:139], v[60:63], v[64:79]
    s_add_u32 m0, s76, 149504
    s_nop 0
    buffer_load_dwordx4 v243, s[8:11], s93 offen lds
    s_add_u32 m0, s76, 150528
    s_add_u32 s93, s93, s94
    buffer_load_dwordx4 v243, s[8:11], s93 offen lds
    v_exp_f32 v45, v45
    v_cvt_pk_bf16_f32 v57, v42, v43
    v_exp_f32 v46, v46
    v_exp_f32 v47, v47
    v_cvt_pk_bf16_f32 v58, v44, v45
    v_exp_f32 v48, v48
    v_cvt_pk_bf16_f32 v59, v46, v47
    v_exp_f32 v49, v49
    v_exp_f32 v50, v50
    v_mfma_f32_32x32x16_bf16 v[80:95], v[132:135], v[56:59], 0
    s_mov_b32 s96, s79
    s_add_u32 s97, s79, 4096
    s_add_u32 s62, s62, 131072
    s_mov_b32 s8, s80
    s_mov_b32 s9, s81
    s_mov_b32 s10, 2097152
    s_mov_b32 s11, 0x20000
    v_cvt_pk_bf16_f32 v60, v48, v49
    v_exp_f32 v51, v51
    v_exp_f32 v52, v52
    v_cvt_pk_bf16_f32 v61, v50, v51
    v_exp_f32 v53, v53
    v_exp_f32 v54, v54
    v_exp_f32 v55, v55
    v_cvt_pk_bf16_f32 v62, v52, v53
    v_cvt_pk_bf16_f32 v63, v54, v55
    v_mfma_f32_32x32x16_bf16 v[40:55], v[128:131], v[20:23], 0
    v_exp_f32 v24, v24
    v_exp_f32 v25, v25
    v_exp_f32 v26, v26
    v_exp_f32 v27, v27
    v_cvt_pk_bf16_f32 v56, v24, v25
    v_exp_f32 v28, v28
    v_mfma_f32_32x32x16_bf16 v[80:95], v[136:139], v[60:63], v[80:95]
    v_exp_f32 v29, v29
    v_cvt_pk_bf16_f32 v57, v26, v27
    v_exp_f32 v30, v30
    v_exp_f32 v31, v31
    v_cvt_pk_bf16_f32 v58, v28, v29
    v_exp_f32 v32, v32
    v_cvt_pk_bf16_f32 v59, v30, v31
    v_exp_f32 v33, v33
    v_exp_f32 v34, v34
    v_mfma_f32_32x32x16_bf16 v[96:111], v[132:135], v[56:59], 0
    s_waitcnt vmcnt(12)
    v_cvt_pk_bf16_f32 v60, v32, v33
    v_exp_f32 v35, v35
    v_exp_f32 v36, v36
    v_cvt_pk_bf16_f32 v61, v34, v35
    v_exp_f32 v37, v37
    v_exp_f32 v38, v38
    v_exp_f32 v39, v39
    v_cvt_pk_bf16_f32 v62, v36, v37
    v_cvt_pk_bf16_f32 v63, v38, v39
    v_mfma_f32_32x32x16_bf16 v[24:39], v[140:143], v[8:11], 0
    v_exp_f32 v40, v40
    v_exp_f32 v41, v41
    v_exp_f32 v42, v42
    v_exp_f32 v43, v43
    v_cvt_pk_bf16_f32 v56, v40, v41
    v_exp_f32 v44, v44
    v_mfma_f32_32x32x16_bf16 v[96:111], v[136:139], v[60:63], v[96:111]
    v_exp_f32 v45, v45
    v_cvt_pk_bf16_f32 v57, v42, v43
    v_exp_f32 v46, v46
    v_exp_f32 v47, v47
    v_cvt_pk_bf16_f32 v58, v44, v45
    v_exp_f32 v48, v48
    v_cvt_pk_bf16_f32 v59, v46, v47
    v_exp_f32 v49, v49
    v_exp_f32 v50, v50
    v_mfma_f32_32x32x16_bf16 v[112:127], v[132:135], v[56:59], 0
    v_cvt_pk_bf16_f32 v60, v48, v49
    v_exp_f32 v51, v51
    v_exp_f32 v52, v52
    v_cvt_pk_bf16_f32 v61, v50, v51
    v_exp_f32 v53, v53
    v_exp_f32 v54, v54
    v_exp_f32 v55, v55
    v_cvt_pk_bf16_f32 v62, v52, v53
    v_cvt_pk_bf16_f32 v63, v54, v55
    v_mfma_f32_32x32x16_bf16 v[40:55], v[140:143], v[12:15], 0
    s_waitcnt vmcnt(10)
    v_exp_f32 v24, v24
    v_exp_f32 v25, v25
    v_exp_f32 v26, v26
    v_exp_f32 v27, v27
    v_cvt_pk_bf16_f32 v56, v24, v25
    v_exp_f32 v28, v28
    v_mfma_f32_32x32x16_bf16 v[112:127], v[136:139], v[60:63], v[112:127]
    v_exp_f32 v29, v29
    v_cvt_pk_bf16_f32 v57, v26, v27
    v_exp_f32 v30, v30
    v_exp_f32 v31, v31
    v_cvt_pk_bf16_f32 v58, v28, v29
    v_exp_f32 v32, v32
    v_cvt_pk_bf16_f32 v59, v30, v31
    v_exp_f32 v33, v33
    v_exp_f32 v34, v34
    v_mfma_f32_32x32x16_bf16 v[64:79], v[144:147], v[56:59], v[64:79]
    v_cvt_pk_bf16_f32 v60, v32, v33
    v_exp_f32 v35, v35
    v_exp_f32 v36, v36
    v_cvt_pk_bf16_f32 v61, v34, v35
    v_exp_f32 v37, v37
    v_exp_f32 v38, v38
    v_exp_f32 v39, v39
    v_cvt_pk_bf16_f32 v62, v36, v37
    v_cvt_pk_bf16_f32 v63, v38, v39
    v_mfma_f32_32x32x16_bf16 v[24:39], v[140:143], v[16:19], 0
    v_exp_f32 v40, v40
    v_exp_f32 v41, v41
    v_exp_f32 v42, v42
    v_exp_f32 v43, v43
    v_cvt_pk_bf16_f32 v56, v40, v41
    v_exp_f32 v44, v44
    v_mfma_f32_32x32x16_bf16 v[64:79], v[148:151], v[60:63], v[64:79]
    v_exp_f32 v45, v45
    v_cvt_pk_bf16_f32 v57, v42, v43
    v_exp_f32 v46, v46
    v_exp_f32 v47, v47
    v_cvt_pk_bf16_f32 v58, v44, v45
    v_exp_f32 v48, v48
    v_cvt_pk_bf16_f32 v59, v46, v47
    v_exp_f32 v49, v49
    v_exp_f32 v50, v50
    v_mfma_f32_32x32x16_bf16 v[80:95], v[144:147], v[56:59], v[80:95]
    v_cvt_pk_bf16_f32 v60, v48, v49
    v_exp_f32 v51, v51
    v_exp_f32 v52, v52
    v_cvt_pk_bf16_f32 v61, v50, v51
    v_exp_f32 v53, v53
    v_exp_f32 v54, v54
    v_exp_f32 v55, v55
    v_cvt_pk_bf16_f32 v62, v52, v53
    v_cvt_pk_bf16_f32 v63, v54, v55
    v_mfma_f32_32x32x16_bf16 v[40:55], v[140:143], v[20:23], 0
    v_exp_f32 v24, v24
    v_exp_f32 v25, v25
    v_exp_f32 v26, v26
    v_exp_f32 v27, v27
    v_cvt_pk_bf16_f32 v56, v24, v25
    v_exp_f32 v28, v28
    v_mfma_f32_32x32x16_bf16 v[80:95], v[148:151], v[60:63], v[80:95]
    v_exp_f32 v29, v29
    v_cvt_pk_bf16_f32 v57, v26, v27
    v_exp_f32 v30, v30
    v_exp_f32 v31, v31
    v_cvt_pk_bf16_f32 v58, v28, v29
    v_exp_f32 v32, v32
    v_cvt_pk_bf16_f32 v59, v30, v31
    v_exp_f32 v33, v33
    v_exp_f32 v34, v34
    v_mfma_f32_32x32x16_bf16 v[96:111], v[144:147], v[56:59], v[96:111]
    s_waitcnt vmcnt(9)
    v_cvt_pk_bf16_f32 v60, v32, v33
    v_exp_f32 v35, v35
    v_exp_f32 v36, v36
    v_cvt_pk_bf16_f32 v61, v34, v35
    v_exp_f32 v37, v37
    v_exp_f32 v38, v38
    v_exp_f32 v39, v39
    v_cvt_pk_bf16_f32 v62, v36, v37
    v_cvt_pk_bf16_f32 v63, v38, v39
    v_mfma_f32_32x32x16_bf16 v[24:39], v[160:163], v[8:11], 0
    v_exp_f32 v40, v40
    v_exp_f32 v41, v41
    v_exp_f32 v42, v42
    v_exp_f32 v43, v43
    v_cvt_pk_bf16_f32 v56, v40, v41
    v_exp_f32 v44, v44
    v_mfma_f32_32x32x16_bf16 v[96:111], v[148:151], v[60:63], v[96:111]
    v_exp_f32 v45, v45
    v_cvt_pk_bf16_f32 v57, v42, v43
    v_exp_f32 v46, v46
    v_exp_f32 v47, v47
    v_cvt_pk_bf16_f32 v58, v44, v45
    v_exp_f32 v48, v48
    v_cvt_pk_bf16_f32 v59, v46, v47
    v_exp_f32 v49, v49
    v_exp_f32 v50, v50
    v_mfma_f32_32x32x16_bf16 v[112:127], v[144:147], v[56:59], v[112:127]
    v_cvt_pk_bf16_f32 v60, v48, v49
    v_exp_f32 v51, v51
    v_exp_f32 v52, v52
    v_cvt_pk_bf16_f32 v61, v50, v51
    v_exp_f32 v53, v53
    v_exp_f32 v54, v54
    v_exp_f32 v55, v55
    v_cvt_pk_bf16_f32 v62, v52, v53
    v_cvt_pk_bf16_f32 v63, v54, v55
    v_mfma_f32_32x32x16_bf16 v[40:55], v[160:163], v[12:15], 0
    s_waitcnt vmcnt(7)
    v_exp_f32 v24, v24
    v_exp_f32 v25, v25
    v_exp_f32 v26, v26
    v_exp_f32 v27, v27
    v_cvt_pk_bf16_f32 v56, v24, v25
    v_exp_f32 v28, v28
    v_mfma_f32_32x32x16_bf16 v[112:127], v[148:151], v[60:63], v[112:127]
    v_exp_f32 v29, v29
    v_cvt_pk_bf16_f32 v57, v26, v27
    v_exp_f32 v30, v30
    v_exp_f32 v31, v31
    v_cvt_pk_bf16_f32 v58, v28, v29
    v_exp_f32 v32, v32
    v_cvt_pk_bf16_f32 v59, v30, v31
    v_exp_f32 v33, v33
    v_exp_f32 v34, v34
    v_mfma_f32_32x32x16_bf16 v[64:79], v[164:167], v[56:59], v[64:79]
    s_buffer_load_dwordx8 s[80:87], s[4:7], s69
    v_cvt_pk_bf16_f32 v60, v32, v33
    v_exp_f32 v35, v35
    v_exp_f32 v36, v36
    v_cvt_pk_bf16_f32 v61, v34, v35
    v_exp_f32 v37, v37
    v_exp_f32 v38, v38
    v_exp_f32 v39, v39
    v_cvt_pk_bf16_f32 v62, v36, v37
    v_cvt_pk_bf16_f32 v63, v38, v39
    v_mfma_f32_32x32x16_bf16 v[24:39], v[160:163], v[16:19], 0
    s_add_u32 s30, s30, 4096
    v_exp_f32 v40, v40
    v_exp_f32 v41, v41
    v_exp_f32 v42, v42
    v_exp_f32 v43, v43
    v_cvt_pk_bf16_f32 v56, v40, v41
    v_exp_f32 v44, v44
    v_mfma_f32_32x32x16_bf16 v[64:79], v[168:171], v[60:63], v[64:79]
    v_exp_f32 v45, v45
    v_cvt_pk_bf16_f32 v57, v42, v43
    v_exp_f32 v46, v46
    v_exp_f32 v47, v47
    v_cvt_pk_bf16_f32 v58, v44, v45
    v_exp_f32 v48, v48
    v_cvt_pk_bf16_f32 v59, v46, v47
    v_exp_f32 v49, v49
    v_exp_f32 v50, v50
    v_mfma_f32_32x32x16_bf16 v[80:95], v[164:167], v[56:59], v[80:95]
    s_and_b32 s30, s30, 0x1ffff
    v_cvt_pk_bf16_f32 v60, v48, v49
    v_exp_f32 v51, v51
    v_exp_f32 v52, v52
    v_cvt_pk_bf16_f32 v61, v50, v51
    v_exp_f32 v53, v53
    v_exp_f32 v54, v54
    v_exp_f32 v55, v55
    v_cvt_pk_bf16_f32 v62, v52, v53
    v_cvt_pk_bf16_f32 v63, v54, v55
    v_mfma_f32_32x32x16_bf16 v[40:55], v[160:163], v[20:23], 0
    s_add_u32 s32, s30, s31
    v_exp_f32 v24, v24
    v_exp_f32 v25, v25
    v_exp_f32 v26, v26
    v_exp_f32 v27, v27
    v_cvt_pk_bf16_f32 v56, v24, v25
    v_exp_f32 v28, v28
    v_mfma_f32_32x32x16_bf16 v[80:95], v[168:171], v[60:63], v[80:95]
    s_addc_u32 s33, s38, 0
    v_exp_f32 v29, v29
    v_cvt_pk_bf16_f32 v57, v26, v27
    v_exp_f32 v30, v30
    v_exp_f32 v31, v31
    v_cvt_pk_bf16_f32 v58, v28, v29
    v_exp_f32 v32, v32
    v_cvt_pk_bf16_f32 v59, v30, v31
    v_exp_f32 v33, v33
    v_exp_f32 v34, v34
    v_mfma_f32_32x32x16_bf16 v[96:111], v[164:167], v[56:59], v[96:111]
    s_waitcnt vmcnt(6)
    v_cvt_pk_bf16_f32 v60, v32, v33
    v_exp_f32 v35, v35
    v_exp_f32 v36, v36
    v_cvt_pk_bf16_f32 v61, v34, v35
    v_exp_f32 v37, v37
    v_exp_f32 v38, v38
    v_exp_f32 v39, v39
    v_cvt_pk_bf16_f32 v62, v36, v37
    v_cvt_pk_bf16_f32 v63, v38, v39
    v_mfma_f32_32x32x16_bf16 v[24:39], v[172:175], v[8:11], 0
    v_exp_f32 v40, v40
    v_exp_f32 v41, v41
    v_exp_f32 v42, v42
    v_exp_f32 v43, v43
    v_cvt_pk_bf16_f32 v56, v40, v41
    v_exp_f32 v44, v44
    v_mfma_f32_32x32x16_bf16 v[96:111], v[168:171], v[60:63], v[96:111]
    v_exp_f32 v45, v45
    v_cvt_pk_bf16_f32 v57, v42, v43
    v_exp_f32 v46, v46
    v_exp_f32 v47, v47
    v_cvt_pk_bf16_f32 v58, v44, v45
    v_exp_f32 v48, v48
    v_cvt_pk_bf16_f32 v59, v46, v47
    v_exp_f32 v49, v49
    v_exp_f32 v50, v50
    v_mfma_f32_32x32x16_bf16 v[112:127], v[164:167], v[56:59], v[112:127]
    s_waitcnt lgkmcnt(0)
    s_and_b64 s[24:25], s[80:81], s[82:83]
    s_and_b64 s[26:27], s[84:85], s[86:87]
    s_and_b64 s[24:25], s[24:25], s[26:27]
    s_or_b64 s[80:81], s[80:81], s[82:83]
    s_or_b64 s[84:85], s[84:85], s[86:87]
    s_or_b64 s[80:81], s[80:81], s[84:85]
    s_and_b32 s24, s24, s25
    s_or_b32 s25, s80, s81
    s_mov_b32 s26, s43
    s_mov_b32 s27, s43
    s_cmp_eq_u64 s[24:25], s[26:27]
    s_cbranch_scc0 XG0_SLOW
XG0_OK:
    v_cvt_pk_bf16_f32 v60, v48, v49
    v_exp_f32 v51, v51
    v_exp_f32 v52, v52
    v_cvt_pk_bf16_f32 v61, v50, v51
    v_exp_f32 v53, v53
    v_exp_f32 v54, v54
    v_exp_f32 v55, v55
    v_cvt_pk_bf16_f32 v62, v52, v53
    v_cvt_pk_bf16_f32 v63, v54, v55
    v_mfma_f32_32x32x16_bf16 v[40:55], v[172:175], v[12:15], 0
    s_waitcnt vmcnt(4)
    v_exp_f32 v24, v24
    v_exp_f32 v25, v25
    v_exp_f32 v26, v26
    v_exp_f32 v27, v27
    v_cvt_pk_bf16_f32 v56, v24, v25
    v_exp_f32 v28, v28
    v_mfma_f32_32x32x16_bf16 v[112:127], v[168:171], v[60:63], v[112:127]
    global_load_dwordx4 v[128:131], v1, s[32:33]
    s_mov_b64 exec, s[20:21]
    global_load_dwordx4 v[132:135], v7, s[32:33] offset:1024
    global_load_dwordx4 v[136:139], v7, s[32:33] offset:1536
    s_mov_b64 exec, -1
    v_lshlrev_b32 v5, 3, v1
    v_exp_f32 v29, v29
    v_cvt_pk_bf16_f32 v57, v26, v27
    v_exp_f32 v30, v30
    v_exp_f32 v31, v31
    v_cvt_pk_bf16_f32 v58, v28, v29
    v_exp_f32 v32, v32
    v_cvt_pk_bf16_f32 v59, v30, v31
    v_exp_f32 v33, v33
    v_exp_f32 v34, v34
    v_mfma_f32_32x32x16_bf16 v[64:79], v[176:179], v[56:59], v[64:79]
    buffer_load_dword v5, v5, s[4:7], s99 offen
    v_cvt_pk_bf16_f32 v60, v32, v33
    v_exp_f32 v35, v35
    v_exp_f32 v36, v36
    v_cvt_pk_bf16_f32 v61, v34, v35
    v_exp_f32 v37, v37
    v_exp_f32 v38, v38
    v_exp_f32 v39, v39
    v_cvt_pk_bf16_f32 v62, v36, v37
    v_cvt_pk_bf16_f32 v63, v38, v39
    v_mfma_f32_32x32x16_bf16 v[24:39], v[172:175], v[16:19], 0
    s_add_u32 s30, s30, 4096
    v_exp_f32 v40, v40
    v_exp_f32 v41, v41
    v_exp_f32 v42, v42
    v_exp_f32 v43, v43
    v_cvt_pk_bf16_f32 v56, v40, v41
    v_exp_f32 v44, v44
    v_mfma_f32_32x32x16_bf16 v[64:79], v[180:183], v[60:63], v[64:79]
    v_exp_f32 v45, v45
    v_cvt_pk_bf16_f32 v57, v42, v43
    v_exp_f32 v46, v46
    v_exp_f32 v47, v47
    v_cvt_pk_bf16_f32 v58, v44, v45
    v_exp_f32 v48, v48
    v_cvt_pk_bf16_f32 v59, v46, v47
    v_exp_f32 v49, v49
    v_exp_f32 v50, v50
    v_mfma_f32_32x32x16_bf16 v[80:95], v[176:179], v[56:59], v[80:95]
    s_and_b32 s30, s30, 0x1ffff
    v_cvt_pk_bf16_f32 v60, v48, v49
    v_exp_f32 v51, v51
    v_exp_f32 v52, v52
    v_cvt_pk_bf16_f32 v61, v50, v51
    v_exp_f32 v53, v53
    v_exp_f32 v54, v54
    v_exp_f32 v55, v55
    v_cvt_pk_bf16_f32 v62, v52, v53
    v_cvt_pk_bf16_f32 v63, v54, v55
    v_mfma_f32_32x32x16_bf16 v[40:55], v[172:175], v[20:23], 0
    s_add_u32 s32, s30, s31
    v_exp_f32 v24, v24
    v_exp_f32 v25, v25
    v_exp_f32 v26, v26
    v_exp_f32 v27, v27
    v_cvt_pk_bf16_f32 v56, v24, v25
    v_exp_f32 v28, v28
    v_mfma_f32_32x32x16_bf16 v[80:95], v[180:183], v[60:63], v[80:95]
    s_addc_u32 s33, s38, 0
    v_exp_f32 v29, v29
    v_cvt_pk_bf16_f32 v57, v26, v27
    v_exp_f32 v30, v30
    v_exp_f32 v31, v31
    v_cvt_pk_bf16_f32 v58, v28, v29
    v_exp_f32 v32, v32
    v_cvt_pk_bf16_f32 v59, v30, v31
    v_exp_f32 v33, v33
    v_exp_f32 v34, v34
    v_mfma_f32_32x32x16_bf16 v[96:111], v[176:179], v[56:59], v[96:111]
    s_waitcnt vmcnt(3)
    v_cvt_pk_bf16_f32 v60, v32, v33
    v_exp_f32 v35, v35
    v_exp_f32 v36, v36
    v_cvt_pk_bf16_f32 v61, v34, v35
    v_exp_f32 v37, v37
    v_exp_f32 v38, v38
    v_exp_f32 v39, v39
    v_cvt_pk_bf16_f32 v62, v36, v37
    v_cvt_pk_bf16_f32 v63, v38, v39
    v_mfma_f32_32x32x16_bf16 v[24:39], v[128:131], v[8:11], 0
    global_load_dwordx4 v[140:143], v1, s[32:33]
    v_exp_f32 v40, v40
    v_exp_f32 v41, v41
    v_exp_f32 v42, v42
    v_exp_f32 v43, v43
    v_cvt_pk_bf16_f32 v56, v40, v41
    v_exp_f32 v44, v44
    v_mfma_f32_32x32x16_bf16 v[96:111], v[180:183], v[60:63], v[96:111]
    ds_read_b64_tr_b16 v[184:185], v233
    ds_read_b64_tr_b16 v[186:187], v234
    ds_read_b64_tr_b16 v[188:189], v235
    ds_read_b64_tr_b16 v[190:191], v236
    v_exp_f32 v45, v45
    v_cvt_pk_bf16_f32 v57, v42, v43
    v_exp_f32 v46, v46
    v_exp_f32 v47, v47
    v_cvt_pk_bf16_f32 v58, v44, v45
    v_exp_f32 v48, v48
    v_cvt_pk_bf16_f32 v59, v46, v47
    v_exp_f32 v49, v49
    v_exp_f32 v50, v50
    v_mfma_f32_32x32x16_bf16 v[112:127], v[176:179], v[56:59], v[112:127]
    ds_read_b64_tr_b16 v[192:193], v237
    ds_read_b64_tr_b16 v[194:195], v238
    ds_read_b64_tr_b16 v[196:197], v239
    ds_read_b64_tr_b16 v[198:199], v240
    v_cvt_pk_bf16_f32 v60, v48, v49
    v_exp_f32 v51, v51
    v_exp_f32 v52, v52
    v_cvt_pk_bf16_f32 v61, v50, v51
    v_exp_f32 v53, v53
    v_exp_f32 v54, v54
    v_exp_f32 v55, v55
    v_cvt_pk_bf16_f32 v62, v52, v53
    v_cvt_pk_bf16_f32 v63, v54, v55
    v_mfma_f32_32x32x16_bf16 v[40:55], v[128:131], v[12:15], 0
    s_waitcnt vmcnt(2)
    v_exp_f32 v24, v24
    v_exp_f32 v25, v25
    v_exp_f32 v26, v26
    v_exp_f32 v27, v27
    v_cvt_pk_bf16_f32 v56, v24, v25
    v_exp_f32 v28, v28
    v_mfma_f32_32x32x16_bf16 v[112:127], v[180:183], v[60:63], v[112:127]
    s_mov_b64 exec, s[20:21]
    global_load_dwordx4 v[144:147], v7, s[32:33] offset:1024
    global_load_dwordx4 v[148:151], v7, s[32:33] offset:1536
    s_mov_b64 exec, -1
    v_exp_f32 v29, v29
    v_cvt_pk_bf16_f32 v57, v26, v27
    v_exp_f32 v30, v30
    v_exp_f32 v31, v31
    v_cvt_pk_bf16_f32 v58, v28, v29
    v_exp_f32 v32, v32
    v_cvt_pk_bf16_f32 v59, v30, v31
    v_exp_f32 v33, v33
    v_exp_f32 v34, v34
    v_mfma_f32_32x32x16_bf16 v[64:79], v[132:135], v[56:59], v[64:79]
    s_waitcnt lgkmcnt(0)
    s_and_b32 s24, s101, 15
    s_mul_i32 s24, s24, s100
    s_add_u32 s24, s24, s95
    s_add_u32 s101, s101, 1
    buffer_store_dwordx4 v[184:187], v1, s[4:7], s24 offen sc1
    v_cvt_pk_bf16_f32 v60, v32, v33
    v_exp_f32 v35, v35
    v_exp_f32 v36, v36
    v_cvt_pk_bf16_f32 v61, v34, v35
    v_exp_f32 v37, v37
    v_exp_f32 v38, v38
    v_exp_f32 v39, v39
    v_cvt_pk_bf16_f32 v62, v36, v37
    v_cvt_pk_bf16_f32 v63, v38, v39
    v_mfma_f32_32x32x16_bf16 v[24:39], v[128:131], v[16:19], 0
    s_add_u32 s30, s30, 4096
    v_exp_f32 v40, v40
    v_exp_f32 v41, v41
    v_exp_f32 v42, v42
    v_exp_f32 v43, v43
    v_cvt_pk_bf16_f32 v56, v40, v41
    v_exp_f32 v44, v44
    v_mfma_f32_32x32x16_bf16 v[64:79], v[136:139], v[60:63], v[64:79]
    v_exp_f32 v45, v45
    v_cvt_pk_bf16_f32 v57, v42, v43
    v_exp_f32 v46, v46
    v_exp_f32 v47, v47
    v_cvt_pk_bf16_f32 v58, v44, v45
    v_exp_f32 v48, v48
    v_cvt_pk_bf16_f32 v59, v46, v47
    v_exp_f32 v49, v49
    v_exp_f32 v50, v50
    v_mfma_f32_32x32x16_bf16 v[80:95], v[132:135], v[56:59], v[80:95]
    s_and_b32 s30, s30, 0x1ffff
    s_and_b32 s24, s101, 15
    s_mul_i32 s24, s24, s100
    s_add_u32 s24, s24, s95
    s_add_u32 s101, s101, 1
    buffer_store_dwordx4 v[188:191], v1, s[4:7], s24 offen sc1
    v_cvt_pk_bf16_f32 v60, v48, v49
    v_exp_f32 v51, v51
    v_exp_f32 v52, v52
    v_cvt_pk_bf16_f32 v61, v50, v51
    v_exp_f32 v53, v53
    v_exp_f32 v54, v54
    v_exp_f32 v55, v55
    v_cvt_pk_bf16_f32 v62, v52, v53
    v_cvt_pk_bf16_f32 v63, v54, v55
    v_mfma_f32_32x32x16_bf16 v[40:55], v[128:131], v[20:23], 0
    s_add_u32 s32, s30, s31
    v_exp_f32 v24, v24
    v_exp_f32 v25, v25
    v_exp_f32 v26, v26
    v_exp_f32 v27, v27
    v_cvt_pk_bf16_f32 v56, v24, v25
    v_exp_f32 v28, v28
    v_mfma_f32_32x32x16_bf16 v[80:95], v[136:139], v[60:63], v[80:95]
    s_addc_u32 s33, s38, 0
    v_exp_f32 v29, v29
    v_cvt_pk_bf16_f32 v57, v26, v27
    v_exp_f32 v30, v30
    v_exp_f32 v31, v31
    v_cvt_pk_bf16_f32 v58, v28, v29
    v_exp_f32 v32, v32
    v_cvt_pk_bf16_f32 v59, v30, v31
    v_exp_f32 v33, v33
    v_exp_f32 v34, v34
    v_mfma_f32_32x32x16_bf16 v[96:111], v[132:135], v[56:59], v[96:111]
    s_waitcnt vmcnt(4)
    s_and_b32 s24, s101, 15
    s_mul_i32 s24, s24, s100
    s_add_u32 s24, s24, s95
    s_add_u32 s101, s101, 1
    buffer_store_dwordx4 v[192:195], v1, s[4:7], s24 offen sc1
    v_cvt_pk_bf16_f32 v60, v32, v33
    v_exp_f32 v35, v35
    v_exp_f32 v36, v36
    v_cvt_pk_bf16_f32 v61, v34, v35
    v_exp_f32 v37, v37
    v_exp_f32 v38, v38
    v_exp_f32 v39, v39
    v_cvt_pk_bf16_f32 v62, v36, v37
    v_cvt_pk_bf16_f32 v63, v38, v39
    v_mfma_f32_32x32x16_bf16 v[24:39], v[140:143], v[8:11], 0
    global_load_dwordx4 v[128:131], v1, s[32:33]
    v_exp_f32 v40, v40
    v_exp_f32 v41, v41
    v_exp_f32 v42, v42
    v_exp_f32 v43, v43
    v_cvt_pk_bf16_f32 v56, v40, v41
    v_exp_f32 v44, v44
    v_mfma_f32_32x32x16_bf16 v[96:111], v[136:139], v[60:63], v[96:111]
    v_exp_f32 v45, v45
    v_cvt_pk_bf16_f32 v57, v42, v43
    v_exp_f32 v46, v46
    v_exp_f32 v47, v47
    v_cvt_pk_bf16_f32 v58, v44, v45
    v_exp_f32 v48, v48
    v_cvt_pk_bf16_f32 v59, v46, v47
    v_exp_f32 v49, v49
    v_exp_f32 v50, v50
    v_mfma_f32_32x32x16_bf16 v[112:127], v[132:135], v[56:59], v[112:127]
    s_and_b32 s24, s101, 15
    s_mul_i32 s24, s24, s100
    s_add_u32 s24, s24, s95
    s_add_u32 s101, s101, 1
    buffer_store_dwordx4 v[196:199], v1, s[4:7], s24 offen sc1
    v_cvt_pk_bf16_f32 v60, v48, v49
    v_exp_f32 v51, v51
    v_exp_f32 v52, v52
    v_cvt_pk_bf16_f32 v61, v50, v51
    v_exp_f32 v53, v53
    v_exp_f32 v54, v54
    v_exp_f32 v55, v55
    v_cvt_pk_bf16_f32 v62, v52, v53
    v_cvt_pk_bf16_f32 v63, v54, v55
    v_mfma_f32_32x32x16_bf16 v[40:55], v[140:143], v[12:15], 0
    s_waitcnt vmcnt(5)
    v_exp_f32 v24, v24
    v_exp_f32 v25, v25
    v_exp_f32 v26, v26
    v_exp_f32 v27, v27
    v_cvt_pk_bf16_f32 v56, v24, v25
    v_exp_f32 v28, v28
    v_mfma_f32_32x32x16_bf16 v[112:127], v[136:139], v[60:63], v[112:127]
    s_mov_b64 exec, s[20:21]
    global_load_dwordx4 v[132:135], v7, s[32:33] offset:1024
    global_load_dwordx4 v[136:139], v7, s[32:33] offset:1536
    s_mov_b64 exec, -1
    v_exp_f32 v29, v29
    v_cvt_pk_bf16_f32 v57, v26, v27
    v_exp_f32 v30, v30
    v_exp_f32 v31, v31
    v_cvt_pk_bf16_f32 v58, v28, v29
    v_exp_f32 v32, v32
    v_cvt_pk_bf16_f32 v59, v30, v31
    v_exp_f32 v33, v33
    v_exp_f32 v34, v34
    v_mfma_f32_32x32x16_bf16 v[64:79], v[144:147], v[56:59], v[64:79]
    v_cvt_pk_bf16_f32 v60, v32, v33
    v_exp_f32 v35, v35
    v_exp_f32 v36, v36
    v_cvt_pk_bf16_f32 v61, v34, v35
    v_exp_f32 v37, v37
    v_exp_f32 v38, v38
    v_exp_f32 v39, v39
    v_cvt_pk_bf16_f32 v62, v36, v37
    v_cvt_pk_bf16_f32 v63, v38, v39
    v_mfma_f32_32x32x16_bf16 v[24:39], v[140:143], v[16:19], 0
    s_add_u32 s30, s30, 4096
    v_exp_f32 v40, v40
    v_exp_f32 v41, v41
    v_exp_f32 v42, v42
    v_exp_f32 v43, v43
    v_cvt_pk_bf16_f32 v56, v40, v41
    v_exp_f32 v44, v44
    v_mfma_f32_32x32x16_bf16 v[64:79], v[148:151], v[60:63], v[64:79]
    v_exp_f32 v45, v45
    v_cvt_pk_bf16_f32 v57, v42, v43
    v_exp_f32 v46, v46
    v_exp_f32 v47, v47
    v_cvt_pk_bf16_f32 v58, v44, v45
    v_exp_f32 v48, v48
    v_cvt_pk_bf16_f32 v59, v46, v47
    v_exp_f32 v49, v49
    v_exp_f32 v50, v50
    v_mfma_f32_32x32x16_bf16 v[80:95], v[144:147], v[56:59], v[80:95]
    s_and_b32 s30, s30, 0x1ffff
    v_cvt_pk_bf16_f32 v60, v48, v49
    v_exp_f32 v51, v51
    v_exp_f32 v52, v52
    v_cvt_pk_bf16_f32 v61, v50, v51
    v_exp_f32 v53, v53
    v_exp_f32 v54, v54
    v_exp_f32 v55, v55
    v_cvt_pk_bf16_f32 v62, v52, v53
    v_cvt_pk_bf16_f32 v63, v54, v55
    v_mfma_f32_32x32x16_bf16 v[40:55], v[140:143], v[20:23], 0
    s_add_u32 s32, s30, s31
    v_exp_f32 v24, v24
    v_exp_f32 v25, v25
    v_exp_f32 v26, v26
    v_exp_f32 v27, v27
    v_cvt_pk_bf16_f32 v56, v24, v25
    v_exp_f32 v28, v28
    v_mfma_f32_32x32x16_bf16 v[80:95], v[148:151], v[60:63], v[80:95]
    s_addc_u32 s33, s38, 0
    v_exp_f32 v29, v29
    v_cvt_pk_bf16_f32 v57, v26, v27
    v_exp_f32 v30, v30
    v_exp_f32 v31, v31
    v_cvt_pk_bf16_f32 v58, v28, v29
    v_exp_f32 v32, v32
    v_cvt_pk_bf16_f32 v59, v30, v31
    v_exp_f32 v33, v33
    v_exp_f32 v34, v34
    v_mfma_f32_32x32x16_bf16 v[96:111], v[144:147], v[56:59], v[96:111]
    s_waitcnt vmcnt(3)
    v_cvt_pk_bf16_f32 v60, v32, v33
    v_exp_f32 v35, v35
    v_exp_f32 v36, v36
    v_cvt_pk_bf16_f32 v61, v34, v35
    v_exp_f32 v37, v37
    v_exp_f32 v38, v38
    v_exp_f32 v39, v39
    v_cvt_pk_bf16_f32 v62, v36, v37
    v_cvt_pk_bf16_f32 v63, v38, v39
    v_mfma_f32_32x32x16_bf16 v[24:39], v[128:131], v[8:11], 0
    global_load_dwordx4 v[140:143], v1, s[32:33]
    v_exp_f32 v40, v40
    v_exp_f32 v41, v41
    v_exp_f32 v42, v42
    v_exp_f32 v43, v43
    v_cvt_pk_bf16_f32 v56, v40, v41
    v_exp_f32 v44, v44
    v_mfma_f32_32x32x16_bf16 v[96:111], v[148:151], v[60:63], v[96:111]
    v_exp_f32 v45, v45
    v_cvt_pk_bf16_f32 v57, v42, v43
    v_exp_f32 v46, v46
    v_exp_f32 v47, v47
    v_cvt_pk_bf16_f32 v58, v44, v45
    v_exp_f32 v48, v48
    v_cvt_pk_bf16_f32 v59, v46, v47
    v_exp_f32 v49, v49
    v_exp_f32 v50, v50
    v_mfma_f32_32x32x16_bf16 v[112:127], v[144:147], v[56:59], v[112:127]
    v_cvt_pk_bf16_f32 v60, v48, v49
    v_exp_f32 v51, v51
    v_exp_f32 v52, v52
    v_cvt_pk_bf16_f32 v61, v50, v51
    v_exp_f32 v53, v53
    v_exp_f32 v54, v54
    v_exp_f32 v55, v55
    v_cvt_pk_bf16_f32 v62, v52, v53
    v_cvt_pk_bf16_f32 v63, v54, v55
    v_mfma_f32_32x32x16_bf16 v[40:55], v[128:131], v[12:15], 0
    s_waitcnt vmcnt(1)
    v_exp_f32 v24, v24
    v_exp_f32 v25, v25
    v_exp_f32 v26, v26
    v_exp_f32 v27, v27
    v_cvt_pk_bf16_f32 v56, v24, v25
    v_exp_f32 v28, v28
    v_mfma_f32_32x32x16_bf16 v[112:127], v[148:151], v[60:63], v[112:127]
    s_mov_b64 exec, s[20:21]
    global_load_dwordx4 v[144:147], v7, s[32:33] offset:1024
    global_load_dwordx4 v[148:151], v7, s[32:33] offset:1536
    s_mov_b64 exec, -1
    v_exp_f32 v29, v29
    v_cvt_pk_bf16_f32 v57, v26, v27
    v_exp_f32 v30, v30
    v_exp_f32 v31, v31
    v_cvt_pk_bf16_f32 v58, v28, v29
    v_exp_f32 v32, v32
    v_cvt_pk_bf16_f32 v59, v30, v31
    v_exp_f32 v33, v33
    v_exp_f32 v34, v34
    v_mfma_f32_32x32x16_bf16 v[64:79], v[132:135], v[56:59], v[64:79]
    v_cvt_pk_bf16_f32 v60, v32, v33
    v_exp_f32 v35, v35
    v_exp_f32 v36, v36
    v_cvt_pk_bf16_f32 v61, v34, v35
    v_exp_f32 v37, v37
    v_exp_f32 v38, v38
    v_exp_f32 v39, v39
    v_cvt_pk_bf16_f32 v62, v36, v37
    v_cvt_pk_bf16_f32 v63, v38, v39
    v_mfma_f32_32x32x16_bf16 v[24:39], v[128:131], v[16:19], 0
    s_add_u32 s30, s30, 4096
    v_exp_f32 v40, v40
    v_exp_f32 v41, v41
    v_exp_f32 v42, v42
    v_exp_f32 v43, v43
    v_cvt_pk_bf16_f32 v56, v40, v41
    v_exp_f32 v44, v44
    v_mfma_f32_32x32x16_bf16 v[64:79], v[136:139], v[60:63], v[64:79]
    v_exp_f32 v45, v45
    v_cvt_pk_bf16_f32 v57, v42, v43
    v_exp_f32 v46, v46
    v_exp_f32 v47, v47
    v_cvt_pk_bf16_f32 v58, v44, v45
    v_exp_f32 v48, v48
    v_cvt_pk_bf16_f32 v59, v46, v47
    v_exp_f32 v49, v49
    v_exp_f32 v50, v50
    v_mfma_f32_32x32x16_bf16 v[80:95], v[132:135], v[56:59], v[80:95]
    s_and_b32 s30, s30, 0x1ffff
    v_cvt_pk_bf16_f32 v60, v48, v49
    v_exp_f32 v51, v51
    v_exp_f32 v52, v52
    v_cvt_pk_bf16_f32 v61, v50, v51
    v_exp_f32 v53, v53
    v_exp_f32 v54, v54
    v_exp_f32 v55, v55
    v_cvt_pk_bf16_f32 v62, v52, v53
    v_cvt_pk_bf16_f32 v63, v54, v55
    v_mfma_f32_32x32x16_bf16 v[40:55], v[128:131], v[20:23], 0
    s_add_u32 s32, s30, s31
    v_exp_f32 v24, v24
    v_exp_f32 v25, v25
    v_exp_f32 v26, v26
    v_exp_f32 v27, v27
    v_cvt_pk_bf16_f32 v56, v24, v25
    v_exp_f32 v28, v28
    v_mfma_f32_32x32x16_bf16 v[80:95], v[136:139], v[60:63], v[80:95]
    s_addc_u32 s33, s38, 0
    v_exp_f32 v29, v29
    v_cvt_pk_bf16_f32 v57, v26, v27
    v_exp_f32 v30, v30
    v_exp_f32 v31, v31
    v_cvt_pk_bf16_f32 v58, v28, v29
    v_exp_f32 v32, v32
    v_cvt_pk_bf16_f32 v59, v30, v31
    v_exp_f32 v33, v33
    v_exp_f32 v34, v34
    v_mfma_f32_32x32x16_bf16 v[96:111], v[132:135], v[56:59], v[96:111]
    s_waitcnt vmcnt(2)
    s_barrier
    s_cmp_lg_u32 s14, 0
    s_cbranch_scc1 PKF_SKIP
    s_mov_b64 exec, 1
    buffer_store_dword v157, off, s[4:7], s77 sc1
    s_mov_b64 exec, -1
PKF_SKIP:
    v_cvt_pk_bf16_f32 v60, v32, v33
    v_exp_f32 v35, v35
    v_exp_f32 v36, v36
    v_cvt_pk_bf16_f32 v61, v34, v35
    v_exp_f32 v37, v37
    v_exp_f32 v38, v38
    v_exp_f32 v39, v39
    v_cvt_pk_bf16_f32 v62, v36, v37
    v_cvt_pk_bf16_f32 v63, v38, v39
    v_mfma_f32_32x32x16_bf16 v[24:39], v[140:143], v[8:11], 0
    global_load_dwordx4 v[128:131], v1, s[32:33]
    v_exp_f32 v40, v40
    v_exp_f32 v41, v41
    v_exp_f32 v42, v42
    v_exp_f32 v43, v43
    v_cvt_pk_bf16_f32 v56, v40, v41
    v_exp_f32 v44, v44
    v_mfma_f32_32x32x16_bf16 v[96:111], v[136:139], v[60:63], v[96:111]
    v_exp_f32 v45, v45
    v_cvt_pk_bf16_f32 v57, v42, v43
    v_exp_f32 v46, v46
    v_exp_f32 v47, v47
    v_cvt_pk_bf16_f32 v58, v44, v45
    v_exp_f32 v48, v48
    v_cvt_pk_bf16_f32 v59, v46, v47
    v_exp_f32 v49, v49
    v_exp_f32 v50, v50
    v_mfma_f32_32x32x16_bf16 v[112:127], v[132:135], v[56:59], v[112:127]
    v_cvt_pk_bf16_f32 v60, v48, v49
    v_exp_f32 v51, v51
    v_exp_f32 v52, v52
    v_cvt_pk_bf16_f32 v61, v50, v51
    v_exp_f32 v53, v53
    v_exp_f32 v54, v54
    v_exp_f32 v55, v55
    v_cvt_pk_bf16_f32 v62, v52, v53
    v_cvt_pk_bf16_f32 v63, v54, v55
    v_mfma_f32_32x32x16_bf16 v[40:55], v[140:143], v[12:15], 0
    s_waitcnt vmcnt(1)
    v_exp_f32 v24, v24
    v_exp_f32 v25, v25
    v_exp_f32 v26, v26
    v_exp_f32 v27, v27
    v_cvt_pk_bf16_f32 v56, v24, v25
    v_exp_f32 v28, v28
    v_mfma_f32_32x32x16_bf16 v[112:127], v[136:139], v[60:63], v[112:127]
    s_mov_b64 exec, s[20:21]
    global_load_dwordx4 v[132:135], v7, s[32:33] offset:1024
    global_load_dwordx4 v[136:139], v7, s[32:33] offset:1536
    s_mov_b64 exec, -1
    v_exp_f32 v29, v29
    v_cvt_pk_bf16_f32 v57, v26, v27
    v_exp_f32 v30, v30
    v_exp_f32 v31, v31
    v_cvt_pk_bf16_f32 v58, v28, v29
    v_exp_f32 v32, v32
    v_cvt_pk_bf16_f32 v59, v30, v31
    v_exp_f32 v33, v33
    v_exp_f32 v34, v34
    v_mfma_f32_32x32x16_bf16 v[64:79], v[144:147], v[56:59], v[64:79]
    v_cvt_pk_bf16_f32 v60, v32, v33
    v_exp_f32 v35, v35
    v_exp_f32 v36, v36
    v_cvt_pk_bf16_f32 v61, v34, v35
    v_exp_f32 v37, v37
    v_exp_f32 v38, v38
    v_exp_f32 v39, v39
    v_cvt_pk_bf16_f32 v62, v36, v37
    v_cvt_pk_bf16_f32 v63, v38, v39
    v_mfma_f32_32x32x16_bf16 v[24:39], v[140:143], v[16:19], 0
    s_add_u32 s30, s30, 4096
    v_exp_f32 v40, v40
    v_exp_f32 v41, v41
    v_exp_f32 v42, v42
    v_exp_f32 v43, v43
    v_cvt_pk_bf16_f32 v56, v40, v41
    v_exp_f32 v44, v44
    v_mfma_f32_32x32x16_bf16 v[64:79], v[148:151], v[60:63], v[64:79]
    v_exp_f32 v45, v45
    v_cvt_pk_bf16_f32 v57, v42, v43
    v_exp_f32 v46, v46
    v_exp_f32 v47, v47
    v_cvt_pk_bf16_f32 v58, v44, v45
    v_exp_f32 v48, v48
    v_cvt_pk_bf16_f32 v59, v46, v47
    v_exp_f32 v49, v49
    v_exp_f32 v50, v50
    v_mfma_f32_32x32x16_bf16 v[80:95], v[144:147], v[56:59], v[80:95]
    s_and_b32 s30, s30, 0x1ffff
    v_cvt_pk_bf16_f32 v60, v48, v49
    v_exp_f32 v51, v51
    v_exp_f32 v52, v52
    v_cvt_pk_bf16_f32 v61, v50, v51
    v_exp_f32 v53, v53
    v_exp_f32 v54, v54
    v_exp_f32 v55, v55
    v_cvt_pk_bf16_f32 v62, v52, v53
    v_cvt_pk_bf16_f32 v63, v54, v55
    v_mfma_f32_32x32x16_bf16 v[40:55], v[140:143], v[20:23], 0
    s_add_u32 s32, s30, s31
    v_exp_f32 v24, v24
    v_exp_f32 v25, v25
    v_exp_f32 v26, v26
    v_exp_f32 v27, v27
    v_cvt_pk_bf16_f32 v56, v24, v25
    v_exp_f32 v28, v28
    v_mfma_f32_32x32x16_bf16 v[80:95], v[148:151], v[60:63], v[80:95]
    s_addc_u32 s33, s38, 0
    v_exp_f32 v29, v29
    v_cvt_pk_bf16_f32 v57, v26, v27
    v_exp_f32 v30, v30
    v_exp_f32 v31, v31
    v_cvt_pk_bf16_f32 v58, v28, v29
    v_exp_f32 v32, v32
    v_cvt_pk_bf16_f32 v59, v30, v31
    v_exp_f32 v33, v33
    v_exp_f32 v34, v34
    v_mfma_f32_32x32x16_bf16 v[96:111], v[144:147], v[56:59], v[96:111]
    s_waitcnt vmcnt(2)
    v_cvt_pk_bf16_f32 v60, v32, v33
    v_exp_f32 v35, v35
    v_exp_f32 v36, v36
    v_cvt_pk_bf16_f32 v61, v34, v35
    v_exp_f32 v37, v37
    v_exp_f32 v38, v38
    v_exp_f32 v39, v39
    v_cvt_pk_bf16_f32 v62, v36, v37
    v_cvt_pk_bf16_f32 v63, v38, v39
    v_mfma_f32_32x32x16_bf16 v[24:39], v[128:131], v[8:11], 0
    global_load_dwordx4 v[140:143], v1, s[32:33]
    v_exp_f32 v40, v40
    v_exp_f32 v41, v41
    v_exp_f32 v42, v42
    v_exp_f32 v43, v43
    v_cvt_pk_bf16_f32 v56, v40, v41
    v_exp_f32 v44, v44
    v_mfma_f32_32x32x16_bf16 v[96:111], v[148:151], v[60:63], v[96:111]
    v_exp_f32 v45, v45
    v_cvt_pk_bf16_f32 v57, v42, v43
    v_exp_f32 v46, v46
    v_exp_f32 v47, v47
    v_cvt_pk_bf16_f32 v58, v44, v45
    v_exp_f32 v48, v48
    v_cvt_pk_bf16_f32 v59, v46, v47
    v_exp_f32 v49, v49
    v_exp_f32 v50, v50
    v_mfma_f32_32x32x16_bf16 v[112:127], v[144:147], v[56:59], v[112:127]
    v_cvt_pk_bf16_f32 v60, v48, v49
    v_exp_f32 v51, v51
    v_exp_f32 v52, v52
    v_cvt_pk_bf16_f32 v61, v50, v51
    v_exp_f32 v53, v53
    v_exp_f32 v54, v54
    v_exp_f32 v55, v55
    v_cvt_pk_bf16_f32 v62, v52, v53
    v_cvt_pk_bf16_f32 v63, v54, v55
    v_mfma_f32_32x32x16_bf16 v[40:55], v[128:131], v[12:15], 0
    s_waitcnt vmcnt(1)
    v_exp_f32 v24, v24
    v_exp_f32 v25, v25
    v_exp_f32 v26, v26
    v_exp_f32 v27, v27
    v_cvt_pk_bf16_f32 v56, v24, v25
    v_exp_f32 v28, v28
    v_mfma_f32_32x32x16_bf16 v[112:127], v[148:151], v[60:63], v[112:127]
    s_mov_b64 exec, s[20:21]
    global_load_dwordx4 v[144:147], v7, s[32:33] offset:1024
    global_load_dwordx4 v[148:151], v7, s[32:33] offset:1536
    s_mov_b64 exec, -1
    v_exp_f32 v29, v29
    v_cvt_pk_bf16_f32 v57, v26, v27
    v_exp_f32 v30, v30
    v_exp_f32 v31, v31
    v_cvt_pk_bf16_f32 v58, v28, v29
    v_exp_f32 v32, v32
    v_cvt_pk_bf16_f32 v59, v30, v31
    v_exp_f32 v33, v33
    v_exp_f32 v34, v34
    v_mfma_f32_32x32x16_bf16 v[64:79], v[132:135], v[56:59], v[64:79]
    v_cvt_pk_bf16_f32 v60, v32, v33
    v_exp_f32 v35, v35
    v_exp_f32 v36, v36
    v_cvt_pk_bf16_f32 v61, v34, v35
    v_exp_f32 v37, v37
    v_exp_f32 v38, v38
    v_exp_f32 v39, v39
    v_cvt_pk_bf16_f32 v62, v36, v37
    v_cvt_pk_bf16_f32 v63, v38, v39
    v_mfma_f32_32x32x16_bf16 v[24:39], v[128:131], v[16:19], 0
    s_add_u32 s30, s30, 4096
    v_exp_f32 v40, v40
    v_exp_f32 v41, v41
    v_exp_f32 v42, v42
    v_exp_f32 v43, v43
    v_cvt_pk_bf16_f32 v56, v40, v41
    v_exp_f32 v44, v44
    v_mfma_f32_32x32x16_bf16 v[64:79], v[136:139], v[60:63], v[64:79]
    v_exp_f32 v45, v45
    v_cvt_pk_bf16_f32 v57, v42, v43
    v_exp_f32 v46, v46
    v_exp_f32 v47, v47
    v_cvt_pk_bf16_f32 v58, v44, v45
    v_exp_f32 v48, v48
    v_cvt_pk_bf16_f32 v59, v46, v47
    v_exp_f32 v49, v49
    v_exp_f32 v50, v50
    v_mfma_f32_32x32x16_bf16 v[80:95], v[132:135], v[56:59], v[80:95]
    s_and_b32 s30, s30, 0x1ffff
    v_cvt_pk_bf16_f32 v60, v48, v49
    v_exp_f32 v51, v51
    v_exp_f32 v52, v52
    v_cvt_pk_bf16_f32 v61, v50, v51
    v_exp_f32 v53, v53
    v_exp_f32 v54, v54
    v_exp_f32 v55, v55
    v_cvt_pk_bf16_f32 v62, v52, v53
    v_cvt_pk_bf16_f32 v63, v54, v55
    v_mfma_f32_32x32x16_bf16 v[40:55], v[128:131], v[20:23], 0
    s_add_u32 s32, s30, s31
    v_exp_f32 v24, v24
    v_exp_f32 v25, v25
    v_exp_f32 v26, v26
    v_exp_f32 v27, v27
    v_cvt_pk_bf16_f32 v56, v24, v25
    v_exp_f32 v28, v28
    v_mfma_f32_32x32x16_bf16 v[80:95], v[136:139], v[60:63], v[80:95]
    s_addc_u32 s33, s38, 0
    v_exp_f32 v29, v29
    v_cvt_pk_bf16_f32 v57, v26, v27
    v_exp_f32 v30, v30
    v_exp_f32 v31, v31
    v_cvt_pk_bf16_f32 v58, v28, v29
    v_exp_f32 v32, v32
    v_cvt_pk_bf16_f32 v59, v30, v31
    v_exp_f32 v33, v33
    v_exp_f32 v34, v34
    v_mfma_f32_32x32x16_bf16 v[96:111], v[132:135], v[56:59], v[96:111]
    s_waitcnt vmcnt(2)
    s_cmp_eq_u32 s14, 1
    s_cselect_b32 s27, 0, 25165824
    buffer_load_dwordx4 v[152:155], v156, s[4:7], s27 offen sc1
    v_cvt_pk_bf16_f32 v60, v32, v33
    v_exp_f32 v35, v35
    v_exp_f32 v36, v36
    v_cvt_pk_bf16_f32 v61, v34, v35
    v_exp_f32 v37, v37
    v_exp_f32 v38, v38
    v_exp_f32 v39, v39
    v_cvt_pk_bf16_f32 v62, v36, v37
    v_cvt_pk_bf16_f32 v63, v38, v39
    v_mfma_f32_32x32x16_bf16 v[24:39], v[140:143], v[8:11], 0
    global_load_dwordx4 v[128:131], v1, s[32:33]
    v_exp_f32 v40, v40
    v_exp_f32 v41, v41
    v_exp_f32 v42, v42
    v_exp_f32 v43, v43
    v_cvt_pk_bf16_f32 v56, v40, v41
    v_exp_f32 v44, v44
    v_mfma_f32_32x32x16_bf16 v[96:111], v[136:139], v[60:63], v[96:111]
    v_exp_f32 v45, v45
    v_cvt_pk_bf16_f32 v57, v42, v43
    v_exp_f32 v46, v46
    v_exp_f32 v47, v47
    v_cvt_pk_bf16_f32 v58, v44, v45
    v_exp_f32 v48, v48
    v_cvt_pk_bf16_f32 v59, v46, v47
    v_exp_f32 v49, v49
    v_exp_f32 v50, v50
    v_mfma_f32_32x32x16_bf16 v[112:127], v[132:135], v[56:59], v[112:127]
    v_cvt_pk_bf16_f32 v60, v48, v49
    v_exp_f32 v51, v51
    v_exp_f32 v52, v52
    v_cvt_pk_bf16_f32 v61, v50, v51
    v_exp_f32 v53, v53
    v_exp_f32 v54, v54
    v_exp_f32 v55, v55
    v_cvt_pk_bf16_f32 v62, v52, v53
    v_cvt_pk_bf16_f32 v63, v54, v55
    v_mfma_f32_32x32x16_bf16 v[40:55], v[140:143], v[12:15], 0
    s_waitcnt vmcnt(2)
    v_exp_f32 v24, v24
    v_exp_f32 v25, v25
    v_exp_f32 v26, v26
    v_exp_f32 v27, v27
    v_cvt_pk_bf16_f32 v56, v24, v25
    v_exp_f32 v28, v28
    v_mfma_f32_32x32x16_bf16 v[112:127], v[136:139], v[60:63], v[112:127]
    s_mov_b64 exec, s[20:21]
    global_load_dwordx4 v[132:135], v7, s[32:33] offset:1024
    global_load_dwordx4 v[136:139], v7, s[32:33] offset:1536
    s_mov_b64 exec, -1
    v_exp_f32 v29, v29
    v_cvt_pk_bf16_f32 v57, v26, v27
    v_exp_f32 v30, v30
    v_exp_f32 v31, v31
    v_cvt_pk_bf16_f32 v58, v28, v29
    v_exp_f32 v32, v32
    v_cvt_pk_bf16_f32 v59, v30, v31
    v_exp_f32 v33, v33
    v_exp_f32 v34, v34
    v_mfma_f32_32x32x16_bf16 v[64:79], v[144:147], v[56:59], v[64:79]
    v_cvt_pk_bf16_f32 v60, v32, v33
    v_exp_f32 v35, v35
    v_exp_f32 v36, v36
    v_cvt_pk_bf16_f32 v61, v34, v35
    v_exp_f32 v37, v37
    v_exp_f32 v38, v38
    v_exp_f32 v39, v39
    v_cvt_pk_bf16_f32 v62, v36, v37
    v_cvt_pk_bf16_f32 v63, v38, v39
    v_mfma_f32_32x32x16_bf16 v[24:39], v[140:143], v[16:19], 0
    s_add_u32 s30, s30, 4096
    v_exp_f32 v40, v40
    v_exp_f32 v41, v41
    v_exp_f32 v42, v42
    v_exp_f32 v43, v43
    v_cvt_pk_bf16_f32 v56, v40, v41
    v_exp_f32 v44, v44
    v_mfma_f32_32x32x16_bf16 v[64:79], v[148:151], v[60:63], v[64:79]
    v_exp_f32 v45, v45
    v_cvt_pk_bf16_f32 v57, v42, v43
    v_exp_f32 v46, v46
    v_exp_f32 v47, v47
    v_cvt_pk_bf16_f32 v58, v44, v45
    v_exp_f32 v48, v48
    v_cvt_pk_bf16_f32 v59, v46, v47
    v_exp_f32 v49, v49
    v_exp_f32 v50, v50
    v_mfma_f32_32x32x16_bf16 v[80:95], v[144:147], v[56:59], v[80:95]
    s_and_b32 s30, s30, 0x1ffff
    v_cvt_pk_bf16_f32 v60, v48, v49
    v_exp_f32 v51, v51
    v_exp_f32 v52, v52
    v_cvt_pk_bf16_f32 v61, v50, v51
    v_exp_f32 v53, v53
    v_exp_f32 v54, v54
    v_exp_f32 v55, v55
    v_cvt_pk_bf16_f32 v62, v52, v53
    v_cvt_pk_bf16_f32 v63, v54, v55
    v_mfma_f32_32x32x16_bf16 v[40:55], v[140:143], v[20:23], 0
    s_add_u32 s32, s30, s31
    v_exp_f32 v24, v24
    v_exp_f32 v25, v25
    v_exp_f32 v26, v26
    v_exp_f32 v27, v27
    v_cvt_pk_bf16_f32 v56, v24, v25
    v_exp_f32 v28, v28
    v_mfma_f32_32x32x16_bf16 v[80:95], v[148:151], v[60:63], v[80:95]
    s_addc_u32 s33, s38, 0
    v_exp_f32 v29, v29
    v_cvt_pk_bf16_f32 v57, v26, v27
    v_exp_f32 v30, v30
    v_exp_f32 v31, v31
    v_cvt_pk_bf16_f32 v58, v28, v29
    v_exp_f32 v32, v32
    v_cvt_pk_bf16_f32 v59, v30, v31
    v_exp_f32 v33, v33
    v_exp_f32 v34, v34
    v_mfma_f32_32x32x16_bf16 v[96:111], v[144:147], v[56:59], v[96:111]
    s_waitcnt vmcnt(2)
    s_cmp_lg_u32 s14, 1
    s_cbranch_scc1 PK_SKIP
    v_xor_b32 v152, s43, v152
    v_xor_b32 v153, s43, v153
    v_xor_b32 v154, s43, v154
    v_xor_b32 v155, s43, v155
    v_or3_b32 v152, v152, v153, v154
    v_or_b32 v152, v152, v155
    v_cmp_ne_u32 vcc, 0, v152
    s_nop 1
    s_cbranch_vccnz PK0_SLOW
PK0_OK:
PK_SKIP:
    s_barrier
    v_cvt_pk_bf16_f32 v60, v32, v33
    v_exp_f32 v35, v35
    v_exp_f32 v36, v36
    v_cvt_pk_bf16_f32 v61, v34, v35
    v_exp_f32 v37, v37
    v_exp_f32 v38, v38
    v_exp_f32 v39, v39
    v_cvt_pk_bf16_f32 v62, v36, v37
    v_cvt_pk_bf16_f32 v63, v38, v39
    v_mfma_f32_32x32x16_bf16 v[24:39], v[128:131], v[8:11], 0
    global_load_dwordx4 v[140:143], v1, s[32:33]
    v_exp_f32 v40, v40
    v_exp_f32 v41, v41
    v_exp_f32 v42, v42
    v_exp_f32 v43, v43
    v_cvt_pk_bf16_f32 v56, v40, v41
    v_exp_f32 v44, v44
    v_mfma_f32_32x32x16_bf16 v[96:111], v[148:151], v[60:63], v[96:111]
    s_add_u32 s34, s4, s72
    v_exp_f32 v45, v45
    v_cvt_pk_bf16_f32 v57, v42, v43
    v_exp_f32 v46, v46
    v_exp_f32 v47, v47
    v_cvt_pk_bf16_f32 v58, v44, v45
    v_exp_f32 v48, v48
    v_cvt_pk_bf16_f32 v59, v46, v47
    v_exp_f32 v49, v49
    v_exp_f32 v50, v50
    v_mfma_f32_32x32x16_bf16 v[112:127], v[144:147], v[56:59], v[112:127]
    s_addc_u32 s35, s5, 0
    v_cvt_pk_bf16_f32 v60, v48, v49
    v_exp_f32 v51, v51
    v_exp_f32 v52, v52
    v_cvt_pk_bf16_f32 v61, v50, v51
    v_exp_f32 v53, v53
    v_exp_f32 v54, v54
    v_exp_f32 v55, v55
    v_cvt_pk_bf16_f32 v62, v52, v53
    v_cvt_pk_bf16_f32 v63, v54, v55
    v_mfma_f32_32x32x16_bf16 v[40:55], v[128:131], v[12:15], 0
    s_waitcnt vmcnt(1)
    v_exp_f32 v24, v24
    v_exp_f32 v25, v25
    v_exp_f32 v26, v26
    v_exp_f32 v27, v27
    v_cvt_pk_bf16_f32 v56, v24, v25
    v_exp_f32 v28, v28
    v_mfma_f32_32x32x16_bf16 v[112:127], v[148:151], v[60:63], v[112:127]
    s_mov_b64 exec, s[20:21]
    global_load_dwordx4 v[144:147], v7, s[32:33] offset:1024
    global_load_dwordx4 v[148:151], v7, s[32:33] offset:1536
    s_mov_b64 exec, -1
    v_exp_f32 v29, v29
    v_cvt_pk_bf16_f32 v57, v26, v27
    v_exp_f32 v30, v30
    v_exp_f32 v31, v31
    v_cvt_pk_bf16_f32 v58, v28, v29
    v_exp_f32 v32, v32
    v_cvt_pk_bf16_f32 v59, v30, v31
    v_exp_f32 v33, v33
    v_exp_f32 v34, v34
    v_mfma_f32_32x32x16_bf16 v[64:79], v[132:135], v[56:59], v[64:79]
    s_lshl_b32 m0, s76, 2
    v_cvt_pk_bf16_f32 v60, v32, v33
    v_exp_f32 v35, v35
    v_exp_f32 v36, v36
    v_cvt_pk_bf16_f32 v61, v34, v35
    v_exp_f32 v37, v37
    v_exp_f32 v38, v38
    v_exp_f32 v39, v39
    v_cvt_pk_bf16_f32 v62, v36, v37
    v_cvt_pk_bf16_f32 v63, v38, v39
    v_mfma_f32_32x32x16_bf16 v[24:39], v[128:131], v[16:19], 0
    s_add_u32 s30, s30, 4096
    v_exp_f32 v40, v40
    v_exp_f32 v41, v41
    v_exp_f32 v42, v42
    v_exp_f32 v43, v43
    v_cvt_pk_bf16_f32 v56, v40, v41
    v_exp_f32 v44, v44
    v_mfma_f32_32x32x16_bf16 v[64:79], v[136:139], v[60:63], v[64:79]
    global_load_lds_dwordx4 v1, s[34:35] offset:0
    global_load_lds_dwordx4 v1, s[34:35] offset:1024
    global_load_lds_dwordx4 v1, s[34:35] offset:2048
    global_load_lds_dwordx4 v1, s[34:35] offset:3072
    v_exp_f32 v45, v45
    v_cvt_pk_bf16_f32 v57, v42, v43
    v_exp_f32 v46, v46
    v_exp_f32 v47, v47
    v_cvt_pk_bf16_f32 v58, v44, v45
    v_exp_f32 v48, v48
    v_cvt_pk_bf16_f32 v59, v46, v47
    v_exp_f32 v49, v49
    v_exp_f32 v50, v50
    v_mfma_f32_32x32x16_bf16 v[80:95], v[132:135], v[56:59], v[80:95]
    s_and_b32 s30, s30, 0x1ffff
    v_cvt_pk_bf16_f32 v60, v48, v49
    v_exp_f32 v51, v51
    v_exp_f32 v52, v52
    v_cvt_pk_bf16_f32 v61, v50, v51
    v_exp_f32 v53, v53
    v_exp_f32 v54, v54
    v_exp_f32 v55, v55
    v_cvt_pk_bf16_f32 v62, v52, v53
    v_cvt_pk_bf16_f32 v63, v54, v55
    v_mfma_f32_32x32x16_bf16 v[40:55], v[128:131], v[20:23], 0
    s_add_u32 s32, s30, s31
    v_exp_f32 v24, v24
    v_exp_f32 v25, v25
    v_exp_f32 v26, v26
    v_exp_f32 v27, v27
    v_cvt_pk_bf16_f32 v56, v24, v25
    v_exp_f32 v28, v28
    v_mfma_f32_32x32x16_bf16 v[80:95], v[136:139], v[60:63], v[80:95]
    s_addc_u32 s33, s38, 0
    v_exp_f32 v29, v29
    v_cvt_pk_bf16_f32 v57, v26, v27
    v_exp_f32 v30, v30
    v_exp_f32 v31, v31
    v_cvt_pk_bf16_f32 v58, v28, v29
    v_exp_f32 v32, v32
    v_cvt_pk_bf16_f32 v59, v30, v31
    v_exp_f32 v33, v33
    v_exp_f32 v34, v34
    v_mfma_f32_32x32x16_bf16 v[96:111], v[132:135], v[56:59], v[96:111]
    s_waitcnt vmcnt(6)
    s_mov_b64 exec, 1
    buffer_store_dword v254, off, s[4:7], s90 sc1
    s_mov_b64 exec, -1
    v_cvt_pk_bf16_f32 v60, v32, v33
    v_exp_f32 v35, v35
    v_exp_f32 v36, v36
    v_cvt_pk_bf16_f32 v61, v34, v35
    v_exp_f32 v37, v37
    v_exp_f32 v38, v38
    v_exp_f32 v39, v39
    v_cvt_pk_bf16_f32 v62, v36, v37
    v_cvt_pk_bf16_f32 v63, v38, v39
    v_mfma_f32_32x32x16_bf16 v[24:39], v[140:143], v[8:11], 0
    global_load_dwordx4 v[128:131], v1, s[32:33]
    v_exp_f32 v40, v40
    v_exp_f32 v41, v41
    v_exp_f32 v42, v42
    v_exp_f32 v43, v43
    v_cvt_pk_bf16_f32 v56, v40, v41
    v_exp_f32 v44, v44
    v_mfma_f32_32x32x16_bf16 v[96:111], v[136:139], v[60:63], v[96:111]
    s_add_u32 s34, s34, 4096
    v_exp_f32 v45, v45
    v_cvt_pk_bf16_f32 v57, v42, v43
    v_exp_f32 v46, v46
    v_exp_f32 v47, v47
    v_cvt_pk_bf16_f32 v58, v44, v45
    v_exp_f32 v48, v48
    v_cvt_pk_bf16_f32 v59, v46, v47
    v_exp_f32 v49, v49
    v_exp_f32 v50, v50
    v_mfma_f32_32x32x16_bf16 v[112:127], v[132:135], v[56:59], v[112:127]
    s_addc_u32 s35, s35, 0
    v_cvt_pk_bf16_f32 v60, v48, v49
    v_exp_f32 v51, v51
    v_exp_f32 v52, v52
    v_cvt_pk_bf16_f32 v61, v50, v51
    v_exp_f32 v53, v53
    v_exp_f32 v54, v54
    v_exp_f32 v55, v55
    v_cvt_pk_bf16_f32 v62, v52, v53
    v_cvt_pk_bf16_f32 v63, v54, v55
    v_mfma_f32_32x32x16_bf16 v[40:55], v[140:143], v[12:15], 0
    s_waitcnt vmcnt(6)
    v_exp_f32 v24, v24
    v_exp_f32 v25, v25
    v_exp_f32 v26, v26
    v_exp_f32 v27, v27
    v_cvt_pk_bf16_f32 v56, v24, v25
    v_exp_f32 v28, v28
    v_mfma_f32_32x32x16_bf16 v[112:127], v[136:139], v[60:63], v[112:127]
    s_mov_b64 exec, s[20:21]
    global_load_dwordx4 v[132:135], v7, s[32:33] offset:1024
    global_load_dwordx4 v[136:139], v7, s[32:33] offset:1536
    s_mov_b64 exec, -1
    v_exp_f32 v29, v29
    v_cvt_pk_bf16_f32 v57, v26, v27
    v_exp_f32 v30, v30
    v_exp_f32 v31, v31
    v_cvt_pk_bf16_f32 v58, v28, v29
    v_exp_f32 v32, v32
    v_cvt_pk_bf16_f32 v59, v30, v31
    v_exp_f32 v33, v33
    v_exp_f32 v34, v34
    v_mfma_f32_32x32x16_bf16 v[64:79], v[144:147], v[56:59], v[64:79]
    s_add_u32 m0, m0, 4096
    v_cvt_pk_bf16_f32 v60, v32, v33
    v_exp_f32 v35, v35
    v_exp_f32 v36, v36
    v_cvt_pk_bf16_f32 v61, v34, v35
    v_exp_f32 v37, v37
    v_exp_f32 v38, v38
    v_exp_f32 v39, v39
    v_cvt_pk_bf16_f32 v62, v36, v37
    v_cvt_pk_bf16_f32 v63, v38, v39
    v_mfma_f32_32x32x16_bf16 v[24:39], v[140:143], v[16:19], 0
    s_add_u32 s30, s30, 4096
    v_exp_f32 v40, v40
    v_exp_f32 v41, v41
    v_exp_f32 v42, v42
    v_exp_f32 v43, v43
    v_cvt_pk_bf16_f32 v56, v40, v41
    v_exp_f32 v44, v44
    v_mfma_f32_32x32x16_bf16 v[64:79], v[148:151], v[60:63], v[64:79]
    global_load_lds_dwordx4 v1, s[34:35] offset:0
    global_load_lds_dwordx4 v1, s[34:35] offset:1024
    global_load_lds_dwordx4 v1, s[34:35] offset:2048
    global_load_lds_dwordx4 v1, s[34:35] offset:3072
    v_exp_f32 v45, v45
    v_cvt_pk_bf16_f32 v57, v42, v43
    v_exp_f32 v46, v46
    v_exp_f32 v47, v47
    v_cvt_pk_bf16_f32 v58, v44, v45
    v_exp_f32 v48, v48
    v_cvt_pk_bf16_f32 v59, v46, v47
    v_exp_f32 v49, v49
    v_exp_f32 v50, v50
    v_mfma_f32_32x32x16_bf16 v[80:95], v[144:147], v[56:59], v[80:95]
    s_and_b32 s30, s30, 0x1ffff
    v_cvt_pk_bf16_f32 v60, v48, v49
    v_exp_f32 v51, v51
    v_exp_f32 v52, v52
    v_cvt_pk_bf16_f32 v61, v50, v51
    v_exp_f32 v53, v53
    v_exp_f32 v54, v54
    v_exp_f32 v55, v55
    v_cvt_pk_bf16_f32 v62, v52, v53
    v_cvt_pk_bf16_f32 v63, v54, v55
    v_mfma_f32_32x32x16_bf16 v[40:55], v[140:143], v[20:23], 0
    s_add_u32 s32, s30, s31
    v_exp_f32 v24, v24
    v_exp_f32 v25, v25
    v_exp_f32 v26, v26
    v_exp_f32 v27, v27
    v_cvt_pk_bf16_f32 v56, v24, v25
    v_exp_f32 v28, v28
    v_mfma_f32_32x32x16_bf16 v[80:95], v[148:151], v[60:63], v[80:95]
    s_addc_u32 s33, s38, 0
    v_exp_f32 v29, v29
    v_cvt_pk_bf16_f32 v57, v26, v27
    v_exp_f32 v30, v30
    v_exp_f32 v31, v31
    v_cvt_pk_bf16_f32 v58, v28, v29
    v_exp_f32 v32, v32
    v_cvt_pk_bf16_f32 v59, v30, v31
    v_exp_f32 v33, v33
    v_exp_f32 v34, v34
    v_mfma_f32_32x32x16_bf16 v[96:111], v[144:147], v[56:59], v[96:111]
    s_waitcnt vmcnt(6)
    buffer_store_dwordx4 v[224:227], v1, s[4:7], s91 offen sc1
    v_cvt_pk_bf16_f32 v60, v32, v33
    v_exp_f32 v35, v35
    v_exp_f32 v36, v36
    v_cvt_pk_bf16_f32 v61, v34, v35
    v_exp_f32 v37, v37
    v_exp_f32 v38, v38
    v_exp_f32 v39, v39
    v_cvt_pk_bf16_f32 v62, v36, v37
    v_cvt_pk_bf16_f32 v63, v38, v39
    v_mfma_f32_32x32x16_bf16 v[24:39], v[128:131], v[8:11], 0
    global_load_dwordx4 v[140:143], v1, s[32:33]
    v_exp_f32 v40, v40
    v_exp_f32 v41, v41
    v_exp_f32 v42, v42
    v_exp_f32 v43, v43
    v_cvt_pk_bf16_f32 v56, v40, v41
    v_exp_f32 v44, v44
    v_mfma_f32_32x32x16_bf16 v[96:111], v[148:151], v[60:63], v[96:111]
    s_add_u32 s34, s34, 4096
    v_exp_f32 v45, v45
    v_cvt_pk_bf16_f32 v57, v42, v43
    v_exp_f32 v46, v46
    v_exp_f32 v47, v47
    v_cvt_pk_bf16_f32 v58, v44, v45
    v_exp_f32 v48, v48
    v_cvt_pk_bf16_f32 v59, v46, v47
    v_exp_f32 v49, v49
    v_exp_f32 v50, v50
    v_mfma_f32_32x32x16_bf16 v[112:127], v[144:147], v[56:59], v[112:127]
    s_addc_u32 s35, s35, 0
    v_cvt_pk_bf16_f32 v60, v48, v49
    v_exp_f32 v51, v51
    v_exp_f32 v52, v52
    v_cvt_pk_bf16_f32 v61, v50, v51
    v_exp_f32 v53, v53
    v_exp_f32 v54, v54
    v_exp_f32 v55, v55
    v_cvt_pk_bf16_f32 v62, v52, v53
    v_cvt_pk_bf16_f32 v63, v54, v55
    v_mfma_f32_32x32x16_bf16 v[40:55], v[128:131], v[12:15], 0
    s_waitcnt vmcnt(6)
    v_exp_f32 v24, v24
    v_exp_f32 v25, v25
    v_exp_f32 v26, v26
    v_exp_f32 v27, v27
    v_cvt_pk_bf16_f32 v56, v24, v25
    v_exp_f32 v28, v28
    v_mfma_f32_32x32x16_bf16 v[112:127], v[148:151], v[60:63], v[112:127]
    s_mov_b64 exec, s[20:21]
    global_load_dwordx4 v[144:147], v7, s[32:33] offset:1024
    global_load_dwordx4 v[148:151], v7, s[32:33] offset:1536
    s_mov_b64 exec, -1
    v_exp_f32 v29, v29
    v_cvt_pk_bf16_f32 v57, v26, v27
    v_exp_f32 v30, v30
    v_exp_f32 v31, v31
    v_cvt_pk_bf16_f32 v58, v28, v29
    v_exp_f32 v32, v32
    v_cvt_pk_bf16_f32 v59, v30, v31
    v_exp_f32 v33, v33
    v_exp_f32 v34, v34
    v_mfma_f32_32x32x16_bf16 v[64:79], v[132:135], v[56:59], v[64:79]
    s_add_u32 m0, m0, 4096
    v_cvt_pk_bf16_f32 v60, v32, v33
    v_exp_f32 v35, v35
    v_exp_f32 v36, v36
    v_cvt_pk_bf16_f32 v61, v34, v35
    v_exp_f32 v37, v37
    v_exp_f32 v38, v38
    v_exp_f32 v39, v39
    v_cvt_pk_bf16_f32 v62, v36, v37
    v_cvt_pk_bf16_f32 v63, v38, v39
    v_mfma_f32_32x32x16_bf16 v[24:39], v[128:131], v[16:19], 0
    s_add_u32 s30, s30, 4096
    v_exp_f32 v40, v40
    v_exp_f32 v41, v41
    v_exp_f32 v42, v42
    v_exp_f32 v43, v43
    v_cvt_pk_bf16_f32 v56, v40, v41
    v_exp_f32 v44, v44
    v_mfma_f32_32x32x16_bf16 v[64:79], v[136:139], v[60:63], v[64:79]
    global_load_lds_dwordx4 v1, s[34:35] offset:0
    global_load_lds_dwordx4 v1, s[34:35] offset:1024
    global_load_lds_dwordx4 v1, s[34:35] offset:2048
    global_load_lds_dwordx4 v1, s[34:35] offset:3072
    v_exp_f32 v45, v45
    v_cvt_pk_bf16_f32 v57, v42, v43
    v_exp_f32 v46, v46
    v_exp_f32 v47, v47
    v_cvt_pk_bf16_f32 v58, v44, v45
    v_exp_f32 v48, v48
    v_cvt_pk_bf16_f32 v59, v46, v47
    v_exp_f32 v49, v49
    v_exp_f32 v50, v50
    v_mfma_f32_32x32x16_bf16 v[80:95], v[132:135], v[56:59], v[80:95]
    s_and_b32 s30, s30, 0x1ffff
    v_cvt_pk_bf16_f32 v60, v48, v49
    v_exp_f32 v51, v51
    v_exp_f32 v52, v52
    v_cvt_pk_bf16_f32 v61, v50, v51
    v_exp_f32 v53, v53
    v_exp_f32 v54, v54
    v_exp_f32 v55, v55
    v_cvt_pk_bf16_f32 v62, v52, v53
    v_cvt_pk_bf16_f32 v63, v54, v55
    v_mfma_f32_32x32x16_bf16 v[40:55], v[128:131], v[20:23], 0
    s_add_u32 s32, s30, s31
    v_exp_f32 v24, v24
    v_exp_f32 v25, v25
    v_exp_f32 v26, v26
    v_exp_f32 v27, v27
    v_cvt_pk_bf16_f32 v56, v24, v25
    v_exp_f32 v28, v28
    v_mfma_f32_32x32x16_bf16 v[80:95], v[136:139], v[60:63], v[80:95]
    s_addc_u32 s33, s38, 0
    v_exp_f32 v29, v29
    v_cvt_pk_bf16_f32 v57, v26, v27
    v_exp_f32 v30, v30
    v_exp_f32 v31, v31
    v_cvt_pk_bf16_f32 v58, v28, v29
    v_exp_f32 v32, v32
    v_cvt_pk_bf16_f32 v59, v30, v31
    v_exp_f32 v33, v33
    v_exp_f32 v34, v34
    v_mfma_f32_32x32x16_bf16 v[96:111], v[132:135], v[56:59], v[96:111]
    s_waitcnt vmcnt(6)
    buffer_store_dwordx4 v[244:247], v1, s[4:7], s52 offen sc1
    v_cvt_pk_bf16_f32 v60, v32, v33
    v_exp_f32 v35, v35
    v_exp_f32 v36, v36
    v_cvt_pk_bf16_f32 v61, v34, v35
    v_exp_f32 v37, v37
    v_exp_f32 v38, v38
    v_exp_f32 v39, v39
    v_cvt_pk_bf16_f32 v62, v36, v37
    v_cvt_pk_bf16_f32 v63, v38, v39
    v_mfma_f32_32x32x16_bf16 v[24:39], v[140:143], v[8:11], 0
    global_load_dwordx4 v[128:131], v1, s[32:33]
    v_exp_f32 v40, v40
    v_exp_f32 v41, v41
    v_exp_f32 v42, v42
    v_exp_f32 v43, v43
    v_cvt_pk_bf16_f32 v56, v40, v41
    v_exp_f32 v44, v44
    v_mfma_f32_32x32x16_bf16 v[96:111], v[136:139], v[60:63], v[96:111]
    s_add_u32 s34, s34, 4096
    v_exp_f32 v45, v45
    v_cvt_pk_bf16_f32 v57, v42, v43
    v_exp_f32 v46, v46
    v_exp_f32 v47, v47
    v_cvt_pk_bf16_f32 v58, v44, v45
    v_exp_f32 v48, v48
    v_cvt_pk_bf16_f32 v59, v46, v47
    v_exp_f32 v49, v49
    v_exp_f32 v50, v50
    v_mfma_f32_32x32x16_bf16 v[112:127], v[132:135], v[56:59], v[112:127]
    s_addc_u32 s35, s35, 0
    v_cvt_pk_bf16_f32 v60, v48, v49
    v_exp_f32 v51, v51
    v_exp_f32 v52, v52
    v_cvt_pk_bf16_f32 v61, v50, v51
    v_exp_f32 v53, v53
    v_exp_f32 v54, v54
    v_exp_f32 v55, v55
    v_cvt_pk_bf16_f32 v62, v52, v53
    v_cvt_pk_bf16_f32 v63, v54, v55
    v_mfma_f32_32x32x16_bf16 v[40:55], v[140:143], v[12:15], 0
    s_waitcnt vmcnt(6)
    v_exp_f32 v24, v24
    v_exp_f32 v25, v25
    v_exp_f32 v26, v26
    v_exp_f32 v27, v27
    v_cvt_pk_bf16_f32 v56, v24, v25
    v_exp_f32 v28, v28
    v_mfma_f32_32x32x16_bf16 v[112:127], v[136:139], v[60:63], v[112:127]
    s_mov_b64 exec, s[20:21]
    global_load_dwordx4 v[132:135], v7, s[32:33] offset:1024
    global_load_dwordx4 v[136:139], v7, s[32:33] offset:1536
    s_mov_b64 exec, -1
    v_exp_f32 v29, v29
    v_cvt_pk_bf16_f32 v57, v26, v27
    v_exp_f32 v30, v30
    v_exp_f32 v31, v31
    v_cvt_pk_bf16_f32 v58, v28, v29
    v_exp_f32 v32, v32
    v_cvt_pk_bf16_f32 v59, v30, v31
    v_exp_f32 v33, v33
    v_exp_f32 v34, v34
    v_mfma_f32_32x32x16_bf16 v[64:79], v[144:147], v[56:59], v[64:79]
    s_add_u32 m0, m0, 4096
    v_cvt_pk_bf16_f32 v60, v32, v33
    v_exp_f32 v35, v35
    v_exp_f32 v36, v36
    v_cvt_pk_bf16_f32 v61, v34, v35
    v_exp_f32 v37, v37
    v_exp_f32 v38, v38
    v_exp_f32 v39, v39
    v_cvt_pk_bf16_f32 v62, v36, v37
    v_cvt_pk_bf16_f32 v63, v38, v39
    v_mfma_f32_32x32x16_bf16 v[24:39], v[140:143], v[16:19], 0
    s_add_u32 s30, s30, 4096
    v_exp_f32 v40, v40
    v_exp_f32 v41, v41
    v_exp_f32 v42, v42
    v_exp_f32 v43, v43
    v_cvt_pk_bf16_f32 v56, v40, v41
    v_exp_f32 v44, v44
    v_mfma_f32_32x32x16_bf16 v[64:79], v[148:151], v[60:63], v[64:79]
    global_load_lds_dwordx4 v1, s[34:35] offset:0
    global_load_lds_dwordx4 v1, s[34:35] offset:1024
    global_load_lds_dwordx4 v1, s[34:35] offset:2048
    global_load_lds_dwordx4 v1, s[34:35] offset:3072
    v_exp_f32 v45, v45
    v_cvt_pk_bf16_f32 v57, v42, v43
    v_exp_f32 v46, v46
    v_exp_f32 v47, v47
    v_cvt_pk_bf16_f32 v58, v44, v45
    v_exp_f32 v48, v48
    v_cvt_pk_bf16_f32 v59, v46, v47
    v_exp_f32 v49, v49
    v_exp_f32 v50, v50
    v_mfma_f32_32x32x16_bf16 v[80:95], v[144:147], v[56:59], v[80:95]
    s_and_b32 s30, s30, 0x1ffff
    v_cvt_pk_bf16_f32 v60, v48, v49
    v_exp_f32 v51, v51
    v_exp_f32 v52, v52
    v_cvt_pk_bf16_f32 v61, v50, v51
    v_exp_f32 v53, v53
    v_exp_f32 v54, v54
    v_exp_f32 v55, v55
    v_cvt_pk_bf16_f32 v62, v52, v53
    v_cvt_pk_bf16_f32 v63, v54, v55
    v_mfma_f32_32x32x16_bf16 v[40:55], v[140:143], v[20:23], 0
    s_add_u32 s32, s30, s31
    v_exp_f32 v24, v24
    v_exp_f32 v25, v25
    v_exp_f32 v26, v26
    v_exp_f32 v27, v27
    v_cvt_pk_bf16_f32 v56, v24, v25
    v_exp_f32 v28, v28
    v_mfma_f32_32x32x16_bf16 v[80:95], v[148:151], v[60:63], v[80:95]
    s_addc_u32 s33, s38, 0
    v_exp_f32 v29, v29
    v_cvt_pk_bf16_f32 v57, v26, v27
    v_exp_f32 v30, v30
    v_exp_f32 v31, v31
    v_cvt_pk_bf16_f32 v58, v28, v29
    v_exp_f32 v32, v32
    v_cvt_pk_bf16_f32 v59, v30, v31
    v_exp_f32 v33, v33
    v_exp_f32 v34, v34
    v_mfma_f32_32x32x16_bf16 v[96:111], v[144:147], v[56:59], v[96:111]
    s_waitcnt vmcnt(6)
    buffer_store_dwordx4 v[248:251], v1, s[4:7], s52 offen offset:1024 sc1
    v_cvt_pk_bf16_f32 v60, v32, v33
    v_exp_f32 v35, v35
    v_exp_f32 v36, v36
    v_cvt_pk_bf16_f32 v61, v34, v35
    v_exp_f32 v37, v37
    v_exp_f32 v38, v38
    v_exp_f32 v39, v39
    v_cvt_pk_bf16_f32 v62, v36, v37
    v_cvt_pk_bf16_f32 v63, v38, v39
    v_mfma_f32_32x32x16_bf16 v[24:39], v[128:131], v[8:11], 0
    global_load_dwordx4 v[140:143], v1, s[32:33]
    v_exp_f32 v40, v40
    v_exp_f32 v41, v41
    v_exp_f32 v42, v42
    v_exp_f32 v43, v43
    v_cvt_pk_bf16_f32 v56, v40, v41
    v_exp_f32 v44, v44
    v_mfma_f32_32x32x16_bf16 v[96:111], v[148:151], v[60:63], v[96:111]
    s_add_u32 s34, s4, s73
    v_exp_f32 v45, v45
    v_cvt_pk_bf16_f32 v57, v42, v43
    v_exp_f32 v46, v46
    v_exp_f32 v47, v47
    v_cvt_pk_bf16_f32 v58, v44, v45
    v_exp_f32 v48, v48
    v_cvt_pk_bf16_f32 v59, v46, v47
    v_exp_f32 v49, v49
    v_exp_f32 v50, v50
    v_mfma_f32_32x32x16_bf16 v[112:127], v[144:147], v[56:59], v[112:127]
    s_addc_u32 s35, s5, 0
    v_cvt_pk_bf16_f32 v60, v48, v49
    v_exp_f32 v51, v51
    v_exp_f32 v52, v52
    v_cvt_pk_bf16_f32 v61, v50, v51
    v_exp_f32 v53, v53
    v_exp_f32 v54, v54
    v_exp_f32 v55, v55
    v_cvt_pk_bf16_f32 v62, v52, v53
    v_cvt_pk_bf16_f32 v63, v54, v55
    v_mfma_f32_32x32x16_bf16 v[40:55], v[128:131], v[12:15], 0
    s_waitcnt vmcnt(6)
    v_exp_f32 v24, v24
    v_exp_f32 v25, v25
    v_exp_f32 v26, v26
    v_exp_f32 v27, v27
    v_cvt_pk_bf16_f32 v56, v24, v25
    v_exp_f32 v28, v28
    v_mfma_f32_32x32x16_bf16 v[112:127], v[148:151], v[60:63], v[112:127]
    s_mov_b64 exec, s[20:21]
    global_load_dwordx4 v[144:147], v7, s[32:33] offset:1024
    global_load_dwordx4 v[148:151], v7, s[32:33] offset:1536
    s_mov_b64 exec, -1
    v_exp_f32 v29, v29
    v_cvt_pk_bf16_f32 v57, v26, v27
    v_exp_f32 v30, v30
    v_exp_f32 v31, v31
    v_cvt_pk_bf16_f32 v58, v28, v29
    v_exp_f32 v32, v32
    v_cvt_pk_bf16_f32 v59, v30, v31
    v_exp_f32 v33, v33
    v_exp_f32 v34, v34
    v_mfma_f32_32x32x16_bf16 v[64:79], v[132:135], v[56:59], v[64:79]
    v_cvt_pk_bf16_f32 v60, v32, v33
    v_exp_f32 v35, v35
    v_exp_f32 v36, v36
    v_cvt_pk_bf16_f32 v61, v34, v35
    v_exp_f32 v37, v37
    v_exp_f32 v38, v38
    v_exp_f32 v39, v39
    v_cvt_pk_bf16_f32 v62, v36, v37
    v_cvt_pk_bf16_f32 v63, v38, v39
    v_mfma_f32_32x32x16_bf16 v[24:39], v[128:131], v[16:19], 0
    s_add_u32 s30, s30, 4096
    v_exp_f32 v40, v40
    v_exp_f32 v41, v41
    v_exp_f32 v42, v42
    v_exp_f32 v43, v43
    v_cvt_pk_bf16_f32 v56, v40, v41
    v_exp_f32 v44, v44
    v_mfma_f32_32x32x16_bf16 v[64:79], v[136:139], v[60:63], v[64:79]
    global_load_dwordx4 a[0:3], v1, s[34:35] offset:-4096
    global_load_dwordx4 a[4:7], v1, s[34:35] offset:-3072
    global_load_dwordx4 a[8:11], v1, s[34:35] offset:-2048
    global_load_dwordx4 a[12:15], v1, s[34:35] offset:-1024
    v_exp_f32 v45, v45
    v_cvt_pk_bf16_f32 v57, v42, v43
    v_exp_f32 v46, v46
    v_exp_f32 v47, v47
    v_cvt_pk_bf16_f32 v58, v44, v45
    v_exp_f32 v48, v48
    v_cvt_pk_bf16_f32 v59, v46, v47
    v_exp_f32 v49, v49
    v_exp_f32 v50, v50
    v_mfma_f32_32x32x16_bf16 v[80:95], v[132:135], v[56:59], v[80:95]
    s_and_b32 s30, s30, 0x1ffff
    v_cvt_pk_bf16_f32 v60, v48, v49
    v_exp_f32 v51, v51
    v_exp_f32 v52, v52
    v_cvt_pk_bf16_f32 v61, v50, v51
    v_exp_f32 v53, v53
    v_exp_f32 v54, v54
    v_exp_f32 v55, v55
    v_cvt_pk_bf16_f32 v62, v52, v53
    v_cvt_pk_bf16_f32 v63, v54, v55
    v_mfma_f32_32x32x16_bf16 v[40:55], v[128:131], v[20:23], 0
    s_add_u32 s32, s30, s31
    v_exp_f32 v24, v24
    v_exp_f32 v25, v25
    v_exp_f32 v26, v26
    v_exp_f32 v27, v27
    v_cvt_pk_bf16_f32 v56, v24, v25
    v_exp_f32 v28, v28
    v_mfma_f32_32x32x16_bf16 v[80:95], v[136:139], v[60:63], v[80:95]
    s_addc_u32 s33, s38, 0
    v_exp_f32 v29, v29
    v_cvt_pk_bf16_f32 v57, v26, v27
    v_exp_f32 v30, v30
    v_exp_f32 v31, v31
    v_cvt_pk_bf16_f32 v58, v28, v29
    v_exp_f32 v32, v32
    v_cvt_pk_bf16_f32 v59, v30, v31
    v_exp_f32 v33, v33
    v_exp_f32 v34, v34
    v_mfma_f32_32x32x16_bf16 v[96:111], v[132:135], v[56:59], v[96:111]
    s_waitcnt vmcnt(6)
    s_add_u32 s27, s79, 4096
    s_cmp_eq_u32 s14, 0
    s_cselect_b32 s27, s27, 25165824
    buffer_store_dwordx4 v[204:207], v1, s[4:7], s27 offen sc1
    v_cvt_pk_bf16_f32 v60, v32, v33
    v_exp_f32 v35, v35
    v_exp_f32 v36, v36
    v_cvt_pk_bf16_f32 v61, v34, v35
    v_exp_f32 v37, v37
    v_exp_f32 v38, v38
    v_exp_f32 v39, v39
    v_cvt_pk_bf16_f32 v62, v36, v37
    v_cvt_pk_bf16_f32 v63, v38, v39
    v_mfma_f32_32x32x16_bf16 v[24:39], v[140:143], v[8:11], 0
    global_load_dwordx4 v[128:131], v1, s[32:33]
    global_load_dwordx4 a[16:19], v1, s[34:35] offset:0
    global_load_dwordx4 a[20:23], v1, s[34:35] offset:1024
    global_load_dwordx4 a[24:27], v1, s[34:35] offset:2048
    v_exp_f32 v40, v40
    v_exp_f32 v41, v41
    v_exp_f32 v42, v42
    v_exp_f32 v43, v43
    v_cvt_pk_bf16_f32 v56, v40, v41
    v_exp_f32 v44, v44
    v_mfma_f32_32x32x16_bf16 v[96:111], v[136:139], v[60:63], v[96:111]
    s_add_u32 s34, s34, 7168
    v_exp_f32 v45, v45
    v_cvt_pk_bf16_f32 v57, v42, v43
    v_exp_f32 v46, v46
    v_exp_f32 v47, v47
    v_cvt_pk_bf16_f32 v58, v44, v45
    v_exp_f32 v48, v48
    v_cvt_pk_bf16_f32 v59, v46, v47
    v_exp_f32 v49, v49
    v_exp_f32 v50, v50
    v_mfma_f32_32x32x16_bf16 v[112:127], v[132:135], v[56:59], v[112:127]
    s_addc_u32 s35, s35, 0
    v_cvt_pk_bf16_f32 v60, v48, v49
    v_exp_f32 v51, v51
    v_exp_f32 v52, v52
    v_cvt_pk_bf16_f32 v61, v50, v51
    v_exp_f32 v53, v53
    v_exp_f32 v54, v54
    v_exp_f32 v55, v55
    v_cvt_pk_bf16_f32 v62, v52, v53
    v_cvt_pk_bf16_f32 v63, v54, v55
    v_mfma_f32_32x32x16_bf16 v[40:55], v[140:143], v[12:15], 0
    s_waitcnt vmcnt(9)
    v_exp_f32 v24, v24
    v_exp_f32 v25, v25
    v_exp_f32 v26, v26
    v_exp_f32 v27, v27
    v_cvt_pk_bf16_f32 v56, v24, v25
    v_exp_f32 v28, v28
    v_mfma_f32_32x32x16_bf16 v[112:127], v[136:139], v[60:63], v[112:127]
    s_mov_b64 exec, s[20:21]
    global_load_dwordx4 v[132:135], v7, s[32:33] offset:1024
    global_load_dwordx4 v[136:139], v7, s[32:33] offset:1536
    s_mov_b64 exec, -1
    v_exp_f32 v29, v29
    v_cvt_pk_bf16_f32 v57, v26, v27
    v_exp_f32 v30, v30
    v_exp_f32 v31, v31
    v_cvt_pk_bf16_f32 v58, v28, v29
    v_exp_f32 v32, v32
    v_cvt_pk_bf16_f32 v59, v30, v31
    v_exp_f32 v33, v33
    v_exp_f32 v34, v34
    v_mfma_f32_32x32x16_bf16 v[64:79], v[144:147], v[56:59], v[64:79]
    v_cvt_pk_bf16_f32 v60, v32, v33
    v_exp_f32 v35, v35
    v_exp_f32 v36, v36
    v_cvt_pk_bf16_f32 v61, v34, v35
    v_exp_f32 v37, v37
    v_exp_f32 v38, v38
    v_exp_f32 v39, v39
    v_cvt_pk_bf16_f32 v62, v36, v37
    v_cvt_pk_bf16_f32 v63, v38, v39
    v_mfma_f32_32x32x16_bf16 v[24:39], v[140:143], v[16:19], 0
    s_add_u32 s30, s30, 4096
    v_exp_f32 v40, v40
    v_exp_f32 v41, v41
    v_exp_f32 v42, v42
    v_exp_f32 v43, v43
    v_cvt_pk_bf16_f32 v56, v40, v41
    v_exp_f32 v44, v44
    v_mfma_f32_32x32x16_bf16 v[64:79], v[148:151], v[60:63], v[64:79]
    global_load_dwordx4 a[28:31], v1, s[34:35] offset:-4096
    global_load_dwordx4 a[32:35], v1, s[34:35] offset:-3072
    global_load_dwordx4 a[36:39], v1, s[34:35] offset:-2048
    global_load_dwordx4 a[40:43], v1, s[34:35] offset:-1024
    v_exp_f32 v45, v45
    v_cvt_pk_bf16_f32 v57, v42, v43
    v_exp_f32 v46, v46
    v_exp_f32 v47, v47
    v_cvt_pk_bf16_f32 v58, v44, v45
    v_exp_f32 v48, v48
    v_cvt_pk_bf16_f32 v59, v46, v47
    v_exp_f32 v49, v49
    v_exp_f32 v50, v50
    v_mfma_f32_32x32x16_bf16 v[80:95], v[144:147], v[56:59], v[80:95]
    s_and_b32 s30, s30, 0x1ffff
    v_cvt_pk_bf16_f32 v60, v48, v49
    v_exp_f32 v51, v51
    v_exp_f32 v52, v52
    v_cvt_pk_bf16_f32 v61, v50, v51
    v_exp_f32 v53, v53
    v_exp_f32 v54, v54
    v_exp_f32 v55, v55
    v_cvt_pk_bf16_f32 v62, v52, v53
    v_cvt_pk_bf16_f32 v63, v54, v55
    v_mfma_f32_32x32x16_bf16 v[40:55], v[140:143], v[20:23], 0
    s_add_u32 s32, s30, s31
    v_exp_f32 v24, v24
    v_exp_f32 v25, v25
    v_exp_f32 v26, v26
    v_exp_f32 v27, v27
    v_cvt_pk_bf16_f32 v56, v24, v25
    v_exp_f32 v28, v28
    v_mfma_f32_32x32x16_bf16 v[80:95], v[148:151], v[60:63], v[80:95]
    s_addc_u32 s33, s38, 0
    v_exp_f32 v29, v29
    v_cvt_pk_bf16_f32 v57, v26, v27
    v_exp_f32 v30, v30
    v_exp_f32 v31, v31
    v_cvt_pk_bf16_f32 v58, v28, v29
    v_exp_f32 v32, v32
    v_cvt_pk_bf16_f32 v59, v30, v31
    v_exp_f32 v33, v33
    v_exp_f32 v34, v34
    v_mfma_f32_32x32x16_bf16 v[96:111], v[144:147], v[56:59], v[96:111]
    s_waitcnt vmcnt(9)
    v_and_b32 v255, 1, v3
    v_lshlrev_b32 v255, 14, v255
    v_add_u32 v255, v255, v7
    buffer_store_dwordx4 v[244:247], v255, s[4:7], s36 offen sc1
    v_cvt_pk_bf16_f32 v60, v32, v33
    v_exp_f32 v35, v35
    v_exp_f32 v36, v36
    v_cvt_pk_bf16_f32 v61, v34, v35
    v_exp_f32 v37, v37
    v_exp_f32 v38, v38
    v_exp_f32 v39, v39
    v_cvt_pk_bf16_f32 v62, v36, v37
    v_cvt_pk_bf16_f32 v63, v38, v39
    v_mfma_f32_32x32x16_bf16 v[24:39], v[128:131], v[8:11], 0
    global_load_dwordx4 v[140:143], v1, s[32:33]
    global_load_dwordx4 a[44:47], v1, s[34:35] offset:0
    global_load_dwordx4 a[48:51], v1, s[34:35] offset:1024
    global_load_dwordx4 a[52:55], v1, s[34:35] offset:2048
    v_exp_f32 v40, v40
    v_exp_f32 v41, v41
    v_exp_f32 v42, v42
    v_exp_f32 v43, v43
    v_cvt_pk_bf16_f32 v56, v40, v41
    v_exp_f32 v44, v44
    v_mfma_f32_32x32x16_bf16 v[96:111], v[148:151], v[60:63], v[96:111]
    s_add_u32 s34, s34, 7168
    v_exp_f32 v45, v45
    v_cvt_pk_bf16_f32 v57, v42, v43
    v_exp_f32 v46, v46
    v_exp_f32 v47, v47
    v_cvt_pk_bf16_f32 v58, v44, v45
    v_exp_f32 v48, v48
    v_cvt_pk_bf16_f32 v59, v46, v47
    v_exp_f32 v49, v49
    v_exp_f32 v50, v50
    v_mfma_f32_32x32x16_bf16 v[112:127], v[144:147], v[56:59], v[112:127]
    s_addc_u32 s35, s35, 0
    v_cvt_pk_bf16_f32 v60, v48, v49
    v_exp_f32 v51, v51
    v_exp_f32 v52, v52
    v_cvt_pk_bf16_f32 v61, v50, v51
    v_exp_f32 v53, v53
    v_exp_f32 v54, v54
    v_exp_f32 v55, v55
    v_cvt_pk_bf16_f32 v62, v52, v53
    v_cvt_pk_bf16_f32 v63, v54, v55
    v_mfma_f32_32x32x16_bf16 v[40:55], v[128:131], v[12:15], 0
    s_waitcnt vmcnt(9)
    v_exp_f32 v24, v24
    v_exp_f32 v25, v25
    v_exp_f32 v26, v26
    v_exp_f32 v27, v27
    v_cvt_pk_bf16_f32 v56, v24, v25
    v_exp_f32 v28, v28
    v_mfma_f32_32x32x16_bf16 v[112:127], v[148:151], v[60:63], v[112:127]
    s_mov_b64 exec, s[20:21]
    global_load_dwordx4 v[144:147], v7, s[32:33] offset:1024
    global_load_dwordx4 v[148:151], v7, s[32:33] offset:1536
    s_mov_b64 exec, -1
    v_exp_f32 v29, v29
    v_cvt_pk_bf16_f32 v57, v26, v27
    v_exp_f32 v30, v30
    v_exp_f32 v31, v31
    v_cvt_pk_bf16_f32 v58, v28, v29
    v_exp_f32 v32, v32
    v_cvt_pk_bf16_f32 v59, v30, v31
    v_exp_f32 v33, v33
    v_exp_f32 v34, v34
    v_mfma_f32_32x32x16_bf16 v[64:79], v[132:135], v[56:59], v[64:79]
    v_cvt_pk_bf16_f32 v60, v32, v33
    v_exp_f32 v35, v35
    v_exp_f32 v36, v36
    v_cvt_pk_bf16_f32 v61, v34, v35
    v_exp_f32 v37, v37
    v_exp_f32 v38, v38
    v_exp_f32 v39, v39
    v_cvt_pk_bf16_f32 v62, v36, v37
    v_cvt_pk_bf16_f32 v63, v38, v39
    v_mfma_f32_32x32x16_bf16 v[24:39], v[128:131], v[16:19], 0
    s_add_u32 s30, s30, 4096
    v_exp_f32 v40, v40
    v_exp_f32 v41, v41
    v_exp_f32 v42, v42
    v_exp_f32 v43, v43
    v_cvt_pk_bf16_f32 v56, v40, v41
    v_exp_f32 v44, v44
    v_mfma_f32_32x32x16_bf16 v[64:79], v[136:139], v[60:63], v[64:79]
    global_load_dwordx4 a[56:59], v1, s[34:35] offset:-4096
    global_load_dwordx4 a[60:63], v1, s[34:35] offset:-3072
    global_load_dwordx4 a[64:67], v1, s[34:35] offset:-2048
    global_load_dwordx4 a[68:71], v1, s[34:35] offset:-1024
    v_exp_f32 v45, v45
    v_cvt_pk_bf16_f32 v57, v42, v43
    v_exp_f32 v46, v46
    v_exp_f32 v47, v47
    v_cvt_pk_bf16_f32 v58, v44, v45
    v_exp_f32 v48, v48
    v_cvt_pk_bf16_f32 v59, v46, v47
    v_exp_f32 v49, v49
    v_exp_f32 v50, v50
    v_mfma_f32_32x32x16_bf16 v[80:95], v[132:135], v[56:59], v[80:95]
    s_and_b32 s30, s30, 0x1ffff
    v_cvt_pk_bf16_f32 v60, v48, v49
    v_exp_f32 v51, v51
    v_exp_f32 v52, v52
    v_cvt_pk_bf16_f32 v61, v50, v51
    v_exp_f32 v53, v53
    v_exp_f32 v54, v54
    v_exp_f32 v55, v55
    v_cvt_pk_bf16_f32 v62, v52, v53
    v_cvt_pk_bf16_f32 v63, v54, v55
    v_mfma_f32_32x32x16_bf16 v[40:55], v[128:131], v[20:23], 0
    s_add_u32 s32, s30, s31
    v_exp_f32 v24, v24
    v_exp_f32 v25, v25
    v_exp_f32 v26, v26
    v_exp_f32 v27, v27
    v_cvt_pk_bf16_f32 v56, v24, v25
    v_exp_f32 v28, v28
    v_mfma_f32_32x32x16_bf16 v[80:95], v[136:139], v[60:63], v[80:95]
    s_addc_u32 s33, s38, 0
    v_exp_f32 v29, v29
    v_cvt_pk_bf16_f32 v57, v26, v27
    v_exp_f32 v30, v30
    v_exp_f32 v31, v31
    v_cvt_pk_bf16_f32 v58, v28, v29
    v_exp_f32 v32, v32
    v_cvt_pk_bf16_f32 v59, v30, v31
    v_exp_f32 v33, v33
    v_exp_f32 v34, v34
    v_mfma_f32_32x32x16_bf16 v[96:111], v[132:135], v[56:59], v[96:111]
    s_waitcnt vmcnt(9)
    buffer_store_dwordx4 v[244:247], v255, s[4:7], s37 offen sc1
    v_cvt_pk_bf16_f32 v60, v32, v33
    v_exp_f32 v35, v35
    v_exp_f32 v36, v36
    v_cvt_pk_bf16_f32 v61, v34, v35
    v_exp_f32 v37, v37
    v_exp_f32 v38, v38
    v_exp_f32 v39, v39
    v_cvt_pk_bf16_f32 v62, v36, v37
    v_cvt_pk_bf16_f32 v63, v38, v39
    v_mfma_f32_32x32x16_bf16 v[24:39], v[140:143], v[8:11], 0
    global_load_dwordx4 v[128:131], v1, s[32:33]
    global_load_dwordx4 a[72:75], v1, s[34:35] offset:0
    global_load_dwordx4 a[76:79], v1, s[34:35] offset:1024
    global_load_dwordx4 a[80:83], v1, s[34:35] offset:2048
    v_exp_f32 v40, v40
    v_exp_f32 v41, v41
    v_exp_f32 v42, v42
    v_exp_f32 v43, v43
    v_cvt_pk_bf16_f32 v56, v40, v41
    v_exp_f32 v44, v44
    v_mfma_f32_32x32x16_bf16 v[96:111], v[136:139], v[60:63], v[96:111]
    s_add_u32 s34, s34, 7168
    v_exp_f32 v45, v45
    v_cvt_pk_bf16_f32 v57, v42, v43
    v_exp_f32 v46, v46
    v_exp_f32 v47, v47
    v_cvt_pk_bf16_f32 v58, v44, v45
    v_exp_f32 v48, v48
    v_cvt_pk_bf16_f32 v59, v46, v47
    v_exp_f32 v49, v49
    v_exp_f32 v50, v50
    v_mfma_f32_32x32x16_bf16 v[112:127], v[132:135], v[56:59], v[112:127]
    s_addc_u32 s35, s35, 0
    v_cvt_pk_bf16_f32 v60, v48, v49
    v_exp_f32 v51, v51
    v_exp_f32 v52, v52
    v_cvt_pk_bf16_f32 v61, v50, v51
    v_exp_f32 v53, v53
    v_exp_f32 v54, v54
    v_exp_f32 v55, v55
    v_cvt_pk_bf16_f32 v62, v52, v53
    v_cvt_pk_bf16_f32 v63, v54, v55
    v_mfma_f32_32x32x16_bf16 v[40:55], v[140:143], v[12:15], 0
    s_waitcnt vmcnt(9)
    v_exp_f32 v24, v24
    v_exp_f32 v25, v25
    v_exp_f32 v26, v26
    v_exp_f32 v27, v27
    v_cvt_pk_bf16_f32 v56, v24, v25
    v_exp_f32 v28, v28
    v_mfma_f32_32x32x16_bf16 v[112:127], v[136:139], v[60:63], v[112:127]
    s_mov_b64 exec, s[20:21]
    global_load_dwordx4 v[132:135], v7, s[32:33] offset:1024
    global_load_dwordx4 v[136:139], v7, s[32:33] offset:1536
    s_mov_b64 exec, -1
    v_exp_f32 v29, v29
    v_cvt_pk_bf16_f32 v57, v26, v27
    v_exp_f32 v30, v30
    v_exp_f32 v31, v31
    v_cvt_pk_bf16_f32 v58, v28, v29
    v_exp_f32 v32, v32
    v_cvt_pk_bf16_f32 v59, v30, v31
    v_exp_f32 v33, v33
    v_exp_f32 v34, v34
    v_mfma_f32_32x32x16_bf16 v[64:79], v[144:147], v[56:59], v[64:79]
    v_cvt_pk_bf16_f32 v60, v32, v33
    v_exp_f32 v35, v35
    v_exp_f32 v36, v36
    v_cvt_pk_bf16_f32 v61, v34, v35
    v_exp_f32 v37, v37
    v_exp_f32 v38, v38
    v_exp_f32 v39, v39
    v_cvt_pk_bf16_f32 v62, v36, v37
    v_cvt_pk_bf16_f32 v63, v38, v39
    v_mfma_f32_32x32x16_bf16 v[24:39], v[140:143], v[16:19], 0
    s_add_u32 s30, s30, 4096
    v_exp_f32 v40, v40
    v_exp_f32 v41, v41
    v_exp_f32 v42, v42
    v_exp_f32 v43, v43
    v_cvt_pk_bf16_f32 v56, v40, v41
    v_exp_f32 v44, v44
    v_mfma_f32_32x32x16_bf16 v[64:79], v[148:151], v[60:63], v[64:79]
    global_load_dwordx4 a[84:87], v1, s[34:35] offset:-4096
    global_load_dwordx4 a[88:91], v1, s[34:35] offset:-3072
    global_load_dwordx4 a[92:95], v1, s[34:35] offset:-2048
    global_load_dwordx4 a[96:99], v1, s[34:35] offset:-1024
    v_exp_f32 v45, v45
    v_cvt_pk_bf16_f32 v57, v42, v43
    v_exp_f32 v46, v46
    v_exp_f32 v47, v47
    v_cvt_pk_bf16_f32 v58, v44, v45
    v_exp_f32 v48, v48
    v_cvt_pk_bf16_f32 v59, v46, v47
    v_exp_f32 v49, v49
    v_exp_f32 v50, v50
    v_mfma_f32_32x32x16_bf16 v[80:95], v[144:147], v[56:59], v[80:95]
    s_and_b32 s30, s30, 0x1ffff
    v_cvt_pk_bf16_f32 v60, v48, v49
    v_exp_f32 v51, v51
    v_exp_f32 v52, v52
    v_cvt_pk_bf16_f32 v61, v50, v51
    v_exp_f32 v53, v53
    v_exp_f32 v54, v54
    v_exp_f32 v55, v55
    v_cvt_pk_bf16_f32 v62, v52, v53
    v_cvt_pk_bf16_f32 v63, v54, v55
    v_mfma_f32_32x32x16_bf16 v[40:55], v[140:143], v[20:23], 0
    s_add_u32 s32, s30, s31
    v_exp_f32 v24, v24
    v_exp_f32 v25, v25
    v_exp_f32 v26, v26
    v_exp_f32 v27, v27
    v_cvt_pk_bf16_f32 v56, v24, v25
    v_exp_f32 v28, v28
    v_mfma_f32_32x32x16_bf16 v[80:95], v[148:151], v[60:63], v[80:95]
    s_addc_u32 s33, s38, 0
    v_exp_f32 v29, v29
    v_cvt_pk_bf16_f32 v57, v26, v27
    v_exp_f32 v30, v30
    v_exp_f32 v31, v31
    v_cvt_pk_bf16_f32 v58, v28, v29
    v_exp_f32 v32, v32
    v_cvt_pk_bf16_f32 v59, v30, v31
    v_exp_f32 v33, v33
    v_exp_f32 v34, v34
    v_mfma_f32_32x32x16_bf16 v[96:111], v[144:147], v[56:59], v[96:111]
    s_waitcnt vmcnt(9)
    buffer_store_dword v244, v242, s[4:7], s53 offen sc1
    v_cvt_pk_bf16_f32 v60, v32, v33
    v_exp_f32 v35, v35
    v_exp_f32 v36, v36
    v_cvt_pk_bf16_f32 v61, v34, v35
    v_exp_f32 v37, v37
    v_exp_f32 v38, v38
    v_exp_f32 v39, v39
    v_cvt_pk_bf16_f32 v62, v36, v37
    v_cvt_pk_bf16_f32 v63, v38, v39
    v_mfma_f32_32x32x16_bf16 v[24:39], v[128:131], v[8:11], 0
    global_load_dwordx4 v[140:143], v1, s[32:33]
    global_load_dwordx4 a[100:103], v1, s[34:35] offset:0
    global_load_dwordx4 a[104:107], v1, s[34:35] offset:1024
    global_load_dwordx4 a[108:111], v1, s[34:35] offset:2048
    v_exp_f32 v40, v40
    v_exp_f32 v41, v41
    v_exp_f32 v42, v42
    v_exp_f32 v43, v43
    v_cvt_pk_bf16_f32 v56, v40, v41
    v_exp_f32 v44, v44
    v_mfma_f32_32x32x16_bf16 v[96:111], v[148:151], v[60:63], v[96:111]
    s_add_u32 s34, s34, 7168
    v_exp_f32 v45, v45
    v_cvt_pk_bf16_f32 v57, v42, v43
    v_exp_f32 v46, v46
    v_exp_f32 v47, v47
    v_cvt_pk_bf16_f32 v58, v44, v45
    v_exp_f32 v48, v48
    v_cvt_pk_bf16_f32 v59, v46, v47
    v_exp_f32 v49, v49
    v_exp_f32 v50, v50
    v_mfma_f32_32x32x16_bf16 v[112:127], v[144:147], v[56:59], v[112:127]
    s_addc_u32 s35, s35, 0
    v_cvt_pk_bf16_f32 v60, v48, v49
    v_exp_f32 v51, v51
    v_exp_f32 v52, v52
    v_cvt_pk_bf16_f32 v61, v50, v51
    v_exp_f32 v53, v53
    v_exp_f32 v54, v54
    v_exp_f32 v55, v55
    v_cvt_pk_bf16_f32 v62, v52, v53
    v_cvt_pk_bf16_f32 v63, v54, v55
    v_mfma_f32_32x32x16_bf16 v[40:55], v[128:131], v[12:15], 0
    s_waitcnt vmcnt(9)
    v_exp_f32 v24, v24
    v_exp_f32 v25, v25
    v_exp_f32 v26, v26
    v_exp_f32 v27, v27
    v_cvt_pk_bf16_f32 v56, v24, v25
    v_exp_f32 v28, v28
    v_mfma_f32_32x32x16_bf16 v[112:127], v[148:151], v[60:63], v[112:127]
    s_mov_b64 exec, s[20:21]
    global_load_dwordx4 v[144:147], v7, s[32:33] offset:1024
    global_load_dwordx4 v[148:151], v7, s[32:33] offset:1536
    s_mov_b64 exec, -1
    v_exp_f32 v29, v29
    v_cvt_pk_bf16_f32 v57, v26, v27
    v_exp_f32 v30, v30
    v_exp_f32 v31, v31
    v_cvt_pk_bf16_f32 v58, v28, v29
    v_exp_f32 v32, v32
    v_cvt_pk_bf16_f32 v59, v30, v31
    v_exp_f32 v33, v33
    v_exp_f32 v34, v34
    v_mfma_f32_32x32x16_bf16 v[64:79], v[132:135], v[56:59], v[64:79]
    v_cvt_pk_bf16_f32 v60, v32, v33
    v_exp_f32 v35, v35
    v_exp_f32 v36, v36
    v_cvt_pk_bf16_f32 v61, v34, v35
    v_exp_f32 v37, v37
    v_exp_f32 v38, v38
    v_exp_f32 v39, v39
    v_cvt_pk_bf16_f32 v62, v36, v37
    v_cvt_pk_bf16_f32 v63, v38, v39
    v_mfma_f32_32x32x16_bf16 v[24:39], v[128:131], v[16:19], 0
    s_add_u32 s30, s30, 4096
    v_exp_f32 v40, v40
    v_exp_f32 v41, v41
    v_exp_f32 v42, v42
    v_exp_f32 v43, v43
    v_cvt_pk_bf16_f32 v56, v40, v41
    v_exp_f32 v44, v44
    v_mfma_f32_32x32x16_bf16 v[64:79], v[136:139], v[60:63], v[64:79]
    global_load_dwordx4 a[112:115], v1, s[34:35] offset:-4096
    global_load_dwordx4 a[116:119], v1, s[34:35] offset:-3072
    global_load_dwordx4 a[120:123], v1, s[34:35] offset:-2048
    global_load_dwordx4 a[124:127], v1, s[34:35] offset:-1024
    v_exp_f32 v45, v45
    v_cvt_pk_bf16_f32 v57, v42, v43
    v_exp_f32 v46, v46
    v_exp_f32 v47, v47
    v_cvt_pk_bf16_f32 v58, v44, v45
    v_exp_f32 v48, v48
    v_cvt_pk_bf16_f32 v59, v46, v47
    v_exp_f32 v49, v49
    v_exp_f32 v50, v50
    v_mfma_f32_32x32x16_bf16 v[80:95], v[132:135], v[56:59], v[80:95]
    s_and_b32 s30, s30, 0x1ffff
    v_cvt_pk_bf16_f32 v60, v48, v49
    v_exp_f32 v51, v51
    v_exp_f32 v52, v52
    v_cvt_pk_bf16_f32 v61, v50, v51
    v_exp_f32 v53, v53
    v_exp_f32 v54, v54
    v_exp_f32 v55, v55
    v_cvt_pk_bf16_f32 v62, v52, v53
    v_cvt_pk_bf16_f32 v63, v54, v55
    v_mfma_f32_32x32x16_bf16 v[40:55], v[128:131], v[20:23], 0
    s_add_u32 s32, s30, s31
    v_exp_f32 v24, v24
    v_exp_f32 v25, v25
    v_exp_f32 v26, v26
    v_exp_f32 v27, v27
    v_cvt_pk_bf16_f32 v56, v24, v25
    v_exp_f32 v28, v28
    v_mfma_f32_32x32x16_bf16 v[80:95], v[136:139], v[60:63], v[80:95]
    s_addc_u32 s33, s38, 0
    v_exp_f32 v29, v29
    v_cvt_pk_bf16_f32 v57, v26, v27
    v_exp_f32 v30, v30
    v_exp_f32 v31, v31
    v_cvt_pk_bf16_f32 v58, v28, v29
    v_exp_f32 v32, v32
    v_cvt_pk_bf16_f32 v59, v30, v31
    v_exp_f32 v33, v33
    v_exp_f32 v34, v34
    v_mfma_f32_32x32x16_bf16 v[96:111], v[132:135], v[56:59], v[96:111]
    s_waitcnt vmcnt(9)
    s_and_b32 s24, s2, 7
    s_lshl_b32 s24, s24, 9
    s_add_u32 s24, s24, 4395008
    buffer_load_dword v159, v158, s[4:7], s24 offen sc1
    v_cvt_pk_bf16_f32 v60, v32, v33
    v_exp_f32 v35, v35
    v_exp_f32 v36, v36
    v_cvt_pk_bf16_f32 v61, v34, v35
    v_exp_f32 v37, v37
    v_exp_f32 v38, v38
    v_exp_f32 v39, v39
    v_cvt_pk_bf16_f32 v62, v36, v37
    v_cvt_pk_bf16_f32 v63, v38, v39
    v_mfma_f32_32x32x16_bf16 v[24:39], v[140:143], v[8:11], 0
    global_load_dwordx4 v[128:131], v1, s[32:33]
    global_load_dwordx4 a[128:131], v1, s[34:35] offset:0
    global_load_dwordx4 a[132:135], v1, s[34:35] offset:1024
    global_load_dwordx4 a[136:139], v1, s[34:35] offset:2048
    v_exp_f32 v40, v40
    v_exp_f32 v41, v41
    v_exp_f32 v42, v42
    v_exp_f32 v43, v43
    v_cvt_pk_bf16_f32 v56, v40, v41
    v_exp_f32 v44, v44
    v_mfma_f32_32x32x16_bf16 v[96:111], v[136:139], v[60:63], v[96:111]
    s_add_u32 s34, s34, 7168
    v_exp_f32 v45, v45
    v_cvt_pk_bf16_f32 v57, v42, v43
    v_exp_f32 v46, v46
    v_exp_f32 v47, v47
    v_cvt_pk_bf16_f32 v58, v44, v45
    v_exp_f32 v48, v48
    v_cvt_pk_bf16_f32 v59, v46, v47
    v_exp_f32 v49, v49
    v_exp_f32 v50, v50
    v_mfma_f32_32x32x16_bf16 v[112:127], v[132:135], v[56:59], v[112:127]
    s_addc_u32 s35, s35, 0
    v_cvt_pk_bf16_f32 v60, v48, v49
    v_exp_f32 v51, v51
    v_exp_f32 v52, v52
    v_cvt_pk_bf16_f32 v61, v50, v51
    v_exp_f32 v53, v53
    v_exp_f32 v54, v54
    v_exp_f32 v55, v55
    v_cvt_pk_bf16_f32 v62, v52, v53
    v_cvt_pk_bf16_f32 v63, v54, v55
    v_mfma_f32_32x32x16_bf16 v[40:55], v[140:143], v[12:15], 0
    s_waitcnt vmcnt(9)
    v_exp_f32 v24, v24
    v_exp_f32 v25, v25
    v_exp_f32 v26, v26
    v_exp_f32 v27, v27
    v_cvt_pk_bf16_f32 v56, v24, v25
    v_exp_f32 v28, v28
    v_mfma_f32_32x32x16_bf16 v[112:127], v[136:139], v[60:63], v[112:127]
    s_mov_b64 exec, s[20:21]
    global_load_dwordx4 v[132:135], v7, s[32:33] offset:1024
    global_load_dwordx4 v[136:139], v7, s[32:33] offset:1536
    s_mov_b64 exec, -1
    v_exp_f32 v29, v29
    v_cvt_pk_bf16_f32 v57, v26, v27
    v_exp_f32 v30, v30
    v_exp_f32 v31, v31
    v_cvt_pk_bf16_f32 v58, v28, v29
    v_exp_f32 v32, v32
    v_cvt_pk_bf16_f32 v59, v30, v31
    v_exp_f32 v33, v33
    v_exp_f32 v34, v34
    v_mfma_f32_32x32x16_bf16 v[64:79], v[144:147], v[56:59], v[64:79]
    v_cvt_pk_bf16_f32 v60, v32, v33
    v_exp_f32 v35, v35
    v_exp_f32 v36, v36
    v_cvt_pk_bf16_f32 v61, v34, v35
    v_exp_f32 v37, v37
    v_exp_f32 v38, v38
    v_exp_f32 v39, v39
    v_cvt_pk_bf16_f32 v62, v36, v37
    v_cvt_pk_bf16_f32 v63, v38, v39
    v_mfma_f32_32x32x16_bf16 v[24:39], v[140:143], v[16:19], 0
    s_add_u32 s30, s30, 4096
    v_exp_f32 v40, v40
    v_exp_f32 v41, v41
    v_exp_f32 v42, v42
    v_exp_f32 v43, v43
    v_cvt_pk_bf16_f32 v56, v40, v41
    v_exp_f32 v44, v44
    v_mfma_f32_32x32x16_bf16 v[64:79], v[148:151], v[60:63], v[64:79]
    global_load_dwordx4 a[140:143], v1, s[34:35] offset:-4096
    global_load_dwordx4 a[144:147], v1, s[34:35] offset:-3072
    global_load_dwordx4 a[148:151], v1, s[34:35] offset:-2048
    global_load_dwordx4 a[152:155], v1, s[34:35] offset:-1024
    v_exp_f32 v45, v45
    v_cvt_pk_bf16_f32 v57, v42, v43
    v_exp_f32 v46, v46
    v_exp_f32 v47, v47
    v_cvt_pk_bf16_f32 v58, v44, v45
    v_exp_f32 v48, v48
    v_cvt_pk_bf16_f32 v59, v46, v47
    v_exp_f32 v49, v49
    v_exp_f32 v50, v50
    v_mfma_f32_32x32x16_bf16 v[80:95], v[144:147], v[56:59], v[80:95]
    s_and_b32 s30, s30, 0x1ffff
    v_cvt_pk_bf16_f32 v60, v48, v49
    v_exp_f32 v51, v51
    v_exp_f32 v52, v52
    v_cvt_pk_bf16_f32 v61, v50, v51
    v_exp_f32 v53, v53
    v_exp_f32 v54, v54
    v_exp_f32 v55, v55
    v_cvt_pk_bf16_f32 v62, v52, v53
    v_cvt_pk_bf16_f32 v63, v54, v55
    v_mfma_f32_32x32x16_bf16 v[40:55], v[140:143], v[20:23], 0
    s_add_u32 s32, s30, s31
    v_exp_f32 v24, v24
    v_exp_f32 v25, v25
    v_exp_f32 v26, v26
    v_exp_f32 v27, v27
    v_cvt_pk_bf16_f32 v56, v24, v25
    v_exp_f32 v28, v28
    v_mfma_f32_32x32x16_bf16 v[80:95], v[148:151], v[60:63], v[80:95]
    s_addc_u32 s33, s38, 0
    v_exp_f32 v29, v29
    v_cvt_pk_bf16_f32 v57, v26, v27
    v_exp_f32 v30, v30
    v_exp_f32 v31, v31
    v_cvt_pk_bf16_f32 v58, v28, v29
    v_exp_f32 v32, v32
    v_cvt_pk_bf16_f32 v59, v30, v31
    v_exp_f32 v33, v33
    v_exp_f32 v34, v34
    v_mfma_f32_32x32x16_bf16 v[96:111], v[144:147], v[56:59], v[96:111]
    s_waitcnt vmcnt(9)
    v_cvt_pk_bf16_f32 v60, v32, v33
    v_exp_f32 v35, v35
    v_exp_f32 v36, v36
    v_cvt_pk_bf16_f32 v61, v34, v35
    v_exp_f32 v37, v37
    v_exp_f32 v38, v38
    v_exp_f32 v39, v39
    v_cvt_pk_bf16_f32 v62, v36, v37
    v_cvt_pk_bf16_f32 v63, v38, v39
    v_mfma_f32_32x32x16_bf16 v[24:39], v[128:131], v[8:11], 0
    global_load_dwordx4 v[140:143], v1, s[32:33]
    global_load_dwordx4 a[156:159], v1, s[34:35] offset:0
    global_load_dwordx4 a[160:163], v1, s[34:35] offset:1024
    global_load_dwordx4 a[164:167], v1, s[34:35] offset:2048
    v_exp_f32 v40, v40
    v_exp_f32 v41, v41
    v_exp_f32 v42, v42
    v_exp_f32 v43, v43
    v_cvt_pk_bf16_f32 v56, v40, v41
    v_exp_f32 v44, v44
    v_mfma_f32_32x32x16_bf16 v[96:111], v[148:151], v[60:63], v[96:111]
    s_add_u32 s34, s34, 7168
    v_exp_f32 v45, v45
    v_cvt_pk_bf16_f32 v57, v42, v43
    v_exp_f32 v46, v46
    v_exp_f32 v47, v47
    v_cvt_pk_bf16_f32 v58, v44, v45
    v_exp_f32 v48, v48
    v_cvt_pk_bf16_f32 v59, v46, v47
    v_exp_f32 v49, v49
    v_exp_f32 v50, v50
    v_mfma_f32_32x32x16_bf16 v[112:127], v[144:147], v[56:59], v[112:127]
    s_addc_u32 s35, s35, 0
    v_cvt_pk_bf16_f32 v60, v48, v49
    v_exp_f32 v51, v51
    v_exp_f32 v52, v52
    v_cvt_pk_bf16_f32 v61, v50, v51
    v_exp_f32 v53, v53
    v_exp_f32 v54, v54
    v_exp_f32 v55, v55
    v_cvt_pk_bf16_f32 v62, v52, v53
    v_cvt_pk_bf16_f32 v63, v54, v55
    v_mfma_f32_32x32x16_bf16 v[40:55], v[128:131], v[12:15], 0
    s_waitcnt vmcnt(8)
    v_exp_f32 v24, v24
    v_exp_f32 v25, v25
    v_exp_f32 v26, v26
    v_exp_f32 v27, v27
    v_cvt_pk_bf16_f32 v56, v24, v25
    v_exp_f32 v28, v28
    v_mfma_f32_32x32x16_bf16 v[112:127], v[148:151], v[60:63], v[112:127]
    s_mov_b64 exec, s[20:21]
    global_load_dwordx4 v[144:147], v7, s[32:33] offset:1024
    global_load_dwordx4 v[148:151], v7, s[32:33] offset:1536
    s_mov_b64 exec, -1
    v_exp_f32 v29, v29
    v_cvt_pk_bf16_f32 v57, v26, v27
    v_exp_f32 v30, v30
    v_exp_f32 v31, v31
    v_cvt_pk_bf16_f32 v58, v28, v29
    v_exp_f32 v32, v32
    v_cvt_pk_bf16_f32 v59, v30, v31
    v_exp_f32 v33, v33
    v_exp_f32 v34, v34
    v_mfma_f32_32x32x16_bf16 v[64:79], v[132:135], v[56:59], v[64:79]
    v_cvt_pk_bf16_f32 v60, v32, v33
    v_exp_f32 v35, v35
    v_exp_f32 v36, v36
    v_cvt_pk_bf16_f32 v61, v34, v35
    v_exp_f32 v37, v37
    v_exp_f32 v38, v38
    v_exp_f32 v39, v39
    v_cvt_pk_bf16_f32 v62, v36, v37
    v_cvt_pk_bf16_f32 v63, v38, v39
    v_mfma_f32_32x32x16_bf16 v[24:39], v[128:131], v[16:19], 0
    s_add_u32 s30, s30, 4096
    v_exp_f32 v40, v40
    v_exp_f32 v41, v41
    v_exp_f32 v42, v42
    v_exp_f32 v43, v43
    v_cvt_pk_bf16_f32 v56, v40, v41
    v_exp_f32 v44, v44
    v_mfma_f32_32x32x16_bf16 v[64:79], v[136:139], v[60:63], v[64:79]
    global_load_dwordx4 a[168:171], v1, s[34:35] offset:-4096
    global_load_dwordx4 a[172:175], v1, s[34:35] offset:-3072
    global_load_dwordx4 a[176:179], v1, s[34:35] offset:-2048
    global_load_dwordx4 a[180:183], v1, s[34:35] offset:-1024
    v_exp_f32 v45, v45
    v_cvt_pk_bf16_f32 v57, v42, v43
    v_exp_f32 v46, v46
    v_exp_f32 v47, v47
    v_cvt_pk_bf16_f32 v58, v44, v45
    v_exp_f32 v48, v48
    v_cvt_pk_bf16_f32 v59, v46, v47
    v_exp_f32 v49, v49
    v_exp_f32 v50, v50
    v_mfma_f32_32x32x16_bf16 v[80:95], v[132:135], v[56:59], v[80:95]
    s_and_b32 s30, s30, 0x1ffff
    v_cvt_pk_bf16_f32 v60, v48, v49
    v_exp_f32 v51, v51
    v_exp_f32 v52, v52
    v_cvt_pk_bf16_f32 v61, v50, v51
    v_exp_f32 v53, v53
    v_exp_f32 v54, v54
    v_exp_f32 v55, v55
    v_cvt_pk_bf16_f32 v62, v52, v53
    v_cvt_pk_bf16_f32 v63, v54, v55
    v_mfma_f32_32x32x16_bf16 v[40:55], v[128:131], v[20:23], 0
    s_add_u32 s32, s30, s31
    v_exp_f32 v24, v24
    v_exp_f32 v25, v25
    v_exp_f32 v26, v26
    v_exp_f32 v27, v27
    v_cvt_pk_bf16_f32 v56, v24, v25
    v_exp_f32 v28, v28
    v_mfma_f32_32x32x16_bf16 v[80:95], v[136:139], v[60:63], v[80:95]
    s_addc_u32 s33, s38, 0
    v_exp_f32 v29, v29
    v_cvt_pk_bf16_f32 v57, v26, v27
    v_exp_f32 v30, v30
    v_exp_f32 v31, v31
    v_cvt_pk_bf16_f32 v58, v28, v29
    v_exp_f32 v32, v32
    v_cvt_pk_bf16_f32 v59, v30, v31
    v_exp_f32 v33, v33
    v_exp_f32 v34, v34
    v_mfma_f32_32x32x16_bf16 v[96:111], v[132:135], v[56:59], v[96:111]
    s_waitcnt vmcnt(9)
    v_cmp_ne_u32 vcc, s61, v159
    s_nop 1
    s_cmp_lg_u64 vcc, 0
    s_cselect_b32 s23, 1, 0
    v_cvt_pk_bf16_f32 v60, v32, v33
    v_exp_f32 v35, v35
    v_exp_f32 v36, v36
    v_cvt_pk_bf16_f32 v61, v34, v35
    v_exp_f32 v37, v37
    v_exp_f32 v38, v38
    v_exp_f32 v39, v39
    v_cvt_pk_bf16_f32 v62, v36, v37
    v_cvt_pk_bf16_f32 v63, v38, v39
    v_mfma_f32_32x32x16_bf16 v[24:39], v[140:143], v[8:11], 0
    global_load_dwordx4 v[128:131], v1, s[32:33]
    global_load_dwordx4 a[184:187], v1, s[34:35] offset:0
    global_load_dwordx4 a[188:191], v1, s[34:35] offset:1024
    v_exp_f32 v40, v40
    v_exp_f32 v41, v41
    v_exp_f32 v42, v42
    v_exp_f32 v43, v43
    v_cvt_pk_bf16_f32 v56, v40, v41
    v_exp_f32 v44, v44
    v_mfma_f32_32x32x16_bf16 v[96:111], v[136:139], v[60:63], v[96:111]
    s_add_u32 s34, s4, s75
    v_exp_f32 v45, v45
    v_cvt_pk_bf16_f32 v57, v42, v43
    v_exp_f32 v46, v46
    v_exp_f32 v47, v47
    v_cvt_pk_bf16_f32 v58, v44, v45
    v_exp_f32 v48, v48
    v_cvt_pk_bf16_f32 v59, v46, v47
    v_exp_f32 v49, v49
    v_exp_f32 v50, v50
    v_mfma_f32_32x32x16_bf16 v[112:127], v[132:135], v[56:59], v[112:127]
    s_addc_u32 s35, s5, 0
    v_cvt_pk_bf16_f32 v60, v48, v49
    v_exp_f32 v51, v51
    v_exp_f32 v52, v52
    v_cvt_pk_bf16_f32 v61, v50, v51
    v_exp_f32 v53, v53
    v_exp_f32 v54, v54
    v_exp_f32 v55, v55
    v_cvt_pk_bf16_f32 v62, v52, v53
    v_cvt_pk_bf16_f32 v63, v54, v55
    v_mfma_f32_32x32x16_bf16 v[40:55], v[140:143], v[12:15], 0
    s_waitcnt vmcnt(7)
    v_exp_f32 v24, v24
    v_exp_f32 v25, v25
    v_exp_f32 v26, v26
    v_exp_f32 v27, v27
    v_cvt_pk_bf16_f32 v56, v24, v25
    v_exp_f32 v28, v28
    v_mfma_f32_32x32x16_bf16 v[112:127], v[136:139], v[60:63], v[112:127]
    s_mov_b64 exec, s[20:21]
    global_load_dwordx4 v[132:135], v7, s[32:33] offset:1024
    global_load_dwordx4 v[136:139], v7, s[32:33] offset:1536
    s_mov_b64 exec, -1
    v_exp_f32 v29, v29
    v_cvt_pk_bf16_f32 v57, v26, v27
    v_exp_f32 v30, v30
    v_exp_f32 v31, v31
    v_cvt_pk_bf16_f32 v58, v28, v29
    v_exp_f32 v32, v32
    v_cvt_pk_bf16_f32 v59, v30, v31
    v_exp_f32 v33, v33
    v_exp_f32 v34, v34
    v_mfma_f32_32x32x16_bf16 v[64:79], v[144:147], v[56:59], v[64:79]
    v_cvt_pk_bf16_f32 v60, v32, v33
    v_exp_f32 v35, v35
    v_exp_f32 v36, v36
    v_cvt_pk_bf16_f32 v61, v34, v35
    v_exp_f32 v37, v37
    v_exp_f32 v38, v38
    v_exp_f32 v39, v39
    v_cvt_pk_bf16_f32 v62, v36, v37
    v_cvt_pk_bf16_f32 v63, v38, v39
    v_mfma_f32_32x32x16_bf16 v[24:39], v[140:143], v[16:19], 0
    s_add_u32 s30, s30, 4096
    v_exp_f32 v40, v40
    v_exp_f32 v41, v41
    v_exp_f32 v42, v42
    v_exp_f32 v43, v43
    v_cvt_pk_bf16_f32 v56, v40, v41
    v_exp_f32 v44, v44
    v_mfma_f32_32x32x16_bf16 v[64:79], v[148:151], v[60:63], v[64:79]
    global_load_dwordx4 a[192:195], v1, s[34:35] offset:-3072
    global_load_dwordx4 a[196:199], v1, s[34:35] offset:-2048
    global_load_dwordx4 a[200:203], v1, s[34:35] offset:-1024
    global_load_dwordx4 a[204:207], v1, s[34:35] offset:0
    v_exp_f32 v45, v45
    v_cvt_pk_bf16_f32 v57, v42, v43
    v_exp_f32 v46, v46
    v_exp_f32 v47, v47
    v_cvt_pk_bf16_f32 v58, v44, v45
    v_exp_f32 v48, v48
    v_cvt_pk_bf16_f32 v59, v46, v47
    v_exp_f32 v49, v49
    v_exp_f32 v50, v50
    v_mfma_f32_32x32x16_bf16 v[80:95], v[144:147], v[56:59], v[80:95]
    s_and_b32 s30, s30, 0x1ffff
    v_cvt_pk_bf16_f32 v60, v48, v49
    v_exp_f32 v51, v51
    v_exp_f32 v52, v52
    v_cvt_pk_bf16_f32 v61, v50, v51
    v_exp_f32 v53, v53
    v_exp_f32 v54, v54
    v_exp_f32 v55, v55
    v_cvt_pk_bf16_f32 v62, v52, v53
    v_cvt_pk_bf16_f32 v63, v54, v55
    v_mfma_f32_32x32x16_bf16 v[40:55], v[140:143], v[20:23], 0
    s_add_u32 s32, s30, s31
    v_exp_f32 v24, v24
    v_exp_f32 v25, v25
    v_exp_f32 v26, v26
    v_exp_f32 v27, v27
    v_cvt_pk_bf16_f32 v56, v24, v25
    v_exp_f32 v28, v28
    v_mfma_f32_32x32x16_bf16 v[80:95], v[148:151], v[60:63], v[80:95]
    s_addc_u32 s33, s38, 0
    v_exp_f32 v29, v29
    v_cvt_pk_bf16_f32 v57, v26, v27
    v_exp_f32 v30, v30
    v_exp_f32 v31, v31
    v_cvt_pk_bf16_f32 v58, v28, v29
    v_exp_f32 v32, v32
    v_cvt_pk_bf16_f32 v59, v30, v31
    v_exp_f32 v33, v33
    v_exp_f32 v34, v34
    v_mfma_f32_32x32x16_bf16 v[96:111], v[144:147], v[56:59], v[96:111]
    s_waitcnt vmcnt(8)
    v_cvt_pk_bf16_f32 v60, v32, v33
    v_exp_f32 v35, v35
    v_exp_f32 v36, v36
    v_cvt_pk_bf16_f32 v61, v34, v35
    v_exp_f32 v37, v37
    v_exp_f32 v38, v38
    v_exp_f32 v39, v39
    v_cvt_pk_bf16_f32 v62, v36, v37
    v_cvt_pk_bf16_f32 v63, v38, v39
    v_mfma_f32_32x32x16_bf16 v[24:39], v[128:131], v[8:11], 0
    global_load_dwordx4 v[140:143], v1, s[32:33]
    global_load_dwordx4 a[208:211], v1, s[34:35] offset:1024
    global_load_dwordx4 a[212:215], v1, s[34:35] offset:2048
    global_load_dwordx4 a[216:219], v1, s[34:35] offset:3072
    v_exp_f32 v40, v40
    v_exp_f32 v41, v41
    v_exp_f32 v42, v42
    v_exp_f32 v43, v43
    v_cvt_pk_bf16_f32 v56, v40, v41
    v_exp_f32 v44, v44
    v_mfma_f32_32x32x16_bf16 v[96:111], v[148:151], v[60:63], v[96:111]
    s_add_u32 s34, s34, 7168
    v_exp_f32 v45, v45
    v_cvt_pk_bf16_f32 v57, v42, v43
    v_exp_f32 v46, v46
    v_exp_f32 v47, v47
    v_cvt_pk_bf16_f32 v58, v44, v45
    v_exp_f32 v48, v48
    v_cvt_pk_bf16_f32 v59, v46, v47
    v_exp_f32 v49, v49
    v_exp_f32 v50, v50
    v_mfma_f32_32x32x16_bf16 v[112:127], v[144:147], v[56:59], v[112:127]
    s_addc_u32 s35, s35, 0
    v_cvt_pk_bf16_f32 v60, v48, v49
    v_exp_f32 v51, v51
    v_exp_f32 v52, v52
    v_cvt_pk_bf16_f32 v61, v50, v51
    v_exp_f32 v53, v53
    v_exp_f32 v54, v54
    v_exp_f32 v55, v55
    v_cvt_pk_bf16_f32 v62, v52, v53
    v_cvt_pk_bf16_f32 v63, v54, v55
    v_mfma_f32_32x32x16_bf16 v[40:55], v[128:131], v[12:15], 0
    s_waitcnt vmcnt(8)
    v_exp_f32 v24, v24
    v_exp_f32 v25, v25
    v_exp_f32 v26, v26
    v_exp_f32 v27, v27
    v_cvt_pk_bf16_f32 v56, v24, v25
    v_exp_f32 v28, v28
    v_mfma_f32_32x32x16_bf16 v[112:127], v[148:151], v[60:63], v[112:127]
    s_mov_b64 exec, s[20:21]
    global_load_dwordx4 v[144:147], v7, s[32:33] offset:1024
    global_load_dwordx4 v[148:151], v7, s[32:33] offset:1536
    s_mov_b64 exec, -1
    v_exp_f32 v29, v29
    v_cvt_pk_bf16_f32 v57, v26, v27
    v_exp_f32 v30, v30
    v_exp_f32 v31, v31
    v_cvt_pk_bf16_f32 v58, v28, v29
    v_exp_f32 v32, v32
    v_cvt_pk_bf16_f32 v59, v30, v31
    v_exp_f32 v33, v33
    v_exp_f32 v34, v34
    v_mfma_f32_32x32x16_bf16 v[64:79], v[132:135], v[56:59], v[64:79]
    v_cvt_pk_bf16_f32 v60, v32, v33
    v_exp_f32 v35, v35
    v_exp_f32 v36, v36
    v_cvt_pk_bf16_f32 v61, v34, v35
    v_exp_f32 v37, v37
    v_exp_f32 v38, v38
    v_exp_f32 v39, v39
    v_cvt_pk_bf16_f32 v62, v36, v37
    v_cvt_pk_bf16_f32 v63, v38, v39
    v_mfma_f32_32x32x16_bf16 v[24:39], v[128:131], v[16:19], 0
    s_add_u32 s30, s30, 4096
    v_exp_f32 v40, v40
    v_exp_f32 v41, v41
    v_exp_f32 v42, v42
    v_exp_f32 v43, v43
    v_cvt_pk_bf16_f32 v56, v40, v41
    v_exp_f32 v44, v44
    v_mfma_f32_32x32x16_bf16 v[64:79], v[136:139], v[60:63], v[64:79]
    global_load_dwordx4 a[220:223], v1, s[34:35] offset:-3072
    global_load_dwordx4 a[224:227], v1, s[34:35] offset:-2048
    global_load_dwordx4 a[228:231], v1, s[34:35] offset:-1024
    global_load_dwordx4 a[232:235], v1, s[34:35] offset:0
    v_exp_f32 v45, v45
    v_cvt_pk_bf16_f32 v57, v42, v43
    v_exp_f32 v46, v46
    v_exp_f32 v47, v47
    v_cvt_pk_bf16_f32 v58, v44, v45
    v_exp_f32 v48, v48
    v_cvt_pk_bf16_f32 v59, v46, v47
    v_exp_f32 v49, v49
    v_exp_f32 v50, v50
    v_mfma_f32_32x32x16_bf16 v[80:95], v[132:135], v[56:59], v[80:95]
    s_and_b32 s30, s30, 0x1ffff
    v_cvt_pk_bf16_f32 v60, v48, v49
    v_exp_f32 v51, v51
    v_exp_f32 v52, v52
    v_cvt_pk_bf16_f32 v61, v50, v51
    v_exp_f32 v53, v53
    v_exp_f32 v54, v54
    v_exp_f32 v55, v55
    v_cvt_pk_bf16_f32 v62, v52, v53
    v_cvt_pk_bf16_f32 v63, v54, v55
    v_mfma_f32_32x32x16_bf16 v[40:55], v[128:131], v[20:23], 0
    s_add_u32 s32, s30, s31
    v_exp_f32 v24, v24
    v_exp_f32 v25, v25
    v_exp_f32 v26, v26
    v_exp_f32 v27, v27
    v_cvt_pk_bf16_f32 v56, v24, v25
    v_exp_f32 v28, v28
    v_mfma_f32_32x32x16_bf16 v[80:95], v[136:139], v[60:63], v[80:95]
    s_addc_u32 s33, s38, 0
    v_exp_f32 v29, v29
    v_cvt_pk_bf16_f32 v57, v26, v27
    v_exp_f32 v30, v30
    v_exp_f32 v31, v31
    v_cvt_pk_bf16_f32 v58, v28, v29
    v_exp_f32 v32, v32
    v_cvt_pk_bf16_f32 v59, v30, v31
    v_exp_f32 v33, v33
    v_exp_f32 v34, v34
    v_mfma_f32_32x32x16_bf16 v[96:111], v[132:135], v[56:59], v[96:111]
    s_waitcnt vmcnt(9)
    v_cvt_pk_bf16_f32 v60, v32, v33
    v_exp_f32 v35, v35
    v_exp_f32 v36, v36
    v_cvt_pk_bf16_f32 v61, v34, v35
    v_exp_f32 v37, v37
    v_exp_f32 v38, v38
    v_exp_f32 v39, v39
    v_cvt_pk_bf16_f32 v62, v36, v37
    v_cvt_pk_bf16_f32 v63, v38, v39
    v_mfma_f32_32x32x16_bf16 v[24:39], v[140:143], v[8:11], 0
    global_load_dwordx4 v[128:131], v1, s[32:33]
    global_load_dwordx4 a[236:239], v1, s[34:35] offset:1024
    global_load_dwordx4 a[240:243], v1, s[34:35] offset:2048
    global_load_dwordx4 a[244:247], v1, s[34:35] offset:3072
    v_exp_f32 v40, v40
    v_exp_f32 v41, v41
    v_exp_f32 v42, v42
    v_exp_f32 v43, v43
    v_cvt_pk_bf16_f32 v56, v40, v41
    v_exp_f32 v44, v44
    v_mfma_f32_32x32x16_bf16 v[96:111], v[136:139], v[60:63], v[96:111]
    s_add_u32 s34, s34, 7168
    v_exp_f32 v45, v45
    v_cvt_pk_bf16_f32 v57, v42, v43
    v_exp_f32 v46, v46
    v_exp_f32 v47, v47
    v_cvt_pk_bf16_f32 v58, v44, v45
    v_exp_f32 v48, v48
    v_cvt_pk_bf16_f32 v59, v46, v47
    v_exp_f32 v49, v49
    v_exp_f32 v50, v50
    v_mfma_f32_32x32x16_bf16 v[112:127], v[132:135], v[56:59], v[112:127]
    s_addc_u32 s35, s35, 0
    v_cvt_pk_bf16_f32 v60, v48, v49
    v_exp_f32 v51, v51
    v_exp_f32 v52, v52
    v_cvt_pk_bf16_f32 v61, v50, v51
    v_exp_f32 v53, v53
    v_exp_f32 v54, v54
    v_exp_f32 v55, v55
    v_cvt_pk_bf16_f32 v62, v52, v53
    v_cvt_pk_bf16_f32 v63, v54, v55
    v_mfma_f32_32x32x16_bf16 v[40:55], v[140:143], v[12:15], 0
    s_waitcnt vmcnt(8)
    v_exp_f32 v24, v24
    v_exp_f32 v25, v25
    v_exp_f32 v26, v26
    v_exp_f32 v27, v27
    v_cvt_pk_bf16_f32 v56, v24, v25
    v_exp_f32 v28, v28
    v_mfma_f32_32x32x16_bf16 v[112:127], v[136:139], v[60:63], v[112:127]
    s_mov_b64 exec, s[20:21]
    global_load_dwordx4 v[132:135], v7, s[32:33] offset:1024
    global_load_dwordx4 v[136:139], v7, s[32:33] offset:1536
    s_mov_b64 exec, -1
    v_exp_f32 v29, v29
    v_cvt_pk_bf16_f32 v57, v26, v27
    v_exp_f32 v30, v30
    v_exp_f32 v31, v31
    v_cvt_pk_bf16_f32 v58, v28, v29
    v_exp_f32 v32, v32
    v_cvt_pk_bf16_f32 v59, v30, v31
    v_exp_f32 v33, v33
    v_exp_f32 v34, v34
    v_mfma_f32_32x32x16_bf16 v[64:79], v[144:147], v[56:59], v[64:79]
    v_cvt_pk_bf16_f32 v60, v32, v33
    v_exp_f32 v35, v35
    v_exp_f32 v36, v36
    v_cvt_pk_bf16_f32 v61, v34, v35
    v_exp_f32 v37, v37
    v_exp_f32 v38, v38
    v_exp_f32 v39, v39
    v_cvt_pk_bf16_f32 v62, v36, v37
    v_cvt_pk_bf16_f32 v63, v38, v39
    v_mfma_f32_32x32x16_bf16 v[24:39], v[140:143], v[16:19], 0
    s_add_u32 s30, s30, 4096
    v_exp_f32 v40, v40
    v_exp_f32 v41, v41
    v_exp_f32 v42, v42
    v_exp_f32 v43, v43
    v_cvt_pk_bf16_f32 v56, v40, v41
    v_exp_f32 v44, v44
    v_mfma_f32_32x32x16_bf16 v[64:79], v[148:151], v[60:63], v[64:79]
    global_load_dwordx4 a[248:251], v1, s[34:35] offset:-3072
    global_load_dwordx4 a[252:255], v1, s[34:35] offset:-2048
    global_load_dwordx4 v[152:155], v1, s[34:35] offset:-1024
    global_load_dwordx4 v[156:159], v1, s[34:35] offset:0
    v_exp_f32 v45, v45
    v_cvt_pk_bf16_f32 v57, v42, v43
    v_exp_f32 v46, v46
    v_exp_f32 v47, v47
    v_cvt_pk_bf16_f32 v58, v44, v45
    v_exp_f32 v48, v48
    v_cvt_pk_bf16_f32 v59, v46, v47
    v_exp_f32 v49, v49
    v_exp_f32 v50, v50
    v_mfma_f32_32x32x16_bf16 v[80:95], v[144:147], v[56:59], v[80:95]
    s_and_b32 s30, s30, 0x1ffff
    v_cvt_pk_bf16_f32 v60, v48, v49
    v_exp_f32 v51, v51
    v_exp_f32 v52, v52
    v_cvt_pk_bf16_f32 v61, v50, v51
    v_exp_f32 v53, v53
    v_exp_f32 v54, v54
    v_exp_f32 v55, v55
    v_cvt_pk_bf16_f32 v62, v52, v53
    v_cvt_pk_bf16_f32 v63, v54, v55
    v_mfma_f32_32x32x16_bf16 v[40:55], v[140:143], v[20:23], 0
    s_add_u32 s32, s30, s31
    v_exp_f32 v24, v24
    v_exp_f32 v25, v25
    v_exp_f32 v26, v26
    v_exp_f32 v27, v27
    v_cvt_pk_bf16_f32 v56, v24, v25
    v_exp_f32 v28, v28
    v_mfma_f32_32x32x16_bf16 v[80:95], v[148:151], v[60:63], v[80:95]
    s_addc_u32 s33, s38, 0
    v_exp_f32 v29, v29
    v_cvt_pk_bf16_f32 v57, v26, v27
    v_exp_f32 v30, v30
    v_exp_f32 v31, v31
    v_cvt_pk_bf16_f32 v58, v28, v29
    v_exp_f32 v32, v32
    v_cvt_pk_bf16_f32 v59, v30, v31
    v_exp_f32 v33, v33
    v_exp_f32 v34, v34
    v_mfma_f32_32x32x16_bf16 v[96:111], v[144:147], v[56:59], v[96:111]
    s_waitcnt vmcnt(9)
    v_cvt_pk_bf16_f32 v60, v32, v33
    v_exp_f32 v35, v35
    v_exp_f32 v36, v36
    v_cvt_pk_bf16_f32 v61, v34, v35
    v_exp_f32 v37, v37
    v_exp_f32 v38, v38
    v_exp_f32 v39, v39
    v_cvt_pk_bf16_f32 v62, v36, v37
    v_cvt_pk_bf16_f32 v63, v38, v39
    v_mfma_f32_32x32x16_bf16 v[24:39], v[128:131], v[8:11], 0
    global_load_dwordx4 v[140:143], v1, s[32:33]
    global_load_dwordx4 v[160:163], v1, s[34:35] offset:1024
    global_load_dwordx4 v[164:167], v1, s[34:35] offset:2048
    global_load_dwordx4 v[168:171], v1, s[34:35] offset:3072
    v_exp_f32 v40, v40
    v_exp_f32 v41, v41
    v_exp_f32 v42, v42
    v_exp_f32 v43, v43
    v_cvt_pk_bf16_f32 v56, v40, v41
    v_exp_f32 v44, v44
    v_mfma_f32_32x32x16_bf16 v[96:111], v[148:151], v[60:63], v[96:111]
    s_add_u32 s34, s34, 7168
    v_exp_f32 v45, v45
    v_cvt_pk_bf16_f32 v57, v42, v43
    v_exp_f32 v46, v46
    v_exp_f32 v47, v47
    v_cvt_pk_bf16_f32 v58, v44, v45
    v_exp_f32 v48, v48
    v_cvt_pk_bf16_f32 v59, v46, v47
    v_exp_f32 v49, v49
    v_exp_f32 v50, v50
    v_mfma_f32_32x32x16_bf16 v[112:127], v[144:147], v[56:59], v[112:127]
    s_addc_u32 s35, s35, 0
    v_cvt_pk_bf16_f32 v60, v48, v49
    v_exp_f32 v51, v51
    v_exp_f32 v52, v52
    v_cvt_pk_bf16_f32 v61, v50, v51
    v_exp_f32 v53, v53
    v_exp_f32 v54, v54
    v_exp_f32 v55, v55
    v_cvt_pk_bf16_f32 v62, v52, v53
    v_cvt_pk_bf16_f32 v63, v54, v55
    v_mfma_f32_32x32x16_bf16 v[40:55], v[128:131], v[12:15], 0
    s_waitcnt vmcnt(8)
    v_exp_f32 v24, v24
    v_exp_f32 v25, v25
    v_exp_f32 v26, v26
    v_exp_f32 v27, v27
    v_cvt_pk_bf16_f32 v56, v24, v25
    v_exp_f32 v28, v28
    v_mfma_f32_32x32x16_bf16 v[112:127], v[148:151], v[60:63], v[112:127]
    s_mov_b64 exec, s[20:21]
    global_load_dwordx4 v[144:147], v7, s[32:33] offset:1024
    global_load_dwordx4 v[148:151], v7, s[32:33] offset:1536
    s_mov_b64 exec, -1
    v_exp_f32 v29, v29
    v_cvt_pk_bf16_f32 v57, v26, v27
    v_exp_f32 v30, v30
    v_exp_f32 v31, v31
    v_cvt_pk_bf16_f32 v58, v28, v29
    v_exp_f32 v32, v32
    v_cvt_pk_bf16_f32 v59, v30, v31
    v_exp_f32 v33, v33
    v_exp_f32 v34, v34
    v_mfma_f32_32x32x16_bf16 v[64:79], v[132:135], v[56:59], v[64:79]
    v_cvt_pk_bf16_f32 v60, v32, v33
    v_exp_f32 v35, v35
    v_exp_f32 v36, v36
    v_cvt_pk_bf16_f32 v61, v34, v35
    v_exp_f32 v37, v37
    v_exp_f32 v38, v38
    v_exp_f32 v39, v39
    v_cvt_pk_bf16_f32 v62, v36, v37
    v_cvt_pk_bf16_f32 v63, v38, v39
    v_mfma_f32_32x32x16_bf16 v[24:39], v[128:131], v[16:19], 0
    s_add_u32 s30, s30, 4096
    v_exp_f32 v40, v40
    v_exp_f32 v41, v41
    v_exp_f32 v42, v42
    v_exp_f32 v43, v43
    v_cvt_pk_bf16_f32 v56, v40, v41
    v_exp_f32 v44, v44
    v_mfma_f32_32x32x16_bf16 v[64:79], v[136:139], v[60:63], v[64:79]
    global_load_dwordx4 v[172:175], v1, s[34:35] offset:-3072
    global_load_dwordx4 v[176:179], v1, s[34:35] offset:-2048
    global_load_dwordx4 v[180:183], v1, s[34:35] offset:-1024
    global_load_dwordx4 v[184:187], v1, s[34:35] offset:0
    v_exp_f32 v45, v45
    v_cvt_pk_bf16_f32 v57, v42, v43
    v_exp_f32 v46, v46
    v_exp_f32 v47, v47
    v_cvt_pk_bf16_f32 v58, v44, v45
    v_exp_f32 v48, v48
    v_cvt_pk_bf16_f32 v59, v46, v47
    v_exp_f32 v49, v49
    v_exp_f32 v50, v50
    v_mfma_f32_32x32x16_bf16 v[80:95], v[132:135], v[56:59], v[80:95]
    s_and_b32 s30, s30, 0x1ffff
    v_cvt_pk_bf16_f32 v60, v48, v49
    v_exp_f32 v51, v51
    v_exp_f32 v52, v52
    v_cvt_pk_bf16_f32 v61, v50, v51
    v_exp_f32 v53, v53
    v_exp_f32 v54, v54
    v_exp_f32 v55, v55
    v_cvt_pk_bf16_f32 v62, v52, v53
    v_cvt_pk_bf16_f32 v63, v54, v55
    v_mfma_f32_32x32x16_bf16 v[40:55], v[128:131], v[20:23], 0
    s_add_u32 s32, s30, s31
    v_exp_f32 v24, v24
    v_exp_f32 v25, v25
    v_exp_f32 v26, v26
    v_exp_f32 v27, v27
    v_cvt_pk_bf16_f32 v56, v24, v25
    v_exp_f32 v28, v28
    v_mfma_f32_32x32x16_bf16 v[80:95], v[136:139], v[60:63], v[80:95]
    s_addc_u32 s33, s38, 0
    v_exp_f32 v29, v29
    v_cvt_pk_bf16_f32 v57, v26, v27
    v_exp_f32 v30, v30
    v_exp_f32 v31, v31
    v_cvt_pk_bf16_f32 v58, v28, v29
    v_exp_f32 v32, v32
    v_cvt_pk_bf16_f32 v59, v30, v31
    v_exp_f32 v33, v33
    v_exp_f32 v34, v34
    v_mfma_f32_32x32x16_bf16 v[96:111], v[132:135], v[56:59], v[96:111]
    s_waitcnt vmcnt(9)
    v_cvt_pk_bf16_f32 v60, v32, v33
    v_exp_f32 v35, v35
    v_exp_f32 v36, v36
    v_cvt_pk_bf16_f32 v61, v34, v35
    v_exp_f32 v37, v37
    v_exp_f32 v38, v38
    v_exp_f32 v39, v39
    v_cvt_pk_bf16_f32 v62, v36, v37
    v_cvt_pk_bf16_f32 v63, v38, v39
    v_mfma_f32_32x32x16_bf16 v[24:39], v[140:143], v[8:11], 0
    global_load_dwordx4 v[128:131], v1, s[32:33]
    global_load_dwordx4 v[188:191], v1, s[34:35] offset:1024
    global_load_dwordx4 v[192:195], v1, s[34:35] offset:2048
    global_load_dwordx4 v[196:199], v1, s[34:35] offset:3072
    v_exp_f32 v40, v40
    v_exp_f32 v41, v41
    v_exp_f32 v42, v42
    v_exp_f32 v43, v43
    v_cvt_pk_bf16_f32 v56, v40, v41
    v_exp_f32 v44, v44
    v_mfma_f32_32x32x16_bf16 v[96:111], v[136:139], v[60:63], v[96:111]
    s_add_u32 s34, s34, 7168
    v_exp_f32 v45, v45
    v_cvt_pk_bf16_f32 v57, v42, v43
    v_exp_f32 v46, v46
    v_exp_f32 v47, v47
    v_cvt_pk_bf16_f32 v58, v44, v45
    v_exp_f32 v48, v48
    v_cvt_pk_bf16_f32 v59, v46, v47
    v_exp_f32 v49, v49
    v_exp_f32 v50, v50
    v_mfma_f32_32x32x16_bf16 v[112:127], v[132:135], v[56:59], v[112:127]
    s_addc_u32 s35, s35, 0
    v_cvt_pk_bf16_f32 v60, v48, v49
    v_exp_f32 v51, v51
    v_exp_f32 v52, v52
    v_cvt_pk_bf16_f32 v61, v50, v51
    v_exp_f32 v53, v53
    v_exp_f32 v54, v54
    v_exp_f32 v55, v55
    v_cvt_pk_bf16_f32 v62, v52, v53
    v_cvt_pk_bf16_f32 v63, v54, v55
    v_mfma_f32_32x32x16_bf16 v[40:55], v[140:143], v[12:15], 0
    s_waitcnt vmcnt(8)
    v_exp_f32 v24, v24
    v_exp_f32 v25, v25
    v_exp_f32 v26, v26
    v_exp_f32 v27, v27
    v_cvt_pk_bf16_f32 v56, v24, v25
    v_exp_f32 v28, v28
    v_mfma_f32_32x32x16_bf16 v[112:127], v[136:139], v[60:63], v[112:127]
    s_mov_b64 exec, s[20:21]
    global_load_dwordx4 v[132:135], v7, s[32:33] offset:1024
    global_load_dwordx4 v[136:139], v7, s[32:33] offset:1536
    s_mov_b64 exec, -1
    v_exp_f32 v29, v29
    v_cvt_pk_bf16_f32 v57, v26, v27
    v_exp_f32 v30, v30
    v_exp_f32 v31, v31
    v_cvt_pk_bf16_f32 v58, v28, v29
    v_exp_f32 v32, v32
    v_cvt_pk_bf16_f32 v59, v30, v31
    v_exp_f32 v33, v33
    v_exp_f32 v34, v34
    v_mfma_f32_32x32x16_bf16 v[64:79], v[144:147], v[56:59], v[64:79]
    v_cvt_pk_bf16_f32 v60, v32, v33
    v_exp_f32 v35, v35
    v_exp_f32 v36, v36
    v_cvt_pk_bf16_f32 v61, v34, v35
    v_exp_f32 v37, v37
    v_exp_f32 v38, v38
    v_exp_f32 v39, v39
    v_cvt_pk_bf16_f32 v62, v36, v37
    v_cvt_pk_bf16_f32 v63, v38, v39
    v_mfma_f32_32x32x16_bf16 v[24:39], v[140:143], v[16:19], 0
    s_add_u32 s30, s30, 4096
    v_exp_f32 v40, v40
    v_exp_f32 v41, v41
    v_exp_f32 v42, v42
    v_exp_f32 v43, v43
    v_cvt_pk_bf16_f32 v56, v40, v41
    v_exp_f32 v44, v44
    v_mfma_f32_32x32x16_bf16 v[64:79], v[148:151], v[60:63], v[64:79]
    global_load_dwordx4 v[200:203], v1, s[34:35] offset:-3072
    global_load_dwordx4 v[204:207], v1, s[34:35] offset:-2048
    global_load_dwordx4 v[208:211], v1, s[34:35] offset:-1024
    global_load_dwordx4 v[212:215], v1, s[34:35] offset:0
    v_exp_f32 v45, v45
    v_cvt_pk_bf16_f32 v57, v42, v43
    v_exp_f32 v46, v46
    v_exp_f32 v47, v47
    v_cvt_pk_bf16_f32 v58, v44, v45
    v_exp_f32 v48, v48
    v_cvt_pk_bf16_f32 v59, v46, v47
    v_exp_f32 v49, v49
    v_exp_f32 v50, v50
    v_mfma_f32_32x32x16_bf16 v[80:95], v[144:147], v[56:59], v[80:95]
    s_and_b32 s30, s30, 0x1ffff
    v_cvt_pk_bf16_f32 v60, v48, v49
    v_exp_f32 v51, v51
    v_exp_f32 v52, v52
    v_cvt_pk_bf16_f32 v61, v50, v51
    v_exp_f32 v53, v53
    v_exp_f32 v54, v54
    v_exp_f32 v55, v55
    v_cvt_pk_bf16_f32 v62, v52, v53
    v_cvt_pk_bf16_f32 v63, v54, v55
    v_mfma_f32_32x32x16_bf16 v[40:55], v[140:143], v[20:23], 0
    s_add_u32 s32, s30, s31
    v_exp_f32 v24, v24
    v_exp_f32 v25, v25
    v_exp_f32 v26, v26
    v_exp_f32 v27, v27
    v_cvt_pk_bf16_f32 v56, v24, v25
    v_exp_f32 v28, v28
    v_mfma_f32_32x32x16_bf16 v[80:95], v[148:151], v[60:63], v[80:95]
    s_addc_u32 s33, s38, 0
    v_exp_f32 v29, v29
    v_cvt_pk_bf16_f32 v57, v26, v27
    v_exp_f32 v30, v30
    v_exp_f32 v31, v31
    v_cvt_pk_bf16_f32 v58, v28, v29
    v_exp_f32 v32, v32
    v_cvt_pk_bf16_f32 v59, v30, v31
    v_exp_f32 v33, v33
    v_exp_f32 v34, v34
    v_mfma_f32_32x32x16_bf16 v[96:111], v[144:147], v[56:59], v[96:111]
    s_waitcnt vmcnt(9)
    v_cvt_pk_bf16_f32 v60, v32, v33
    v_exp_f32 v35, v35
    v_exp_f32 v36, v36
    v_cvt_pk_bf16_f32 v61, v34, v35
    v_exp_f32 v37, v37
    v_exp_f32 v38, v38
    v_exp_f32 v39, v39
    v_cvt_pk_bf16_f32 v62, v36, v37
    v_cvt_pk_bf16_f32 v63, v38, v39
    v_mfma_f32_32x32x16_bf16 v[24:39], v[128:131], v[8:11], 0
    global_load_dwordx4 v[140:143], v1, s[32:33]
    global_load_dwordx4 v[216:219], v1, s[34:35] offset:1024
    global_load_dwordx4 v[220:223], v1, s[34:35] offset:2048
    global_load_dwordx4 v[224:227], v1, s[34:35] offset:3072
    v_exp_f32 v40, v40
    v_exp_f32 v41, v41
    v_exp_f32 v42, v42
    v_exp_f32 v43, v43
    v_cvt_pk_bf16_f32 v56, v40, v41
    v_exp_f32 v44, v44
    v_mfma_f32_32x32x16_bf16 v[96:111], v[148:151], v[60:63], v[96:111]
    s_add_u32 s34, s34, 7168
    v_exp_f32 v45, v45
    v_cvt_pk_bf16_f32 v57, v42, v43
    v_exp_f32 v46, v46
    v_exp_f32 v47, v47
    v_cvt_pk_bf16_f32 v58, v44, v45
    v_exp_f32 v48, v48
    v_cvt_pk_bf16_f32 v59, v46, v47
    v_exp_f32 v49, v49
    v_exp_f32 v50, v50
    v_mfma_f32_32x32x16_bf16 v[112:127], v[144:147], v[56:59], v[112:127]
    s_addc_u32 s35, s35, 0
    v_cvt_pk_bf16_f32 v60, v48, v49
    v_exp_f32 v51, v51
    v_exp_f32 v52, v52
    v_cvt_pk_bf16_f32 v61, v50, v51
    v_exp_f32 v53, v53
    v_exp_f32 v54, v54
    v_exp_f32 v55, v55
    v_cvt_pk_bf16_f32 v62, v52, v53
    v_cvt_pk_bf16_f32 v63, v54, v55
    v_mfma_f32_32x32x16_bf16 v[40:55], v[128:131], v[12:15], 0
    s_waitcnt vmcnt(8)
    v_exp_f32 v24, v24
    v_exp_f32 v25, v25
    v_exp_f32 v26, v26
    v_exp_f32 v27, v27
    v_cvt_pk_bf16_f32 v56, v24, v25
    v_exp_f32 v28, v28
    v_mfma_f32_32x32x16_bf16 v[112:127], v[148:151], v[60:63], v[112:127]
    s_mov_b64 exec, s[20:21]
    global_load_dwordx4 v[144:147], v7, s[32:33] offset:1024
    global_load_dwordx4 v[148:151], v7, s[32:33] offset:1536
    s_mov_b64 exec, -1
    v_exp_f32 v29, v29
    v_cvt_pk_bf16_f32 v57, v26, v27
    v_exp_f32 v30, v30
    v_exp_f32 v31, v31
    v_cvt_pk_bf16_f32 v58, v28, v29
    v_exp_f32 v32, v32
    v_cvt_pk_bf16_f32 v59, v30, v31
    v_exp_f32 v33, v33
    v_exp_f32 v34, v34
    v_mfma_f32_32x32x16_bf16 v[64:79], v[132:135], v[56:59], v[64:79]
    v_cvt_pk_bf16_f32 v60, v32, v33
    v_exp_f32 v35, v35
    v_exp_f32 v36, v36
    v_cvt_pk_bf16_f32 v61, v34, v35
    v_exp_f32 v37, v37
    v_exp_f32 v38, v38
    v_exp_f32 v39, v39
    v_cvt_pk_bf16_f32 v62, v36, v37
    v_cvt_pk_bf16_f32 v63, v38, v39
    v_mfma_f32_32x32x16_bf16 v[24:39], v[128:131], v[16:19], 0
    s_add_u32 s30, s30, 4096
    v_exp_f32 v40, v40
    v_exp_f32 v41, v41
    v_exp_f32 v42, v42
    v_exp_f32 v43, v43
    v_cvt_pk_bf16_f32 v56, v40, v41
    v_exp_f32 v44, v44
    v_mfma_f32_32x32x16_bf16 v[64:79], v[136:139], v[60:63], v[64:79]
    global_load_dwordx4 v[228:231], v1, s[34:35] offset:-3072
    global_load_dwordx4 v[232:235], v1, s[34:35] offset:-2048
    global_load_dwordx4 v[236:239], v1, s[34:35] offset:-1024
    global_load_dwordx4 v[240:243], v1, s[34:35] offset:0
    v_exp_f32 v45, v45
    v_cvt_pk_bf16_f32 v57, v42, v43
    v_exp_f32 v46, v46
    v_exp_f32 v47, v47
    v_cvt_pk_bf16_f32 v58, v44, v45
    v_exp_f32 v48, v48
    v_cvt_pk_bf16_f32 v59, v46, v47
    v_exp_f32 v49, v49
    v_exp_f32 v50, v50
    v_mfma_f32_32x32x16_bf16 v[80:95], v[132:135], v[56:59], v[80:95]
    s_and_b32 s30, s30, 0x1ffff
    v_cvt_pk_bf16_f32 v60, v48, v49
    v_exp_f32 v51, v51
    v_exp_f32 v52, v52
    v_cvt_pk_bf16_f32 v61, v50, v51
    v_exp_f32 v53, v53
    v_exp_f32 v54, v54
    v_exp_f32 v55, v55
    v_cvt_pk_bf16_f32 v62, v52, v53
    v_cvt_pk_bf16_f32 v63, v54, v55
    v_mfma_f32_32x32x16_bf16 v[40:55], v[128:131], v[20:23], 0
    s_add_u32 s32, s30, s31
    v_exp_f32 v24, v24
    v_exp_f32 v25, v25
    v_exp_f32 v26, v26
    v_exp_f32 v27, v27
    v_cvt_pk_bf16_f32 v56, v24, v25
    v_exp_f32 v28, v28
    v_mfma_f32_32x32x16_bf16 v[80:95], v[136:139], v[60:63], v[80:95]
    s_addc_u32 s33, s38, 0
    v_exp_f32 v29, v29
    v_cvt_pk_bf16_f32 v57, v26, v27
    v_exp_f32 v30, v30
    v_exp_f32 v31, v31
    v_cvt_pk_bf16_f32 v58, v28, v29
    v_exp_f32 v32, v32
    v_cvt_pk_bf16_f32 v59, v30, v31
    v_exp_f32 v33, v33
    v_exp_f32 v34, v34
    v_mfma_f32_32x32x16_bf16 v[96:111], v[132:135], v[56:59], v[96:111]
    s_waitcnt vmcnt(9)
    v_cvt_pk_bf16_f32 v60, v32, v33
    v_exp_f32 v35, v35
    v_exp_f32 v36, v36
    v_cvt_pk_bf16_f32 v61, v34, v35
    v_exp_f32 v37, v37
    v_exp_f32 v38, v38
    v_exp_f32 v39, v39
    v_cvt_pk_bf16_f32 v62, v36, v37
    v_cvt_pk_bf16_f32 v63, v38, v39
    v_mfma_f32_32x32x16_bf16 v[24:39], v[140:143], v[8:11], 0
    global_load_dwordx4 v[128:131], v1, s[32:33]
    global_load_dwordx4 v[244:247], v1, s[34:35] offset:1024
    global_load_dwordx4 v[248:251], v1, s[34:35] offset:2048
    global_load_dwordx4 v[252:255], v1, s[34:35] offset:3072
    v_exp_f32 v40, v40
    v_exp_f32 v41, v41
    v_exp_f32 v42, v42
    v_exp_f32 v43, v43
    v_cvt_pk_bf16_f32 v56, v40, v41
    v_exp_f32 v44, v44
    v_mfma_f32_32x32x16_bf16 v[96:111], v[136:139], v[60:63], v[96:111]
    s_add_u32 s34, s4, s74
    v_exp_f32 v45, v45
    v_cvt_pk_bf16_f32 v57, v42, v43
    v_exp_f32 v46, v46
    v_exp_f32 v47, v47
    v_cvt_pk_bf16_f32 v58, v44, v45
    v_exp_f32 v48, v48
    v_cvt_pk_bf16_f32 v59, v46, v47
    v_exp_f32 v49, v49
    v_exp_f32 v50, v50
    v_mfma_f32_32x32x16_bf16 v[112:127], v[132:135], v[56:59], v[112:127]
    s_addc_u32 s35, s5, 0
    v_cvt_pk_bf16_f32 v60, v48, v49
    v_exp_f32 v51, v51
    v_exp_f32 v52, v52
    v_cvt_pk_bf16_f32 v61, v50, v51
    v_exp_f32 v53, v53
    v_exp_f32 v54, v54
    v_exp_f32 v55, v55
    v_cvt_pk_bf16_f32 v62, v52, v53
    v_cvt_pk_bf16_f32 v63, v54, v55
    v_mfma_f32_32x32x16_bf16 v[40:55], v[140:143], v[12:15], 0
    s_waitcnt vmcnt(8)
    v_exp_f32 v24, v24
    v_exp_f32 v25, v25
    v_exp_f32 v26, v26
    v_exp_f32 v27, v27
    v_cvt_pk_bf16_f32 v56, v24, v25
    v_exp_f32 v28, v28
    v_mfma_f32_32x32x16_bf16 v[112:127], v[136:139], v[60:63], v[112:127]
    s_mov_b64 exec, s[20:21]
    global_load_dwordx4 v[132:135], v7, s[32:33] offset:1024
    global_load_dwordx4 v[136:139], v7, s[32:33] offset:1536
    s_mov_b64 exec, -1
    v_exp_f32 v29, v29
    v_cvt_pk_bf16_f32 v57, v26, v27
    v_exp_f32 v30, v30
    v_exp_f32 v31, v31
    v_cvt_pk_bf16_f32 v58, v28, v29
    v_exp_f32 v32, v32
    v_cvt_pk_bf16_f32 v59, v30, v31
    v_exp_f32 v33, v33
    v_exp_f32 v34, v34
    v_mfma_f32_32x32x16_bf16 v[64:79], v[144:147], v[56:59], v[64:79]
    s_add_u32 m0, s76, 65536
    v_cvt_pk_bf16_f32 v60, v32, v33
    v_exp_f32 v35, v35
    v_exp_f32 v36, v36
    v_cvt_pk_bf16_f32 v61, v34, v35
    v_exp_f32 v37, v37
    v_exp_f32 v38, v38
    v_exp_f32 v39, v39
    v_cvt_pk_bf16_f32 v62, v36, v37
    v_cvt_pk_bf16_f32 v63, v38, v39
    v_mfma_f32_32x32x16_bf16 v[24:39], v[140:143], v[16:19], 0
    s_add_u32 s30, s30, 4096
    v_and_b32 v5, 3, v2
    v_lshlrev_b32 v5, 7, v5
    v_lshl_add_u32 v5, v3, 14, v5
    v_exp_f32 v40, v40
    v_exp_f32 v41, v41
    v_exp_f32 v42, v42
    v_exp_f32 v43, v43
    v_cvt_pk_bf16_f32 v56, v40, v41
    v_exp_f32 v44, v44
    v_mfma_f32_32x32x16_bf16 v[64:79], v[148:151], v[60:63], v[64:79]
    global_load_lds_dwordx4 v1, s[34:35] offset:0
    global_load_lds_dwordx4 v1, s[34:35] offset:1024
    global_load_lds_dwordx4 v1, s[34:35] offset:2048
    global_load_lds_dwordx4 v1, s[34:35] offset:3072
    v_exp_f32 v45, v45
    v_cvt_pk_bf16_f32 v57, v42, v43
    v_exp_f32 v46, v46
    v_exp_f32 v47, v47
    v_cvt_pk_bf16_f32 v58, v44, v45
    v_exp_f32 v48, v48
    v_cvt_pk_bf16_f32 v59, v46, v47
    v_exp_f32 v49, v49
    v_exp_f32 v50, v50
    v_mfma_f32_32x32x16_bf16 v[80:95], v[144:147], v[56:59], v[80:95]
    s_and_b32 s30, s30, 0x1ffff
    buffer_load_dword v5, v5, s[4:7], s36 offen
    buffer_load_dword v5, off, s[4:7], s53
    v_cvt_pk_bf16_f32 v60, v48, v49
    v_exp_f32 v51, v51
    v_exp_f32 v52, v52
    v_cvt_pk_bf16_f32 v61, v50, v51
    v_exp_f32 v53, v53
    v_exp_f32 v54, v54
    v_exp_f32 v55, v55
    v_cvt_pk_bf16_f32 v62, v52, v53
    v_cvt_pk_bf16_f32 v63, v54, v55
    v_mfma_f32_32x32x16_bf16 v[40:55], v[140:143], v[20:23], 0
    s_add_u32 s32, s30, s31
    v_exp_f32 v24, v24
    v_exp_f32 v25, v25
    v_exp_f32 v26, v26
    v_exp_f32 v27, v27
    v_cvt_pk_bf16_f32 v56, v24, v25
    v_exp_f32 v28, v28
    v_mfma_f32_32x32x16_bf16 v[80:95], v[148:151], v[60:63], v[80:95]
    s_addc_u32 s33, s38, 0
    v_exp_f32 v29, v29
    v_cvt_pk_bf16_f32 v57, v26, v27
    v_exp_f32 v30, v30
    v_exp_f32 v31, v31
    v_cvt_pk_bf16_f32 v58, v28, v29
    v_exp_f32 v32, v32
    v_cvt_pk_bf16_f32 v59, v30, v31
    v_exp_f32 v33, v33
    v_exp_f32 v34, v34
    v_mfma_f32_32x32x16_bf16 v[96:111], v[144:147], v[56:59], v[96:111]
    s_waitcnt vmcnt(11)
    v_cvt_pk_bf16_f32 v60, v32, v33
    v_exp_f32 v35, v35
    v_exp_f32 v36, v36
    v_cvt_pk_bf16_f32 v61, v34, v35
    v_exp_f32 v37, v37
    v_exp_f32 v38, v38
    v_exp_f32 v39, v39
    v_cvt_pk_bf16_f32 v62, v36, v37
    v_cvt_pk_bf16_f32 v63, v38, v39
    v_mfma_f32_32x32x16_bf16 v[24:39], v[128:131], v[8:11], 0
    global_load_dwordx4 v[140:143], v1, s[32:33]
    v_exp_f32 v40, v40
    v_exp_f32 v41, v41
    v_exp_f32 v42, v42
    v_exp_f32 v43, v43
    v_cvt_pk_bf16_f32 v56, v40, v41
    v_exp_f32 v44, v44
    v_mfma_f32_32x32x16_bf16 v[96:111], v[148:151], v[60:63], v[96:111]
    s_add_u32 s34, s34, 16384
    v_exp_f32 v45, v45
    v_cvt_pk_bf16_f32 v57, v42, v43
    v_exp_f32 v46, v46
    v_exp_f32 v47, v47
    v_cvt_pk_bf16_f32 v58, v44, v45
    v_exp_f32 v48, v48
    v_cvt_pk_bf16_f32 v59, v46, v47
    v_exp_f32 v49, v49
    v_exp_f32 v50, v50
    v_mfma_f32_32x32x16_bf16 v[112:127], v[144:147], v[56:59], v[112:127]
    s_addc_u32 s35, s35, 0
    v_cvt_pk_bf16_f32 v60, v48, v49
    v_exp_f32 v51, v51
    v_exp_f32 v52, v52
    v_cvt_pk_bf16_f32 v61, v50, v51
    v_exp_f32 v53, v53
    v_exp_f32 v54, v54
    v_exp_f32 v55, v55
    v_cvt_pk_bf16_f32 v62, v52, v53
    v_cvt_pk_bf16_f32 v63, v54, v55
    v_mfma_f32_32x32x16_bf16 v[40:55], v[128:131], v[12:15], 0
    s_waitcnt vmcnt(7)
    v_exp_f32 v24, v24
    v_exp_f32 v25, v25
    v_exp_f32 v26, v26
    v_exp_f32 v27, v27
    v_cvt_pk_bf16_f32 v56, v24, v25
    v_exp_f32 v28, v28
    v_mfma_f32_32x32x16_bf16 v[112:127], v[148:151], v[60:63], v[112:127]
    s_mov_b64 exec, s[20:21]
    global_load_dwordx4 v[144:147], v7, s[32:33] offset:1024
    global_load_dwordx4 v[148:151], v7, s[32:33] offset:1536
    s_mov_b64 exec, -1
    v_exp_f32 v29, v29
    v_cvt_pk_bf16_f32 v57, v26, v27
    v_exp_f32 v30, v30
    v_exp_f32 v31, v31
    v_cvt_pk_bf16_f32 v58, v28, v29
    v_exp_f32 v32, v32
    v_cvt_pk_bf16_f32 v59, v30, v31
    v_exp_f32 v33, v33
    v_exp_f32 v34, v34
    v_mfma_f32_32x32x16_bf16 v[64:79], v[132:135], v[56:59], v[64:79]
    s_add_u32 m0, m0, 16384
    v_cvt_pk_bf16_f32 v60, v32, v33
    v_exp_f32 v35, v35
    v_exp_f32 v36, v36
    v_cvt_pk_bf16_f32 v61, v34, v35
    v_exp_f32 v37, v37
    v_exp_f32 v38, v38
    v_exp_f32 v39, v39
    v_cvt_pk_bf16_f32 v62, v36, v37
    v_cvt_pk_bf16_f32 v63, v38, v39
    v_mfma_f32_32x32x16_bf16 v[24:39], v[128:131], v[16:19], 0
    s_add_u32 s30, s30, 4096
    v_exp_f32 v40, v40
    v_exp_f32 v41, v41
    v_exp_f32 v42, v42
    v_exp_f32 v43, v43
    v_cvt_pk_bf16_f32 v56, v40, v41
    v_exp_f32 v44, v44
    v_mfma_f32_32x32x16_bf16 v[64:79], v[136:139], v[60:63], v[64:79]
    global_load_lds_dwordx4 v1, s[34:35] offset:0
    global_load_lds_dwordx4 v1, s[34:35] offset:1024
    global_load_lds_dwordx4 v1, s[34:35] offset:2048
    global_load_lds_dwordx4 v1, s[34:35] offset:3072
    v_exp_f32 v45, v45
    v_cvt_pk_bf16_f32 v57, v42, v43
    v_exp_f32 v46, v46
    v_exp_f32 v47, v47
    v_cvt_pk_bf16_f32 v58, v44, v45
    v_exp_f32 v48, v48
    v_cvt_pk_bf16_f32 v59, v46, v47
    v_exp_f32 v49, v49
    v_exp_f32 v50, v50
    v_mfma_f32_32x32x16_bf16 v[80:95], v[132:135], v[56:59], v[80:95]
    s_and_b32 s30, s30, 0x1ffff
    v_cvt_pk_bf16_f32 v60, v48, v49
    v_exp_f32 v51, v51
    v_exp_f32 v52, v52
    v_cvt_pk_bf16_f32 v61, v50, v51
    v_exp_f32 v53, v53
    v_exp_f32 v54, v54
    v_exp_f32 v55, v55
    v_cvt_pk_bf16_f32 v62, v52, v53
    v_cvt_pk_bf16_f32 v63, v54, v55
    v_mfma_f32_32x32x16_bf16 v[40:55], v[128:131], v[20:23], 0
    s_add_u32 s32, s30, s31
    v_exp_f32 v24, v24
    v_exp_f32 v25, v25
    v_exp_f32 v26, v26
    v_exp_f32 v27, v27
    v_cvt_pk_bf16_f32 v56, v24, v25
    v_exp_f32 v28, v28
    v_mfma_f32_32x32x16_bf16 v[80:95], v[136:139], v[60:63], v[80:95]
    s_addc_u32 s33, s38, 0
    v_exp_f32 v29, v29
    v_cvt_pk_bf16_f32 v57, v26, v27
    v_exp_f32 v30, v30
    v_exp_f32 v31, v31
    v_cvt_pk_bf16_f32 v58, v28, v29
    v_exp_f32 v32, v32
    v_cvt_pk_bf16_f32 v59, v30, v31
    v_exp_f32 v33, v33
    v_exp_f32 v34, v34
    v_mfma_f32_32x32x16_bf16 v[96:111], v[132:135], v[56:59], v[96:111]
    s_waitcnt vmcnt(6)
    s_getpc_b64 s[80:81]
CPF2_HERE:
    s_mov_b32 s82, CODE_END-CPF2_HERE
    s_mov_b32 s83, 0x20000
    s_lshr_b32 s84, s2, 3
    s_lshl_b32 s84, s84, 2
    s_add_u32 s84, s84, s14
    s_lshl_b32 s84, s84, 8
    v_lshlrev_b32 v5, 3, v1
    s_mov_b64 exec, 3
    buffer_load_dword v5, v5, s[80:83], s84 offen
    s_mov_b64 exec, -1
    v_cvt_pk_bf16_f32 v60, v32, v33
    v_exp_f32 v35, v35
    v_exp_f32 v36, v36
    v_cvt_pk_bf16_f32 v61, v34, v35
    v_exp_f32 v37, v37
    v_exp_f32 v38, v38
    v_exp_f32 v39, v39
    v_cvt_pk_bf16_f32 v62, v36, v37
    v_cvt_pk_bf16_f32 v63, v38, v39
    v_mfma_f32_32x32x16_bf16 v[24:39], v[140:143], v[8:11], 0
    global_load_dwordx4 v[128:131], v1, s[32:33]
    v_exp_f32 v40, v40
    v_exp_f32 v41, v41
    v_exp_f32 v42, v42
    v_exp_f32 v43, v43
    v_cvt_pk_bf16_f32 v56, v40, v41
    v_exp_f32 v44, v44
    v_mfma_f32_32x32x16_bf16 v[96:111], v[136:139], v[60:63], v[96:111]
    s_add_u32 s34, s34, 16384
    v_exp_f32 v45, v45
    v_cvt_pk_bf16_f32 v57, v42, v43
    v_exp_f32 v46, v46
    v_exp_f32 v47, v47
    v_cvt_pk_bf16_f32 v58, v44, v45
    v_exp_f32 v48, v48
    v_cvt_pk_bf16_f32 v59, v46, v47
    v_exp_f32 v49, v49
    v_exp_f32 v50, v50
    v_mfma_f32_32x32x16_bf16 v[112:127], v[132:135], v[56:59], v[112:127]
    s_addc_u32 s35, s35, 0
    v_cvt_pk_bf16_f32 v60, v48, v49
    v_exp_f32 v51, v51
    v_exp_f32 v52, v52
    v_cvt_pk_bf16_f32 v61, v50, v51
    v_exp_f32 v53, v53
    v_exp_f32 v54, v54
    v_exp_f32 v55, v55
    v_cvt_pk_bf16_f32 v62, v52, v53
    v_cvt_pk_bf16_f32 v63, v54, v55
    v_mfma_f32_32x32x16_bf16 v[40:55], v[140:143], v[12:15], 0
    s_waitcnt vmcnt(6)
    v_exp_f32 v24, v24
    v_exp_f32 v25, v25
    v_exp_f32 v26, v26
    v_exp_f32 v27, v27
    v_cvt_pk_bf16_f32 v56, v24, v25
    v_exp_f32 v28, v28
    v_mfma_f32_32x32x16_bf16 v[112:127], v[136:139], v[60:63], v[112:127]
    s_mov_b64 exec, s[20:21]
    global_load_dwordx4 v[132:135], v7, s[32:33] offset:1024
    global_load_dwordx4 v[136:139], v7, s[32:33] offset:1536
    s_mov_b64 exec, -1
    v_exp_f32 v29, v29
    v_cvt_pk_bf16_f32 v57, v26, v27
    v_exp_f32 v30, v30
    v_exp_f32 v31, v31
    v_cvt_pk_bf16_f32 v58, v28, v29
    v_exp_f32 v32, v32
    v_cvt_pk_bf16_f32 v59, v30, v31
    v_exp_f32 v33, v33
    v_exp_f32 v34, v34
    v_mfma_f32_32x32x16_bf16 v[64:79], v[144:147], v[56:59], v[64:79]
    s_add_u32 m0, m0, 16384
    v_cvt_pk_bf16_f32 v60, v32, v33
    v_exp_f32 v35, v35
    v_exp_f32 v36, v36
    v_cvt_pk_bf16_f32 v61, v34, v35
    v_exp_f32 v37, v37
    v_exp_f32 v38, v38
    v_exp_f32 v39, v39
    v_cvt_pk_bf16_f32 v62, v36, v37
    v_cvt_pk_bf16_f32 v63, v38, v39
    v_mfma_f32_32x32x16_bf16 v[24:39], v[140:143], v[16:19], 0
    s_add_u32 s30, s30, 4096
    v_exp_f32 v40, v40
    v_exp_f32 v41, v41
    v_exp_f32 v42, v42
    v_exp_f32 v43, v43
    v_cvt_pk_bf16_f32 v56, v40, v41
    v_exp_f32 v44, v44
    v_mfma_f32_32x32x16_bf16 v[64:79], v[148:151], v[60:63], v[64:79]
    global_load_lds_dwordx4 v1, s[34:35] offset:0
    global_load_lds_dwordx4 v1, s[34:35] offset:1024
    global_load_lds_dwordx4 v1, s[34:35] offset:2048
    global_load_lds_dwordx4 v1, s[34:35] offset:3072
    v_exp_f32 v45, v45
    v_cvt_pk_bf16_f32 v57, v42, v43
    v_exp_f32 v46, v46
    v_exp_f32 v47, v47
    v_cvt_pk_bf16_f32 v58, v44, v45
    v_exp_f32 v48, v48
    v_cvt_pk_bf16_f32 v59, v46, v47
    v_exp_f32 v49, v49
    v_exp_f32 v50, v50
    v_mfma_f32_32x32x16_bf16 v[80:95], v[144:147], v[56:59], v[80:95]
    s_and_b32 s30, s30, 0x1ffff
    v_cvt_pk_bf16_f32 v60, v48, v49
    v_exp_f32 v51, v51
    v_exp_f32 v52, v52
    v_cvt_pk_bf16_f32 v61, v50, v51
    v_exp_f32 v53, v53
    v_exp_f32 v54, v54
    v_exp_f32 v55, v55
    v_cvt_pk_bf16_f32 v62, v52, v53
    v_cvt_pk_bf16_f32 v63, v54, v55
    v_mfma_f32_32x32x16_bf16 v[40:55], v[140:143], v[20:23], 0
    s_add_u32 s32, s30, s31
    v_exp_f32 v24, v24
    v_exp_f32 v25, v25
    v_exp_f32 v26, v26
    v_exp_f32 v27, v27
    v_cvt_pk_bf16_f32 v56, v24, v25
    v_exp_f32 v28, v28
    v_mfma_f32_32x32x16_bf16 v[80:95], v[148:151], v[60:63], v[80:95]
    s_addc_u32 s33, s38, 0
    v_exp_f32 v29, v29
    v_cvt_pk_bf16_f32 v57, v26, v27
    v_exp_f32 v30, v30
    v_exp_f32 v31, v31
    v_cvt_pk_bf16_f32 v58, v28, v29
    v_exp_f32 v32, v32
    v_cvt_pk_bf16_f32 v59, v30, v31
    v_exp_f32 v33, v33
    v_exp_f32 v34, v34
    v_mfma_f32_32x32x16_bf16 v[96:111], v[144:147], v[56:59], v[96:111]
    s_waitcnt vmcnt(6)
    v_cvt_pk_bf16_f32 v60, v32, v33
    v_exp_f32 v35, v35
    v_exp_f32 v36, v36
    v_cvt_pk_bf16_f32 v61, v34, v35
    v_exp_f32 v37, v37
    v_exp_f32 v38, v38
    v_exp_f32 v39, v39
    v_cvt_pk_bf16_f32 v62, v36, v37
    v_cvt_pk_bf16_f32 v63, v38, v39
    v_mfma_f32_32x32x16_bf16 v[24:39], v[128:131], v[8:11], 0
    global_load_dwordx4 v[140:143], v1, s[32:33]
    v_exp_f32 v40, v40
    v_exp_f32 v41, v41
    v_exp_f32 v42, v42
    v_exp_f32 v43, v43
    v_cvt_pk_bf16_f32 v56, v40, v41
    v_exp_f32 v44, v44
    v_mfma_f32_32x32x16_bf16 v[96:111], v[148:151], v[60:63], v[96:111]
    v_exp_f32 v45, v45
    v_cvt_pk_bf16_f32 v57, v42, v43
    v_exp_f32 v46, v46
    v_exp_f32 v47, v47
    v_cvt_pk_bf16_f32 v58, v44, v45
    v_exp_f32 v48, v48
    v_cvt_pk_bf16_f32 v59, v46, v47
    v_exp_f32 v49, v49
    v_exp_f32 v50, v50
    v_mfma_f32_32x32x16_bf16 v[112:127], v[144:147], v[56:59], v[112:127]
    v_cvt_pk_bf16_f32 v60, v48, v49
    v_exp_f32 v51, v51
    v_exp_f32 v52, v52
    v_cvt_pk_bf16_f32 v61, v50, v51
    v_exp_f32 v53, v53
    v_exp_f32 v54, v54
    v_exp_f32 v55, v55
    v_cvt_pk_bf16_f32 v62, v52, v53
    v_cvt_pk_bf16_f32 v63, v54, v55
ATT_TAIL:
    v_mfma_f32_32x32x16_bf16 v[40:55], v[128:131], v[16:19], 0
    s_waitcnt vmcnt(1)
    v_exp_f32 v24, v24
    v_exp_f32 v25, v25
    v_exp_f32 v26, v26
    v_exp_f32 v27, v27
    v_cvt_pk_bf16_f32 v56, v24, v25
    v_exp_f32 v28, v28
    v_mfma_f32_32x32x16_bf16 v[112:127], v[148:151], v[60:63], v[112:127]
    s_mov_b64 exec, s[20:21]
    global_load_dwordx4 v[144:147], v7, s[32:33] offset:1024
    global_load_dwordx4 v[148:151], v7, s[32:33] offset:1536
    s_mov_b64 exec, -1
    v_exp_f32 v29, v29
    v_cvt_pk_bf16_f32 v57, v26, v27
    v_exp_f32 v30, v30
    v_exp_f32 v31, v31
    v_cvt_pk_bf16_f32 v58, v28, v29
    v_exp_f32 v32, v32
    v_cvt_pk_bf16_f32 v59, v30, v31
    v_exp_f32 v33, v33
    v_exp_f32 v34, v34
    v_mfma_f32_32x32x16_bf16 v[64:79], v[132:135], v[56:59], v[64:79]
    s_waitcnt vmcnt(2)
    v_cvt_pk_bf16_f32 v60, v32, v33
    v_exp_f32 v35, v35
    v_exp_f32 v36, v36
    v_cvt_pk_bf16_f32 v61, v34, v35
    v_exp_f32 v37, v37
    v_exp_f32 v38, v38
    v_exp_f32 v39, v39
    v_cvt_pk_bf16_f32 v62, v36, v37
    v_cvt_pk_bf16_f32 v63, v38, v39
    v_mfma_f32_32x32x16_bf16 v[24:39], v[140:143], v[8:11], 0
    s_sub_u32 s28, s65, 16384
    v_exp_f32 v40, v40
    v_exp_f32 v41, v41
    v_exp_f32 v42, v42
    v_exp_f32 v43, v43
    v_cvt_pk_bf16_f32 v56, v40, v41
    v_exp_f32 v44, v44
    v_mfma_f32_32x32x16_bf16 v[64:79], v[136:139], v[60:63], v[64:79]
    s_add_u32 m0, s76, 114688
    v_exp_f32 v45, v45
    v_cvt_pk_bf16_f32 v57, v42, v43
    v_exp_f32 v46, v46
    v_exp_f32 v47, v47
    v_cvt_pk_bf16_f32 v58, v44, v45
    v_exp_f32 v48, v48
    v_cvt_pk_bf16_f32 v59, v46, v47
    v_exp_f32 v49, v49
    v_exp_f32 v50, v50
    v_mfma_f32_32x32x16_bf16 v[96:111], v[132:135], v[56:59], v[96:111]
    v_cvt_pk_bf16_f32 v60, v48, v49
    v_exp_f32 v51, v51
    v_exp_f32 v52, v52
    v_cvt_pk_bf16_f32 v61, v50, v51
    v_exp_f32 v53, v53
    v_exp_f32 v54, v54
    v_exp_f32 v55, v55
    v_cvt_pk_bf16_f32 v62, v52, v53
    v_cvt_pk_bf16_f32 v63, v54, v55
    v_and_b32 v5, 1, v3
    v_lshlrev_b32 v5, 14, v5
    v_add_u32 v5, v5, v7
    v_mfma_f32_32x32x16_bf16 v[40:55], v[140:143], v[16:19], 0
    v_exp_f32 v24, v24
    v_exp_f32 v25, v25
    v_exp_f32 v26, v26
    v_exp_f32 v27, v27
    v_cvt_pk_bf16_f32 v56, v24, v25
    v_exp_f32 v28, v28
    v_mfma_f32_32x32x16_bf16 v[96:111], v[136:139], v[60:63], v[96:111]
    s_waitcnt vmcnt(0)
    v_exp_f32 v29, v29
    v_cvt_pk_bf16_f32 v57, v26, v27
    v_exp_f32 v30, v30
    v_exp_f32 v31, v31
    v_cvt_pk_bf16_f32 v58, v28, v29
    v_exp_f32 v32, v32
    v_cvt_pk_bf16_f32 v59, v30, v31
    v_exp_f32 v33, v33
    v_exp_f32 v34, v34
    v_mfma_f32_32x32x16_bf16 v[64:79], v[144:147], v[56:59], v[64:79]
    v_cvt_pk_bf16_f32 v60, v32, v33
    v_exp_f32 v35, v35
    v_exp_f32 v36, v36
    v_cvt_pk_bf16_f32 v61, v34, v35
    v_exp_f32 v37, v37
    v_exp_f32 v38, v38
    v_exp_f32 v39, v39
    v_cvt_pk_bf16_f32 v62, v36, v37
    v_cvt_pk_bf16_f32 v63, v38, v39
    v_mfma_f32_32x32x16_bf16 v[24:39], v[128:131], v[12:15], 0
    buffer_load_dwordx4 v1, s[4:7], s28 offen offset:0 lds
    buffer_load_dwordx4 v1, s[4:7], s28 offen offset:1024 lds
    buffer_load_dwordx4 v1, s[4:7], s28 offen offset:2048 lds
    buffer_load_dwordx4 v1, s[4:7], s28 offen offset:3072 lds
    v_exp_f32 v40, v40
    v_exp_f32 v41, v41
    v_exp_f32 v42, v42
    v_exp_f32 v43, v43
    v_cvt_pk_bf16_f32 v56, v40, v41
    v_exp_f32 v44, v44
    v_mfma_f32_32x32x16_bf16 v[64:79], v[148:151], v[60:63], v[64:79]
    v_exp_f32 v45, v45
    v_cvt_pk_bf16_f32 v57, v42, v43
    v_exp_f32 v46, v46
    v_exp_f32 v47, v47
    v_cvt_pk_bf16_f32 v58, v44, v45
    v_exp_f32 v48, v48
    v_cvt_pk_bf16_f32 v59, v46, v47
    v_exp_f32 v49, v49
    v_exp_f32 v50, v50
    v_mfma_f32_32x32x16_bf16 v[96:111], v[144:147], v[56:59], v[96:111]
    v_cvt_pk_bf16_f32 v60, v48, v49
    v_exp_f32 v51, v51
    v_exp_f32 v52, v52
    v_cvt_pk_bf16_f32 v61, v50, v51
    v_exp_f32 v53, v53
    v_exp_f32 v54, v54
    v_exp_f32 v55, v55
    v_cvt_pk_bf16_f32 v62, v52, v53
    v_cvt_pk_bf16_f32 v63, v54, v55
    v_mfma_f32_32x32x16_bf16 v[40:55], v[140:143], v[12:15], 0
    ds_write_b128 v4, v[64:67] offset:0
    ds_write_b128 v4, v[68:71] offset:1024
    v_exp_f32 v24, v24
    v_exp_f32 v25, v25
    v_exp_f32 v26, v26
    v_exp_f32 v27, v27
    v_cvt_pk_bf16_f32 v56, v24, v25
    v_exp_f32 v28, v28
    v_mfma_f32_32x32x16_bf16 v[96:111], v[148:151], v[60:63], v[96:111]
    ds_write_b32 v4, v72 offset:2048
    v_exp_f32 v29, v29
    v_cvt_pk_bf16_f32 v57, v26, v27
    v_exp_f32 v30, v30
    v_exp_f32 v31, v31
    v_cvt_pk_bf16_f32 v58, v28, v29
    v_exp_f32 v32, v32
    v_cvt_pk_bf16_f32 v59, v30, v31
    v_exp_f32 v33, v33
    v_exp_f32 v34, v34
    v_mfma_f32_32x32x16_bf16 v[80:95], v[132:135], v[56:59], v[80:95]
    s_waitcnt lgkmcnt(0)
    s_barrier
    v_cvt_pk_bf16_f32 v60, v32, v33
    v_exp_f32 v35, v35
    v_exp_f32 v36, v36
    v_cvt_pk_bf16_f32 v61, v34, v35
    v_exp_f32 v37, v37
    v_exp_f32 v38, v38
    v_exp_f32 v39, v39
    v_cvt_pk_bf16_f32 v62, v36, v37
    v_cvt_pk_bf16_f32 v63, v38, v39
    v_xor_b32 v75, 16384, v4
    v_mfma_f32_32x32x16_bf16 v[24:39], v[128:131], v[20:23], 0
    ds_read_b128 v[64:67], v75 offset:0
    ds_read_b128 v[68:71], v75 offset:1024
    ds_read_b32 v72, v75 offset:2048
    v_exp_f32 v40, v40
    v_exp_f32 v41, v41
    v_exp_f32 v42, v42
    v_exp_f32 v43, v43
    v_cvt_pk_bf16_f32 v56, v40, v41
    v_exp_f32 v44, v44
    v_mfma_f32_32x32x16_bf16 v[80:95], v[136:139], v[60:63], v[80:95]
    v_exp_f32 v45, v45
    v_cvt_pk_bf16_f32 v57, v42, v43
    v_exp_f32 v46, v46
    v_exp_f32 v47, v47
    v_cvt_pk_bf16_f32 v58, v44, v45
    v_exp_f32 v48, v48
    v_cvt_pk_bf16_f32 v59, v46, v47
    v_exp_f32 v49, v49
    v_exp_f32 v50, v50
    v_mfma_f32_32x32x16_bf16 v[80:95], v[144:147], v[56:59], v[80:95]
    s_waitcnt lgkmcnt(0)
    v_add_f32 v104, v104, v72
    v_add_f32 v96, v96, v64
    v_add_f32 v97, v97, v65
    v_add_f32 v98, v98, v66
    v_add_f32 v99, v99, v67
    v_add_f32 v100, v100, v68
    v_add_f32 v101, v101, v69
    v_add_f32 v102, v102, v70
    v_add_f32 v103, v103, v71
    v_rcp_f32 v106, v104
    v_cmp_le_f32 s[24:25], s40, v104
    v_cmp_ge_f32 s[26:27], s41, v104
    v_maximum3_f32 v64, |v96|, |v97|, |v98|
    v_maximum3_f32 v65, |v99|, |v100|, |v101|
    v_maximum3_f32 v64, |v102|, |v103|, v64
    s_and_b64 s[24:25], s[24:25], s[26:27]
    v_maximum3_f32 v64, v64, v65, v65
    v_cmp_ge_f32 vcc, s42, v64
    v_cvt_pk_bf16_f32 v60, v48, v49
    v_exp_f32 v51, v51
    v_exp_f32 v52, v52
    v_cvt_pk_bf16_f32 v61, v50, v51
    v_exp_f32 v53, v53
    v_exp_f32 v54, v54
    v_exp_f32 v55, v55
    v_cvt_pk_bf16_f32 v62, v52, v53
    v_cvt_pk_bf16_f32 v63, v54, v55
    v_mfma_f32_32x32x16_bf16 v[40:55], v[140:143], v[20:23], 0
    v_mul_f32 v96, v96, v106
    v_mul_f32 v97, v97, v106
    v_mul_f32 v98, v98, v106
    v_mul_f32 v99, v99, v106
    v_mul_f32 v100, v100, v106
    v_mul_f32 v101, v101, v106
    v_mul_f32 v102, v102, v106
    v_mul_f32 v103, v103, v106
    v_cvt_pk_bf16_f32 v76, v96, v97
    v_cvt_pk_bf16_f32 v77, v98, v99
    v_cvt_pk_bf16_f32 v78, v100, v101
    v_cvt_pk_bf16_f32 v79, v102, v103
    v_mov_b32 v74, s43
    v_exp_f32 v24, v24
    v_exp_f32 v25, v25
    v_exp_f32 v26, v26
    v_exp_f32 v27, v27
    v_cvt_pk_bf16_f32 v56, v24, v25
    v_exp_f32 v28, v28
    v_mfma_f32_32x32x16_bf16 v[80:95], v[148:151], v[60:63], v[80:95]
    s_and_b64 s[24:25], s[24:25], vcc
    s_cmp_eq_u64 s[24:25], -1
    s_cselect_b32 s55, 0, 1
    s_cselect_b32 s28, s36, 25165824
    s_cselect_b32 s29, s54, 25165824
    buffer_store_dwordx4 v[76:79], v5, s[4:7], s28 offen
    s_cmp_lg_u32 s23, 0
    s_cbranch_scc1 DS_1
DB_2:
    v_exp_f32 v29, v29
    v_cvt_pk_bf16_f32 v57, v26, v27
    v_exp_f32 v30, v30
    v_exp_f32 v31, v31
    v_cvt_pk_bf16_f32 v58, v28, v29
    v_exp_f32 v32, v32
    v_cvt_pk_bf16_f32 v59, v30, v31
    v_exp_f32 v33, v33
    v_exp_f32 v34, v34
    v_mfma_f32_32x32x16_bf16 v[112:127], v[132:135], v[56:59], v[112:127]
    buffer_load_dwordx4 v[96:99], v1, s[4:7], s52 offen sc1
    buffer_load_dwordx4 v[100:103], v1, s[4:7], s52 offen offset:1024 sc1
    v_cvt_pk_bf16_f32 v60, v32, v33
    v_exp_f32 v35, v35
    v_exp_f32 v36, v36
    v_cvt_pk_bf16_f32 v61, v34, v35
    v_exp_f32 v37, v37
    v_exp_f32 v38, v38
    v_exp_f32 v39, v39
    v_cvt_pk_bf16_f32 v62, v36, v37
    v_cvt_pk_bf16_f32 v63, v38, v39
    v_exp_f32 v40, v40
    v_exp_f32 v41, v41
    v_exp_f32 v42, v42
    v_exp_f32 v43, v43
    v_cvt_pk_bf16_f32 v56, v40, v41
    v_exp_f32 v44, v44
    v_mfma_f32_32x32x16_bf16 v[112:127], v[136:139], v[60:63], v[112:127]
    ds_write_b128 v4, v[80:83] offset:3072
    ds_write_b128 v4, v[84:87] offset:4096
    v_exp_f32 v45, v45
    v_cvt_pk_bf16_f32 v57, v42, v43
    v_exp_f32 v46, v46
    v_exp_f32 v47, v47
    v_cvt_pk_bf16_f32 v58, v44, v45
    v_exp_f32 v48, v48
    v_cvt_pk_bf16_f32 v59, v46, v47
    v_exp_f32 v49, v49
    v_exp_f32 v50, v50
    v_mfma_f32_32x32x16_bf16 v[112:127], v[144:147], v[56:59], v[112:127]
    ds_write_b32 v4, v88 offset:5120
    v_cvt_pk_bf16_f32 v60, v48, v49
    v_exp_f32 v51, v51
    v_exp_f32 v52, v52
    v_cvt_pk_bf16_f32 v61, v50, v51
    v_exp_f32 v53, v53
    v_exp_f32 v54, v54
    v_exp_f32 v55, v55
    v_cvt_pk_bf16_f32 v62, v52, v53
    v_cvt_pk_bf16_f32 v63, v54, v55
    s_waitcnt lgkmcnt(0)
    s_barrier
    v_mfma_f32_32x32x16_bf16 v[112:127], v[148:151], v[60:63], v[112:127]
    ds_read_b128 v[80:83], v75 offset:3072
    ds_read_b128 v[84:87], v75 offset:4096
    ds_read_b32 v88, v75 offset:5120
    s_waitcnt vmcnt(2)
    s_cmp_lg_u32 s23, 0
    s_mov_b64 exec, 1
    s_cbranch_scc1 WS_3
    buffer_store_dword v74, off, s[4:7], s29 offset:0
WB_4:
    s_mov_b64 exec, -1
    s_waitcnt lgkmcnt(0)
    s_nop 1
    v_add_f32 v120, v120, v88
    v_add_f32 v112, v112, v80
    v_add_f32 v113, v113, v81
    v_add_f32 v114, v114, v82
    v_add_f32 v115, v115, v83
    v_add_f32 v116, v116, v84
    v_add_f32 v117, v117, v85
    v_add_f32 v118, v118, v86
    v_add_f32 v119, v119, v87
    v_rcp_f32 v122, v120
    v_cmp_le_f32 s[24:25], s40, v120
    v_cmp_ge_f32 s[26:27], s41, v120
    v_maximum3_f32 v80, |v112|, |v113|, |v114|
    v_maximum3_f32 v81, |v115|, |v116|, |v117|
    v_maximum3_f32 v80, |v118|, |v119|, v80
    s_and_b64 s[24:25], s[24:25], s[26:27]
    v_maximum3_f32 v80, v80, v81, v81
    v_cmp_ge_f32 vcc, s42, v80
    s_nop 1
    s_and_b64 s[24:25], s[24:25], vcc
    s_cmp_eq_u64 s[24:25], -1
    s_cselect_b32 s63, 0, 1
    s_or_b32 s24, s55, s63
    s_cbranch_scc1 FALLBACK
ATT_NORM:
    v_bfe_u32 v137, v1, 2, 7
    s_add_u32 s26, s22, 896
    s_cmp_ge_u32 s14, 2
    s_cselect_b32 s27, s26, s22
    buffer_load_dword v4, v137, s[4:7], s27 offen offset:0 sc1
    v_pk_mul_f32 v[112:113], v[112:113], v[122:123] op_sel_hi:[1,0]
    v_pk_mul_f32 v[114:115], v[114:115], v[122:123] op_sel_hi:[1,0]
    v_pk_mul_f32 v[116:117], v[116:117], v[122:123] op_sel_hi:[1,0]
    v_pk_mul_f32 v[118:119], v[118:119], v[122:123] op_sel_hi:[1,0]
    v_cvt_pk_bf16_f32 v52, v112, v113
    v_cvt_pk_bf16_f32 v53, v114, v115
    v_cvt_pk_bf16_f32 v54, v116, v117
    v_cvt_pk_bf16_f32 v55, v118, v119
    buffer_store_dwordx4 v[52:55], v5, s[4:7], s37 offen
    s_cmp_lg_u32 s23, 0
    s_cbranch_scc1 DS_5
DB_6:
    v_mov_b32 v7, s43
    s_add_u32 s24, s15, 131072
    v_add_u32 v136, s24, v1
    s_add_u32 m0, s76, 131072
    s_waitcnt vmcnt(1)
    v_cmp_ne_u32 vcc, s43, v4
    v_mov_b32 v128, 0x3f803f80
    v_mov_b32 v129, 0x3f803f80
    v_mov_b32 v130, 0x3f803f80
    v_mov_b32 v131, 0x3f803f80
    s_barrier
    s_cmp_lt_u32 s14, 2
    s_cbranch_scc0 P1_B
    s_cbranch_vccz P1_GO
    s_branch P1_POLL
P1_B:
    s_waitcnt vmcnt(0)
    s_cmp_lg_u32 s23, 0
    s_mov_b64 exec, 1
    s_cbranch_scc1 WS_7
    buffer_store_dword v7, off, s[4:7], s54 offset:896
WB_8:
    s_mov_b64 exec, -1
    v_mfma_f32_16x16x32_bf16 v[56:59], a[0:3], v[128:131], 0
    v_mfma_f32_16x16x32_bf16 v[60:63], a[64:67], v[128:131], 0
    v_mfma_f32_16x16x32_bf16 v[64:67], a[128:131], v[128:131], 0
    v_mfma_f32_16x16x32_bf16 v[56:59], a[4:7], v[128:131], v[56:59]
    v_mfma_f32_16x16x32_bf16 v[60:63], a[68:71], v[128:131], v[60:63]
    v_mfma_f32_16x16x32_bf16 v[64:67], a[132:135], v[128:131], v[64:67]
    v_mfma_f32_16x16x32_bf16 v[56:59], a[8:11], v[128:131], v[56:59]
    v_mfma_f32_16x16x32_bf16 v[60:63], a[72:75], v[128:131], v[60:63]
    v_mfma_f32_16x16x32_bf16 v[64:67], a[136:139], v[128:131], v[64:67]
    v_mfma_f32_16x16x32_bf16 v[56:59], a[12:15], v[128:131], v[56:59]
    v_mfma_f32_16x16x32_bf16 v[60:63], a[76:79], v[128:131], v[60:63]
    v_mfma_f32_16x16x32_bf16 v[64:67], a[140:143], v[128:131], v[64:67]
    v_mfma_f32_16x16x32_bf16 v[56:59], a[16:19], v[128:131], v[56:59]
    v_mfma_f32_16x16x32_bf16 v[60:63], a[80:83], v[128:131], v[60:63]
    v_mfma_f32_16x16x32_bf16 v[64:67], a[144:147], v[128:131], v[64:67]
    v_mfma_f32_16x16x32_bf16 v[56:59], a[20:23], v[128:131], v[56:59]
    v_mfma_f32_16x16x32_bf16 v[60:63], a[84:87], v[128:131], v[60:63]
    v_mfma_f32_16x16x32_bf16 v[64:67], a[148:151], v[128:131], v[64:67]
    v_mfma_f32_16x16x32_bf16 v[56:59], a[24:27], v[128:131], v[56:59]
    v_mfma_f32_16x16x32_bf16 v[60:63], a[88:91], v[128:131], v[60:63]
    v_mfma_f32_16x16x32_bf16 v[64:67], a[152:155], v[128:131], v[64:67]
    v_mfma_f32_16x16x32_bf16 v[56:59], a[28:31], v[128:131], v[56:59]
    v_mfma_f32_16x16x32_bf16 v[60:63], a[92:95], v[128:131], v[60:63]
    v_mfma_f32_16x16x32_bf16 v[64:67], a[156:159], v[128:131], v[64:67]
    v_mfma_f32_16x16x32_bf16 v[56:59], a[32:35], v[128:131], v[56:59]
    v_mfma_f32_16x16x32_bf16 v[60:63], a[96:99], v[128:131], v[60:63]
    v_mfma_f32_16x16x32_bf16 v[64:67], a[160:163], v[128:131], v[64:67]
    v_mfma_f32_16x16x32_bf16 v[56:59], a[36:39], v[128:131], v[56:59]
    v_mfma_f32_16x16x32_bf16 v[60:63], a[100:103], v[128:131], v[60:63]
    v_mfma_f32_16x16x32_bf16 v[64:67], a[164:167], v[128:131], v[64:67]
P1_POLL:
    s_mov_b32 s25, 0
WP_9:
    buffer_load_dword v4, v137, s[4:7], s27 offen offset:0 sc1
    s_add_u32 s25, s25, 1
    s_waitcnt vmcnt(0)
    s_cmp_gt_u32 s25, 400000
    s_cbranch_scc1 WD_10
    v_cmp_ne_u32 vcc, s43, v4
    s_nop 1
    s_cbranch_vccnz WP_9
WD_10:
P1_GO:
    buffer_load_dwordx4 v[24:27], v136, s[4:7], s44 offen offset:0 sc1
    buffer_load_dwordx4 v[28:31], v136, s[4:7], s44 offen offset:1024 sc1
    buffer_load_dwordx4 v[32:35], v136, s[4:7], s45 offen offset:0 sc1
    buffer_load_dwordx4 v[36:39], v136, s[4:7], s45 offen offset:1024 sc1
    buffer_load_dwordx4 v[40:43], v136, s[4:7], s46 offen offset:0 sc1
    buffer_load_dwordx4 v[44:47], v136, s[4:7], s46 offen offset:1024 sc1
    buffer_load_dwordx4 v[48:51], v136, s[4:7], s47 offen offset:0 sc1
    v_lshlrev_b32 v8, 16, v96
    v_and_b32 v9, 0xffff0000, v96
    v_lshlrev_b32 v10, 16, v97
    v_and_b32 v11, 0xffff0000, v97
    v_lshlrev_b32 v12, 16, v98
    v_and_b32 v13, 0xffff0000, v98
    v_lshlrev_b32 v14, 16, v99
    v_and_b32 v15, 0xffff0000, v99
    v_lshlrev_b32 v16, 16, v100
    v_and_b32 v17, 0xffff0000, v100
    v_lshlrev_b32 v18, 16, v101
    v_and_b32 v19, 0xffff0000, v101
    v_lshlrev_b32 v20, 16, v102
    v_and_b32 v21, 0xffff0000, v102
    v_lshlrev_b32 v22, 16, v103
    v_and_b32 v23, 0xffff0000, v103
    ds_read_b128 v[68:71], v1 offset:0
    ds_read_b128 v[72:75], v1 offset:1024
    ds_read_b128 v[76:79], v1 offset:2048
    ds_read_b128 v[80:83], v1 offset:3072
    ds_read_b128 v[84:87], v1 offset:4096
    ds_read_b128 v[88:91], v1 offset:5120
    ds_read_b128 v[92:95], v1 offset:6144
    ds_read_b128 v[96:99], v1 offset:7168
    ds_read_b128 v[100:103], v1 offset:8192
    ds_read_b128 v[104:107], v1 offset:9216
    ds_read_b128 v[108:111], v1 offset:10240
    ds_read_b128 v[112:115], v1 offset:11264
    ds_read_b128 v[116:119], v1 offset:12288
    ds_read_b128 v[120:123], v1 offset:13312
    ds_read_b128 v[124:127], v1 offset:14336
    s_waitcnt vmcnt(7)
    s_cmp_lg_u32 s23, 0
    s_mov_b64 exec, 1
    s_cbranch_scc1 WS_11
    buffer_store_dword v7, off, s[4:7], s54 offset:896
WB_12:
    s_mov_b64 exec, -1
    s_waitcnt vmcnt(7) lgkmcnt(11)
    v_mfma_f32_16x16x32_bf16 v[8:11], v[68:71], v[24:27], v[8:11]
    ds_read_b128 v[68:71], v1 offset:15360
    v_mfma_f32_16x16x32_bf16 v[12:15], v[72:75], v[24:27], v[12:15]
    buffer_load_dwordx4 v[52:55], v136, s[4:7], s47 offen offset:1024 sc1
    ds_read_b128 v[72:75], v1 offset:16384
    v_mfma_f32_16x16x32_bf16 v[16:19], v[76:79], v[24:27], v[16:19]
    ds_read_b128 v[76:79], v1 offset:17408
    v_mfma_f32_16x16x32_bf16 v[20:23], v[80:83], v[24:27], v[20:23]
    s_waitcnt vmcnt(7) lgkmcnt(10)
    ds_read_b128 v[80:83], v1 offset:18432
    v_mfma_f32_16x16x32_bf16 v[8:11], v[84:87], v[28:31], v[8:11]
    ds_read_b128 v[84:87], v1 offset:19456
    v_mfma_f32_16x16x32_bf16 v[12:15], v[88:91], v[28:31], v[12:15]
    buffer_load_dwordx4 v[24:27], v136, s[4:7], s48 offen offset:0 sc1
    ds_read_b128 v[88:91], v1 offset:20480
    v_mfma_f32_16x16x32_bf16 v[16:19], v[92:95], v[28:31], v[16:19]
    ds_read_b128 v[92:95], v1 offset:21504
    v_mfma_f32_16x16x32_bf16 v[20:23], v[96:99], v[28:31], v[20:23]
    s_waitcnt vmcnt(7) lgkmcnt(10)
    ds_read_b128 v[96:99], v1 offset:22528
    v_mfma_f32_16x16x32_bf16 v[8:11], v[100:103], v[32:35], v[8:11]
    ds_read_b128 v[100:103], v1 offset:23552
    v_lshrrev_b32 v138, 1, v3
    v_mfma_f32_16x16x32_bf16 v[12:15], v[104:107], v[32:35], v[12:15]
    buffer_load_dwordx4 v[28:31], v136, s[4:7], s48 offen offset:1024 sc1
    ds_read_b128 v[104:107], v1 offset:24576
    v_mfma_f32_16x16x32_bf16 v[16:19], v[108:111], v[32:35], v[16:19]
    ds_read_b128 v[108:111], v1 offset:25600
    v_lshlrev_b32 v138, 2, v138
    v_mfma_f32_16x16x32_bf16 v[20:23], v[112:115], v[32:35], v[20:23]
    s_waitcnt vmcnt(7) lgkmcnt(10)
    ds_read_b128 v[112:115], v1 offset:26624
    v_lshl_add_u32 v138, v2, 3, v138
    v_mfma_f32_16x16x32_bf16 v[8:11], v[116:119], v[36:39], v[8:11]
    ds_read_b128 v[116:119], v1 offset:27648
    v_lshrrev_b32 v5, 1, v3
    v_mfma_f32_16x16x32_bf16 v[12:15], v[120:123], v[36:39], v[12:15]
    buffer_load_dwordx4 v[32:35], v136, s[4:7], s49 offen offset:0 sc1
    ds_read_b128 v[120:123], v1 offset:28672
    v_mfma_f32_16x16x32_bf16 v[16:19], v[124:127], v[36:39], v[16:19]
    ds_read_b128 v[124:127], v1 offset:29696
    v_lshlrev_b32 v5, 8, v5
    v_mfma_f32_16x16x32_bf16 v[20:23], v[68:71], v[36:39], v[20:23]
    s_waitcnt vmcnt(7) lgkmcnt(10)
    ds_read_b128 v[68:71], v1 offset:30720
    v_lshl_add_u32 v5, v2, 4, v5
    v_mfma_f32_16x16x32_bf16 v[8:11], v[72:75], v[40:43], v[8:11]
    ds_read_b128 v[72:75], v1 offset:31744
    v_and_b32 v4, 1, v3
    v_mfma_f32_16x16x32_bf16 v[12:15], v[76:79], v[40:43], v[12:15]
    buffer_load_dwordx4 v[36:39], v136, s[4:7], s49 offen offset:1024 sc1
    ds_read_b128 v[76:79], v1 offset:32768
    v_mfma_f32_16x16x32_bf16 v[16:19], v[80:83], v[40:43], v[16:19]
    ds_read_b128 v[80:83], v1 offset:33792
    v_lshl_add_u32 v5, v4, 3, v5
    v_mfma_f32_16x16x32_bf16 v[20:23], v[84:87], v[40:43], v[20:23]
    s_waitcnt vmcnt(7) lgkmcnt(10)
    ds_read_b128 v[84:87], v1 offset:34816
    v_lshrrev_b32 v139, 1, v1
    v_mfma_f32_16x16x32_bf16 v[8:11], v[88:91], v[44:47], v[8:11]
    ds_read_b128 v[88:91], v1 offset:35840
    v_add_u32 v139, 147456, v139
    v_mfma_f32_16x16x32_bf16 v[12:15], v[92:95], v[44:47], v[12:15]
    buffer_load_dwordx4 v[40:43], v136, s[4:7], s50 offen offset:0 sc1
    ds_read_b128 v[92:95], v1 offset:36864
    v_mfma_f32_16x16x32_bf16 v[16:19], v[96:99], v[44:47], v[16:19]
    ds_read_b128 v[96:99], v1 offset:37888
    s_lshl_b32 s28, s14, 12
    v_mfma_f32_16x16x32_bf16 v[20:23], v[100:103], v[44:47], v[20:23]
    s_waitcnt vmcnt(7) lgkmcnt(10)
    ds_read_b128 v[100:103], v1 offset:38912
    s_lshl_b32 s29, s14, 10
    v_mfma_f32_16x16x32_bf16 v[8:11], v[104:107], v[48:51], v[8:11]
    ds_read_b128 v[104:107], v1 offset:39936
    s_add_u32 s29, s29, 147456
    v_mfma_f32_16x16x32_bf16 v[12:15], v[108:111], v[48:51], v[12:15]
    buffer_load_dwordx4 v[44:47], v136, s[4:7], s50 offen offset:1024 sc1
    ds_read_b128 v[108:111], v1 offset:40960
    v_mfma_f32_16x16x32_bf16 v[16:19], v[112:115], v[48:51], v[16:19]
    ds_read_b128 v[112:115], v1 offset:41984
    s_mov_b32 s92, s56
    v_mfma_f32_16x16x32_bf16 v[20:23], v[116:119], v[48:51], v[20:23]
    s_waitcnt vmcnt(6) lgkmcnt(10)
    ds_read_b128 v[116:119], v1 offset:43008
    s_mov_b32 s93, s57
    v_mfma_f32_16x16x32_bf16 v[8:11], v[120:123], v[52:55], v[8:11]
    ds_read_b128 v[120:123], v1 offset:44032
    s_lshr_b32 s24, s2, 3
    v_mfma_f32_16x16x32_bf16 v[12:15], v[124:127], v[52:55], v[12:15]
    buffer_load_dwordx4 v[48:51], v136, s[4:7], s51 offen offset:0 sc1
    ds_read_b128 v[124:127], v1 offset:45056
    v_mfma_f32_16x16x32_bf16 v[16:19], v[68:71], v[52:55], v[16:19]
    ds_read_b128 v[68:71], v1 offset:46080
    s_xor_b32 s25, s14, 3
    v_mfma_f32_16x16x32_bf16 v[20:23], v[72:75], v[52:55], v[20:23]
    s_waitcnt vmcnt(6) lgkmcnt(10)
    ds_read_b128 v[72:75], v1 offset:47104
    s_or_b32 s24, s24, s25
    v_mfma_f32_16x16x32_bf16 v[8:11], v[76:79], v[24:27], v[8:11]
    ds_read_b128 v[76:79], v1 offset:48128
    s_xor_b32 s25, s3, 1
    v_mfma_f32_16x16x32_bf16 v[12:15], v[80:83], v[24:27], v[12:15]
    buffer_load_dwordx4 v[52:55], v136, s[4:7], s51 offen offset:1024 sc1
    ds_read_b128 v[80:83], v1 offset:49152
    v_mfma_f32_16x16x32_bf16 v[16:19], v[84:87], v[24:27], v[16:19]
    ds_read_b128 v[84:87], v1 offset:50176
    s_or_b32 s94, s24, s25
    v_mfma_f32_16x16x32_bf16 v[20:23], v[88:91], v[24:27], v[20:23]
    s_waitcnt vmcnt(6) lgkmcnt(10)
    ds_read_b128 v[88:91], v1 offset:51200
    s_add_u32 s88, s22, 256
    v_mfma_f32_16x16x32_bf16 v[8:11], v[92:95], v[28:31], v[8:11]
    ds_read_b128 v[92:95], v1 offset:52224
    s_add_u32 s89, s22, 384
    v_mfma_f32_16x16x32_bf16 v[12:15], v[96:99], v[28:31], v[12:15]
    buffer_load_dwordx4 v[144:147], v1, s[4:7], s64 offen offset:2048
    ds_read_b128 v[96:99], v1 offset:53248
    v_mfma_f32_16x16x32_bf16 v[16:19], v[100:103], v[28:31], v[16:19]
    ds_read_b128 v[100:103], v1 offset:54272
    s_add_u32 s90, s22, 512
    v_mfma_f32_16x16x32_bf16 v[20:23], v[104:107], v[28:31], v[20:23]
    s_waitcnt vmcnt(6) lgkmcnt(10)
    ds_read_b128 v[104:107], v1 offset:55296
    s_add_u32 s91, s22, 640
    v_mfma_f32_16x16x32_bf16 v[8:11], v[108:111], v[32:35], v[8:11]
    ds_read_b128 v[108:111], v1 offset:56320
    s_mov_b32 s100, s43
    v_mfma_f32_16x16x32_bf16 v[12:15], v[112:115], v[32:35], v[12:15]
    buffer_load_dwordx4 v[148:151], v1, s[4:7], s64 offen offset:3072
    ds_read_b128 v[112:115], v1 offset:57344
    v_mfma_f32_16x16x32_bf16 v[16:19], v[116:119], v[32:35], v[16:19]
    ds_read_b128 v[116:119], v1 offset:58368
    s_mov_b32 s101, s43
    v_mfma_f32_16x16x32_bf16 v[20:23], v[120:123], v[32:35], v[20:23]
    s_waitcnt vmcnt(6) lgkmcnt(10)
    ds_read_b128 v[120:123], v1 offset:59392
    s_xor_b32 s98, s3, 1
    v_mfma_f32_16x16x32_bf16 v[8:11], v[124:127], v[36:39], v[8:11]
    ds_read_b128 v[124:127], v1 offset:60416
    s_or_b32 s98, s98, s23
    v_mfma_f32_16x16x32_bf16 v[12:15], v[68:71], v[36:39], v[12:15]
    buffer_load_dwordx4 v1, s[4:7], s65 offen offset:0 lds
    ds_read_b128 v[68:71], v1 offset:61440
    v_mfma_f32_16x16x32_bf16 v[16:19], v[72:75], v[36:39], v[16:19]
    ds_read_b128 v[72:75], v1 offset:62464
    v_mfma_f32_16x16x32_bf16 v[20:23], v[76:79], v[36:39], v[20:23]
    s_waitcnt vmcnt(6) lgkmcnt(10)
    ds_read_b128 v[76:79], v1 offset:63488
    v_mfma_f32_16x16x32_bf16 v[8:11], v[80:83], v[40:43], v[8:11]
    ds_read_b128 v[80:83], v1 offset:64512
    v_mfma_f32_16x16x32_bf16 v[12:15], v[84:87], v[40:43], v[12:15]
    buffer_load_dwordx4 v1, s[4:7], s65 offen offset:1024 lds
    v_mfma_f32_16x16x32_bf16 v[16:19], v[88:91], v[40:43], v[16:19]
    v_mfma_f32_16x16x32_bf16 v[20:23], v[92:95], v[40:43], v[20:23]
    s_waitcnt vmcnt(6) lgkmcnt(8)
    v_mfma_f32_16x16x32_bf16 v[8:11], v[96:99], v[44:47], v[8:11]
    v_mfma_f32_16x16x32_bf16 v[12:15], v[100:103], v[44:47], v[12:15]
    buffer_load_dwordx4 v1, s[4:7], s65 offen offset:2048 lds
    v_mfma_f32_16x16x32_bf16 v[16:19], v[104:107], v[44:47], v[16:19]
    v_mfma_f32_16x16x32_bf16 v[20:23], v[108:111], v[44:47], v[20:23]
    s_waitcnt vmcnt(6) lgkmcnt(4)
    v_mfma_f32_16x16x32_bf16 v[8:11], v[112:115], v[48:51], v[8:11]
    v_mfma_f32_16x16x32_bf16 v[12:15], v[116:119], v[48:51], v[12:15]
    buffer_load_dwordx4 v1, s[4:7], s65 offen offset:3072 lds
    v_mfma_f32_16x16x32_bf16 v[16:19], v[120:123], v[48:51], v[16:19]
    v_mfma_f32_16x16x32_bf16 v[20:23], v[124:127], v[48:51], v[20:23]
    s_waitcnt vmcnt(6) lgkmcnt(0)
    v_mfma_f32_16x16x32_bf16 v[8:11], v[68:71], v[52:55], v[8:11]
    v_mfma_f32_16x16x32_bf16 v[12:15], v[72:75], v[52:55], v[12:15]
    v_mfma_f32_16x16x32_bf16 v[16:19], v[76:79], v[52:55], v[16:19]
    v_mfma_f32_16x16x32_bf16 v[20:23], v[80:83], v[52:55], v[20:23]
    s_nop 4
    v_cvt_pk_bf16_f32 v24, v8, v9
    v_cvt_pk_bf16_f32 v25, v10, v11
    v_cvt_pk_bf16_f32 v26, v12, v13
    v_cvt_pk_bf16_f32 v27, v14, v15
    buffer_store_dwordx4 v[24:27], v1, s[4:7], s52 offen offset:0
    v_cvt_pk_bf16_f32 v28, v16, v17
    v_cvt_pk_bf16_f32 v29, v18, v19
    v_cvt_pk_bf16_f32 v30, v20, v21
    v_cvt_pk_bf16_f32 v31, v22, v23
    buffer_store_dwordx4 v[28:31], v1, s[4:7], s52 offen offset:1024
    v_pk_add_f32 v[32:33], v[8:9], v[10:11]
    v_pk_mul_f32 v[34:35], v[8:9], v[8:9]
    v_pk_fma_f32 v[34:35], v[10:11], v[10:11], v[34:35]
    v_pk_add_f32 v[32:33], v[32:33], v[12:13]
    v_pk_fma_f32 v[34:35], v[12:13], v[12:13], v[34:35]
    v_pk_add_f32 v[32:33], v[32:33], v[14:15]
    v_pk_fma_f32 v[34:35], v[14:15], v[14:15], v[34:35]
    v_pk_add_f32 v[32:33], v[32:33], v[16:17]
    v_pk_fma_f32 v[34:35], v[16:17], v[16:17], v[34:35]
    v_pk_add_f32 v[32:33], v[32:33], v[18:19]
    v_pk_fma_f32 v[34:35], v[18:19], v[18:19], v[34:35]
    v_pk_add_f32 v[32:33], v[32:33], v[20:21]
    v_pk_fma_f32 v[34:35], v[20:21], v[20:21], v[34:35]
    v_pk_add_f32 v[32:33], v[32:33], v[22:23]
    v_pk_fma_f32 v[34:35], v[22:23], v[22:23], v[34:35]
    v_add_f32 v32, v32, v33
    v_add_f32 v34, v34, v35
    s_nop 1
    v_permlane32_swap_b32 v32, v34
    v_add_f32 v32, v32, v34
    v_mov_b32 v34, v32
    s_nop 1
    v_permlane16_swap_b32 v32, v34
    v_add_f32 v32, v32, v34
    buffer_store_dword v32, v138, s[4:7], s53 offen
    s_cmp_lg_u32 s23, 0
    s_cbranch_scc1 DS_13
DB_14:
    s_add_u32 m0, s28, 0
    s_cmp_ge_u32 s14, 2
    s_cbranch_scc1 X1_JOIN
    v_mfma_f32_16x16x32_bf16 v[56:59], a[0:3], v[128:131], 0
    v_mfma_f32_16x16x32_bf16 v[60:63], a[64:67], v[128:131], 0
    v_mfma_f32_16x16x32_bf16 v[64:67], a[128:131], v[128:131], 0
    v_mfma_f32_16x16x32_bf16 v[56:59], a[4:7], v[128:131], v[56:59]
    v_mfma_f32_16x16x32_bf16 v[60:63], a[68:71], v[128:131], v[60:63]
    v_mfma_f32_16x16x32_bf16 v[64:67], a[132:135], v[128:131], v[64:67]
    v_mfma_f32_16x16x32_bf16 v[56:59], a[8:11], v[128:131], v[56:59]
    v_mfma_f32_16x16x32_bf16 v[60:63], a[72:75], v[128:131], v[60:63]
    v_mfma_f32_16x16x32_bf16 v[64:67], a[136:139], v[128:131], v[64:67]
    v_mfma_f32_16x16x32_bf16 v[56:59], a[12:15], v[128:131], v[56:59]
    v_mfma_f32_16x16x32_bf16 v[60:63], a[76:79], v[128:131], v[60:63]
    v_mfma_f32_16x16x32_bf16 v[64:67], a[140:143], v[128:131], v[64:67]
    v_mfma_f32_16x16x32_bf16 v[56:59], a[16:19], v[128:131], v[56:59]
    v_mfma_f32_16x16x32_bf16 v[60:63], a[80:83], v[128:131], v[60:63]
    v_mfma_f32_16x16x32_bf16 v[64:67], a[144:147], v[128:131], v[64:67]
    s_waitcnt vmcnt(0)
    s_cmp_lg_u32 s23, 0
    s_mov_b64 exec, 1
    s_cbranch_scc1 WS_15
    buffer_store_dword v7, off, s[4:7], s54 offset:128
WB_16:
    s_mov_b64 exec, -1
    v_and_b32 v44, 0x74, v137
    v_mfma_f32_16x16x32_bf16 v[56:59], a[20:23], v[128:131], v[56:59]
    v_mfma_f32_16x16x32_bf16 v[60:63], a[84:87], v[128:131], v[60:63]
    v_mfma_f32_16x16x32_bf16 v[64:67], a[148:151], v[128:131], v[64:67]
    v_mfma_f32_16x16x32_bf16 v[56:59], a[24:27], v[128:131], v[56:59]
    v_mfma_f32_16x16x32_bf16 v[60:63], a[88:91], v[128:131], v[60:63]
    v_mfma_f32_16x16x32_bf16 v[64:67], a[152:155], v[128:131], v[64:67]
    v_mfma_f32_16x16x32_bf16 v[56:59], a[28:31], v[128:131], v[56:59]
    v_mfma_f32_16x16x32_bf16 v[60:63], a[92:95], v[128:131], v[60:63]
    v_mfma_f32_16x16x32_bf16 v[64:67], a[156:159], v[128:131], v[64:67]
    v_mfma_f32_16x16x32_bf16 v[56:59], a[32:35], v[128:131], v[56:59]
    v_mfma_f32_16x16x32_bf16 v[60:63], a[96:99], v[128:131], v[60:63]
    v_mfma_f32_16x16x32_bf16 v[64:67], a[160:163], v[128:131], v[64:67]
    v_mfma_f32_16x16x32_bf16 v[56:59], a[36:39], v[128:131], v[56:59]
    v_mfma_f32_16x16x32_bf16 v[60:63], a[100:103], v[128:131], v[60:63]
    v_mfma_f32_16x16x32_bf16 v[64:67], a[164:167], v[128:131], v[64:67]
    s_mov_b32 s25, 0
WP_17:
    buffer_load_dword v4, v44, s[4:7], s22 offen offset:128 sc1
    s_add_u32 s25, s25, 1
    s_waitcnt vmcnt(0)
    s_cmp_gt_u32 s25, 400000
    s_cbranch_scc1 WD_18
    v_cmp_ne_u32 vcc, s43, v4
    s_nop 1
    s_cbranch_vccnz WP_17
WD_18:
X1_JOIN:
    v_mov_b32 v136, v139
    s_barrier
    buffer_load_dwordx4 v1, s[4:7], s59 offen offset:0 sc1 lds
    buffer_load_dwordx4 v1, s[4:7], s59 offen offset:1024 sc1 lds
    buffer_load_dwordx4 v1, s[4:7], s59 offen offset:2048 sc1 lds
    buffer_load_dwordx4 v1, s[4:7], s59 offen offset:3072 sc1 lds
    s_mov_b32 m0, s29
    s_add_u32 s59, s59, 16384
    buffer_load_dwordx4 v1, s[4:7], s66 offen sc1 lds
    s_add_u32 m0, s28, 16384
    s_barrier
    buffer_load_dwordx4 v1, s[4:7], s59 offen offset:0 sc1 lds
    buffer_load_dwordx4 v1, s[4:7], s59 offen offset:1024 sc1 lds
    buffer_load_dwordx4 v1, s[4:7], s59 offen offset:2048 sc1 lds
    buffer_load_dwordx4 v1, s[4:7], s59 offen offset:3072 sc1 lds
    v_mfma_f32_16x16x32_bf16 v[56:59], a[40:43], v[128:131], v[56:59]
    v_mfma_f32_16x16x32_bf16 v[60:63], a[104:107], v[128:131], v[60:63]
    v_mfma_f32_16x16x32_bf16 v[64:67], a[168:171], v[128:131], v[64:67]
    v_mfma_f32_16x16x32_bf16 v[56:59], a[44:47], v[128:131], v[56:59]
    v_mfma_f32_16x16x32_bf16 v[60:63], a[108:111], v[128:131], v[60:63]
    v_mfma_f32_16x16x32_bf16 v[64:67], a[172:175], v[128:131], v[64:67]
    v_mfma_f32_16x16x32_bf16 v[56:59], a[48:51], v[128:131], v[56:59]
    v_mfma_f32_16x16x32_bf16 v[60:63], a[112:115], v[128:131], v[60:63]
    v_mfma_f32_16x16x32_bf16 v[64:67], a[176:179], v[128:131], v[64:67]
    v_mfma_f32_16x16x32_bf16 v[56:59], a[52:55], v[128:131], v[56:59]
    v_mfma_f32_16x16x32_bf16 v[60:63], a[116:119], v[128:131], v[60:63]
    v_mfma_f32_16x16x32_bf16 v[64:67], a[180:183], v[128:131], v[64:67]
    v_mfma_f32_16x16x32_bf16 v[56:59], a[56:59], v[128:131], v[56:59]
    v_mfma_f32_16x16x32_bf16 v[60:63], a[120:123], v[128:131], v[60:63]
    v_mfma_f32_16x16x32_bf16 v[64:67], a[184:187], v[128:131], v[64:67]
    v_mfma_f32_16x16x32_bf16 v[56:59], a[60:63], v[128:131], v[56:59]
    v_mfma_f32_16x16x32_bf16 v[60:63], a[124:127], v[128:131], v[60:63]
    v_mfma_f32_16x16x32_bf16 v[64:67], a[188:191], v[128:131], v[64:67]
    s_waitcnt vmcnt(4)
    s_barrier
    ds_read_b128 v[68:71], v1 offset:0
    ds_read_b128 v[72:75], v1 offset:1024
    ds_read_b128 v[76:79], v1 offset:2048
    ds_read_b128 v[80:83], v1 offset:3072
    ds_read_b128 v[84:87], v1 offset:4096
    s_waitcnt lgkmcnt(4)
    v_mfma_f32_16x16x32_bf16 v[92:95], a[0:3], v[68:71], 0
    ds_read_b128 v[88:91], v1 offset:5120
    v_mfma_f32_16x16x32_bf16 v[96:99], a[64:67], v[68:71], 0
    ds_read_b64 v[24:25], v136 offset:0
    ds_read_b64 v[26:27], v136 offset:512
    v_mfma_f32_16x16x32_bf16 v[100:103], a[128:131], v[68:71], 0
    s_waitcnt lgkmcnt(6)
    v_mfma_f32_16x16x32_bf16 v[92:95], a[4:7], v[72:75], v[92:95]
    ds_read_b128 v[68:71], v1 offset:6144
    v_mfma_f32_16x16x32_bf16 v[96:99], a[68:71], v[72:75], v[96:99]
    ds_read_b64 v[28:29], v136 offset:1024
    ds_read_b64 v[30:31], v136 offset:1536
    v_mfma_f32_16x16x32_bf16 v[100:103], a[132:135], v[72:75], v[100:103]
    s_waitcnt lgkmcnt(8)
    v_mfma_f32_16x16x32_bf16 v[92:95], a[8:11], v[76:79], v[92:95]
    ds_read_b128 v[72:75], v1 offset:7168
    v_mfma_f32_16x16x32_bf16 v[96:99], a[72:75], v[76:79], v[96:99]
    ds_read_b64 v[32:33], v136 offset:2048
    ds_read_b64 v[34:35], v136 offset:2560
    v_mfma_f32_16x16x32_bf16 v[100:103], a[136:139], v[76:79], v[100:103]
    s_cmp_lg_u32 s23, 0
    s_mov_b64 exec, 1
    s_cbranch_scc1 WS_19
    buffer_store_dword v7, off, s[4:7], s54 offset:128
WB_20:
    s_mov_b64 exec, -1
    s_waitcnt lgkmcnt(10)
    v_mfma_f32_16x16x32_bf16 v[92:95], a[12:15], v[80:83], v[92:95]
    ds_read_b128 v[76:79], v1 offset:8192
    v_mfma_f32_16x16x32_bf16 v[96:99], a[76:79], v[80:83], v[96:99]
    ds_read_b64 v[36:37], v136 offset:3072
    ds_read_b64 v[38:39], v136 offset:3584
    v_mfma_f32_16x16x32_bf16 v[100:103], a[140:143], v[80:83], v[100:103]
    s_waitcnt lgkmcnt(12)
    v_mfma_f32_16x16x32_bf16 v[92:95], a[16:19], v[84:87], v[92:95]
    ds_read_b128 v[80:83], v1 offset:9216
    v_mfma_f32_16x16x32_bf16 v[96:99], a[80:83], v[84:87], v[96:99]
    v_mfma_f32_16x16x32_bf16 v[100:103], a[144:147], v[84:87], v[100:103]
    s_waitcnt lgkmcnt(12)
    v_mfma_f32_16x16x32_bf16 v[92:95], a[20:23], v[88:91], v[92:95]
    ds_read_b128 v[84:87], v1 offset:10240
    v_mfma_f32_16x16x32_bf16 v[96:99], a[84:87], v[88:91], v[96:99]
    v_mfma_f32_16x16x32_bf16 v[100:103], a[148:151], v[88:91], v[100:103]
    s_waitcnt lgkmcnt(10)
    v_mfma_f32_16x16x32_bf16 v[92:95], a[24:27], v[68:71], v[92:95]
    ds_read_b128 v[88:91], v1 offset:11264
    s_waitcnt lgkmcnt(3)
    v_add_f32 v24, v24, v26
    v_mfma_f32_16x16x32_bf16 v[96:99], a[88:91], v[68:71], v[96:99]
    v_add_f32 v25, v25, v27
    v_add_f32 v28, v28, v30
    v_mfma_f32_16x16x32_bf16 v[100:103], a[152:155], v[68:71], v[100:103]
    v_add_f32 v29, v29, v31
    v_add_f32 v32, v32, v34
    v_mfma_f32_16x16x32_bf16 v[92:95], a[28:31], v[72:75], v[92:95]
    ds_read_b128 v[68:71], v1 offset:12288
    v_add_f32 v33, v33, v35
    v_mfma_f32_16x16x32_bf16 v[96:99], a[92:95], v[72:75], v[96:99]
    buffer_load_dword v4, v137, s[4:7], s22 offen offset:128 sc1
    v_mfma_f32_16x16x32_bf16 v[100:103], a[156:159], v[72:75], v[100:103]
    v_add_f32 v36, v36, v38
    v_add_f32 v37, v37, v39
    v_mfma_f32_16x16x32_bf16 v[92:95], a[32:35], v[76:79], v[92:95]
    ds_read_b128 v[72:75], v1 offset:13312
    v_add_f32 v24, v24, v28
    v_mfma_f32_16x16x32_bf16 v[96:99], a[96:99], v[76:79], v[96:99]
    s_waitcnt vmcnt(2)
    s_barrier
    v_mfma_f32_16x16x32_bf16 v[100:103], a[160:163], v[76:79], v[100:103]
    s_waitcnt lgkmcnt(4)
    v_add_f32 v25, v25, v29
    v_add_f32 v32, v32, v36
    v_mfma_f32_16x16x32_bf16 v[92:95], a[36:39], v[80:83], v[92:95]
    ds_read_b128 v[76:79], v1 offset:14336
    v_add_f32 v33, v33, v37
    v_mfma_f32_16x16x32_bf16 v[96:99], a[100:103], v[80:83], v[96:99]
    v_add_f32 v24, v24, v32
    v_add_f32 v25, v25, v33
    v_mfma_f32_16x16x32_bf16 v[100:103], a[164:167], v[80:83], v[100:103]
    s_waitcnt lgkmcnt(4)
    v_mul_f32 v24, 0x3b000000, v24
    v_mul_f32 v25, 0x3b000000, v25
    v_mfma_f32_16x16x32_bf16 v[92:95], a[40:43], v[84:87], v[92:95]
    ds_read_b128 v[80:83], v1 offset:15360
    v_fma_f32 v25, -v24, v24, v25
    v_mfma_f32_16x16x32_bf16 v[96:99], a[104:107], v[84:87], v[96:99]
    v_max_f32 v25, 0, v25
    v_add_f32 v25, 0x3727c5ac, v25
    v_mfma_f32_16x16x32_bf16 v[100:103], a[168:171], v[84:87], v[100:103]
    s_waitcnt lgkmcnt(4)
    v_rsq_f32 v40, v25
    v_mfma_f32_16x16x32_bf16 v[92:95], a[44:47], v[88:91], v[92:95]
    ds_read_b128 v[84:87], v1 offset:16384
    v_mul_f32 v40, 0x3fb8aa3b, v40
    v_mfma_f32_16x16x32_bf16 v[96:99], a[108:111], v[88:91], v[96:99]
    v_mul_f32 v41, v24, v40
    v_mov_b32 v138, v40
    v_mfma_f32_16x16x32_bf16 v[100:103], a[172:175], v[88:91], v[100:103]
    s_waitcnt lgkmcnt(4)
    v_mov_b32 v134, v41
    s_nop 0
    v_mfma_f32_16x16x32_bf16 v[92:95], a[48:51], v[68:71], v[92:95]
    ds_read_b128 v[88:91], v1 offset:17408
    v_permlane32_swap_b32 v138, v40
    v_mfma_f32_16x16x32_bf16 v[96:99], a[112:115], v[68:71], v[96:99]
    v_permlane32_swap_b32 v134, v41
    v_mov_b32 v139, v138
    v_mfma_f32_16x16x32_bf16 v[100:103], a[176:179], v[68:71], v[100:103]
    s_waitcnt lgkmcnt(4)
    v_mov_b32 v135, v134
    s_nop 0
    v_mfma_f32_16x16x32_bf16 v[92:95], a[52:55], v[72:75], v[92:95]
    ds_read_b128 v[68:71], v1 offset:18432
    v_permlane16_swap_b32 v138, v139
    v_mfma_f32_16x16x32_bf16 v[96:99], a[116:119], v[72:75], v[96:99]
    s_waitcnt vmcnt(0)
    v_cmp_ne_u32 vcc, s43, v4
    s_nop 1
    s_cbranch_vccnz XS_21
XO_22:
    v_mfma_f32_16x16x32_bf16 v[100:103], a[180:183], v[72:75], v[100:103]
    s_add_u32 s59, s59, 16384
    s_add_u32 m0, m0, 16384
    s_waitcnt lgkmcnt(4)
    v_permlane16_swap_b32 v134, v135
    v_mfma_f32_16x16x32_bf16 v[92:95], a[56:59], v[76:79], v[92:95]
    ds_read_b128 v[72:75], v1 offset:19456
    v_mfma_f32_16x16x32_bf16 v[96:99], a[120:123], v[76:79], v[96:99]
    buffer_load_dwordx4 v1, s[4:7], s59 offen offset:0 sc1 lds
    v_mfma_f32_16x16x32_bf16 v[100:103], a[184:187], v[76:79], v[100:103]
    buffer_load_dwordx4 v1, s[4:7], s59 offen offset:1024 sc1 lds
    s_waitcnt lgkmcnt(4)
    v_mfma_f32_16x16x32_bf16 v[92:95], a[60:63], v[80:83], v[92:95]
    ds_read_b128 v[76:79], v1 offset:20480
    v_mfma_f32_16x16x32_bf16 v[96:99], a[124:127], v[80:83], v[96:99]
    buffer_load_dwordx4 v1, s[4:7], s59 offen offset:2048 sc1 lds
    v_mfma_f32_16x16x32_bf16 v[100:103], a[188:191], v[80:83], v[100:103]
    buffer_load_dwordx4 v1, s[4:7], s59 offen offset:3072 sc1 lds
    s_waitcnt lgkmcnt(4)
    v_mfma_f32_16x16x32_bf16 v[104:107], a[0:3], v[84:87], 0
    ds_read_b128 v[80:83], v1 offset:21504
    v_mfma_f32_16x16x32_bf16 v[108:111], a[64:67], v[84:87], 0
    s_mov_b32 m0, s29
    v_mfma_f32_16x16x32_bf16 v[112:115], a[128:131], v[84:87], 0
    buffer_load_dwordx4 v1, s[4:7], s66 offen sc1 lds
    s_waitcnt lgkmcnt(4)
    v_mul_f32 v92, v92, v138
    v_mfma_f32_16x16x32_bf16 v[104:107], a[4:7], v[88:91], v[104:107]
    ds_read_b128 v[84:87], v1 offset:22528
    v_mul_f32 v93, v93, v138
    v_mul_f32 v94, v94, v138
    v_mfma_f32_16x16x32_bf16 v[108:111], a[68:71], v[88:91], v[108:111]
    s_add_u32 s59, s59, 16384
    s_add_u32 m0, s28, 49152
    v_fma_f32 v92, -v56, v134, v92
    v_mul_f32 v95, v95, v138
    v_mfma_f32_16x16x32_bf16 v[112:115], a[132:135], v[88:91], v[112:115]
    buffer_load_dwordx4 v1, s[4:7], s59 offen offset:0 sc1 lds
    s_waitcnt lgkmcnt(4)
    v_fma_f32 v93, -v57, v134, v93
    v_mfma_f32_16x16x32_bf16 v[104:107], a[8:11], v[68:71], v[104:107]
    ds_read_b128 v[88:91], v1 offset:23552
    v_mul_f32 v96, v96, v138
    v_mfma_f32_16x16x32_bf16 v[108:111], a[72:75], v[68:71], v[108:111]
    buffer_load_dwordx4 v1, s[4:7], s59 offen offset:1024 sc1 lds
    v_mfma_f32_16x16x32_bf16 v[112:115], a[136:139], v[68:71], v[112:115]
    buffer_load_dwordx4 v1, s[4:7], s59 offen offset:2048 sc1 lds
    s_waitcnt lgkmcnt(4)
    v_mfma_f32_16x16x32_bf16 v[104:107], a[12:15], v[72:75], v[104:107]
    ds_read_b128 v[68:71], v1 offset:24576
    v_exp_f32 v116, -v92
    v_mfma_f32_16x16x32_bf16 v[108:111], a[76:79], v[72:75], v[108:111]
    buffer_load_dwordx4 v1, s[4:7], s59 offen offset:3072 sc1 lds
    v_fma_f32 v94, -v58, v134, v94
    v_mfma_f32_16x16x32_bf16 v[112:115], a[140:143], v[72:75], v[112:115]
    s_waitcnt lgkmcnt(4)
    v_mul_f32 v97, v97, v138
    v_exp_f32 v117, -v93
    v_mfma_f32_16x16x32_bf16 v[104:107], a[16:19], v[76:79], v[104:107]
    ds_read_b128 v[72:75], v1 offset:25600
    v_fma_f32 v95, -v59, v134, v95
    v_mul_f32 v98, v98, v138
    v_mfma_f32_16x16x32_bf16 v[108:111], a[80:83], v[76:79], v[108:111]
    s_cmp_eq_u32 s94, 0
    s_cbranch_scc1 WBL_23
    buffer_load_dword v4, off, s[4:7], s6
WBL_24:
    v_mfma_f32_16x16x32_bf16 v[112:115], a[144:147], v[76:79], v[112:115]
    s_waitcnt lgkmcnt(4)
    v_exp_f32 v118, -v94
    v_fma_f32 v96, -v60, v134, v96
    v_mfma_f32_16x16x32_bf16 v[104:107], a[20:23], v[80:83], v[104:107]
    ds_read_b128 v[76:79], v1 offset:26624
    v_add_f32 v116, 1.0, v116
    v_mul_f32 v99, v99, v138
    v_mfma_f32_16x16x32_bf16 v[108:111], a[84:87], v[80:83], v[108:111]
    v_exp_f32 v119, -v95
    v_fma_f32 v97, -v61, v134, v97
    v_mfma_f32_16x16x32_bf16 v[112:115], a[148:151], v[80:83], v[112:115]
    s_waitcnt lgkmcnt(4)
    v_add_f32 v117, 1.0, v117
    v_mul_f32 v100, v100, v138
    v_mfma_f32_16x16x32_bf16 v[104:107], a[24:27], v[84:87], v[104:107]
    ds_read_b128 v[80:83], v1 offset:27648
    v_exp_f32 v120, -v96
    v_mfma_f32_16x16x32_bf16 v[108:111], a[88:91], v[84:87], v[108:111]
    v_fma_f32 v98, -v62, v134, v98
    v_add_f32 v118, 1.0, v118
    v_mfma_f32_16x16x32_bf16 v[112:115], a[152:155], v[84:87], v[112:115]
    s_waitcnt lgkmcnt(4)
    v_rcp_f32 v116, v116
    v_mul_f32 v101, v101, v138
    v_mfma_f32_16x16x32_bf16 v[104:107], a[28:31], v[88:91], v[104:107]
    ds_read_b128 v[84:87], v1 offset:28672
    v_exp_f32 v121, -v97
    v_mfma_f32_16x16x32_bf16 v[108:111], a[92:95], v[88:91], v[108:111]
    v_fma_f32 v99, -v63, v134, v99
    v_add_f32 v119, 1.0, v119
    v_mfma_f32_16x16x32_bf16 v[112:115], a[156:159], v[88:91], v[112:115]
    s_waitcnt lgkmcnt(4)
    v_rcp_f32 v117, v117
    v_mul_f32 v102, v102, v138
    v_mfma_f32_16x16x32_bf16 v[104:107], a[32:35], v[68:71], v[104:107]
    ds_read_b128 v[88:91], v1 offset:29696
    v_exp_f32 v122, -v98
    v_mfma_f32_16x16x32_bf16 v[108:111], a[96:99], v[68:71], v[108:111]
    v_fma_f32 v100, -v64, v134, v100
    v_add_f32 v120, 1.0, v120
    v_mfma_f32_16x16x32_bf16 v[112:115], a[160:163], v[68:71], v[112:115]
    s_waitcnt lgkmcnt(4)
    v_rcp_f32 v118, v118
    v_mul_f32 v92, v92, v116
    v_mfma_f32_16x16x32_bf16 v[104:107], a[36:39], v[72:75], v[104:107]
    ds_read_b128 v[68:71], v1 offset:30720
    v_mul_f32 v103, v103, v138
    v_mfma_f32_16x16x32_bf16 v[108:111], a[100:103], v[72:75], v[108:111]
    v_exp_f32 v123, -v99
    v_fma_f32 v101, -v65, v134, v101
    v_mfma_f32_16x16x32_bf16 v[112:115], a[164:167], v[72:75], v[112:115]
    s_waitcnt lgkmcnt(4)
    v_add_f32 v121, 1.0, v121
    v_rcp_f32 v119, v119
    v_mfma_f32_16x16x32_bf16 v[104:107], a[40:43], v[76:79], v[104:107]
    ds_read_b128 v[72:75], v1 offset:31744
    v_mul_f32 v93, v93, v117
    v_exp_f32 v124, -v100
    v_mfma_f32_16x16x32_bf16 v[108:111], a[104:107], v[76:79], v[108:111]
    s_waitcnt vmcnt(5)
    s_barrier
    v_fma_f32 v102, -v66, v134, v102
    v_mfma_f32_16x16x32_bf16 v[112:115], a[168:171], v[76:79], v[112:115]
    s_waitcnt lgkmcnt(4)
    v_add_f32 v122, 1.0, v122
    v_rcp_f32 v120, v120
    v_mfma_f32_16x16x32_bf16 v[104:107], a[44:47], v[80:83], v[104:107]
    ds_read_b128 v[76:79], v1 offset:32768
    v_mul_f32 v94, v94, v118
    v_exp_f32 v125, -v101
    v_mfma_f32_16x16x32_bf16 v[108:111], a[108:111], v[80:83], v[108:111]
    ds_read_b64 v[24:25], v136 offset:0
    ds_read_b64 v[26:27], v136 offset:512
    v_fma_f32 v103, -v67, v134, v103
    v_mfma_f32_16x16x32_bf16 v[112:115], a[172:175], v[80:83], v[112:115]
    s_waitcnt lgkmcnt(6)
    v_add_f32 v123, 1.0, v123
    v_rcp_f32 v121, v121
    v_mfma_f32_16x16x32_bf16 v[104:107], a[48:51], v[84:87], v[104:107]
    ds_read_b128 v[80:83], v1 offset:33792
    v_mul_f32 v95, v95, v119
    v_cvt_pk_bf16_f32 v128, v92, v93
    v_mfma_f32_16x16x32_bf16 v[108:111], a[112:115], v[84:87], v[108:111]
    ds_read_b64 v[28:29], v136 offset:1024
    ds_read_b64 v[30:31], v136 offset:1536
    v_exp_f32 v126, -v102
    v_mfma_f32_16x16x32_bf16 v[112:115], a[176:179], v[84:87], v[112:115]
    s_waitcnt lgkmcnt(8)
    v_add_f32 v124, 1.0, v124
    v_rcp_f32 v122, v122
    v_mfma_f32_16x16x32_bf16 v[104:107], a[52:55], v[88:91], v[104:107]
    ds_read_b128 v[84:87], v1 offset:34816
    v_mul_f32 v96, v96, v120
    v_exp_f32 v127, -v103
    v_mfma_f32_16x16x32_bf16 v[108:111], a[116:119], v[88:91], v[108:111]
    ds_read_b64 v[32:33], v136 offset:2048
    ds_read_b64 v[34:35], v136 offset:2560
    v_add_f32 v125, 1.0, v125
    v_mfma_f32_16x16x32_bf16 v[112:115], a[180:183], v[88:91], v[112:115]
    s_waitcnt lgkmcnt(10)
    v_rcp_f32 v123, v123
    v_mul_f32 v97, v97, v121
    v_cvt_pk_bf16_f32 v129, v94, v95
    v_mfma_f32_16x16x32_bf16 v[104:107], a[56:59], v[68:71], v[104:107]
    ds_read_b128 v[88:91], v1 offset:35840
    v_add_f32 v126, 1.0, v126
    v_rcp_f32 v124, v124
    v_mfma_f32_16x16x32_bf16 v[108:111], a[120:123], v[68:71], v[108:111]
    ds_read_b64 v[36:37], v136 offset:3072
    ds_read_b64 v[38:39], v136 offset:3584
    v_mul_f32 v98, v98, v122
    v_add_f32 v127, 1.0, v127
    v_mfma_f32_16x16x32_bf16 v[112:115], a[184:187], v[68:71], v[112:115]
    s_waitcnt lgkmcnt(12)
    v_rcp_f32 v125, v125
    v_mul_f32 v99, v99, v123
    v_cvt_pk_bf16_f32 v130, v96, v97
    v_mfma_f32_16x16x32_bf16 v[104:107], a[60:63], v[72:75], v[104:107]
    ds_read_b128 v[68:71], v1 offset:36864
    v_rcp_f32 v126, v126
    v_mul_f32 v100, v100, v124
    v_mfma_f32_16x16x32_bf16 v[108:111], a[124:127], v[72:75], v[108:111]
    v_rcp_f32 v127, v127
    v_mul_f32 v101, v101, v125
    v_cvt_pk_bf16_f32 v131, v98, v99
    v_mfma_f32_16x16x32_bf16 v[112:115], a[188:191], v[72:75], v[112:115]
    s_waitcnt lgkmcnt(12)
    v_mul_f32 v102, v102, v126
    v_mul_f32 v103, v103, v127
    v_cvt_pk_bf16_f32 v132, v100, v101
    v_cvt_pk_bf16_f32 v133, v102, v103
    v_mfma_f32_16x16x32_bf16 v[92:95], a[0:3], v[76:79], 0
    ds_read_b128 v[72:75], v1 offset:37888
    v_mfma_f32_16x16x32_bf16 v[96:99], a[64:67], v[76:79], 0
    buffer_store_dwordx4 v[128:131], v1, s[4:7], s56 offen sc1
    buffer_store_dwordx2 v[132:133], v5, s[4:7], s57 offen sc1
    v_mfma_f32_16x16x32_bf16 v[100:103], a[128:131], v[76:79], 0
    s_waitcnt lgkmcnt(10)
    s_waitcnt lgkmcnt(2)
    v_mul_f32 v104, v104, v139
    v_mul_f32 v105, v105, v139
    v_mul_f32 v106, v106, v139
    v_mfma_f32_16x16x32_bf16 v[92:95], a[4:7], v[80:83], v[92:95]
    ds_read_b128 v[76:79], v1 offset:38912
    v_fma_f32 v104, -v56, v135, v104
    v_mul_f32 v107, v107, v139
    v_mfma_f32_16x16x32_bf16 v[96:99], a[68:71], v[80:83], v[96:99]
    s_add_u32 s56, s56, 45056
    v_fma_f32 v105, -v57, v135, v105
    v_mul_f32 v108, v108, v139
    v_exp_f32 v116, -v104
    v_mfma_f32_16x16x32_bf16 v[100:103], a[132:135], v[80:83], v[100:103]
    v_fma_f32 v106, -v58, v135, v106
    v_mul_f32 v109, v109, v139
    v_exp_f32 v117, -v105
    v_mfma_f32_16x16x32_bf16 v[92:95], a[8:11], v[84:87], v[92:95]
    ds_read_b128 v[80:83], v1 offset:39936
    v_fma_f32 v107, -v59, v135, v107
    v_mul_f32 v110, v110, v139
    v_mfma_f32_16x16x32_bf16 v[96:99], a[72:75], v[84:87], v[96:99]
    s_add_u32 s57, s57, 45056
    v_exp_f32 v118, -v106
    v_fma_f32 v108, -v60, v135, v108
    v_mfma_f32_16x16x32_bf16 v[100:103], a[136:139], v[84:87], v[100:103]
    v_add_f32 v116, 1.0, v116
    v_mul_f32 v111, v111, v139
    v_exp_f32 v119, -v107
    v_mfma_f32_16x16x32_bf16 v[92:95], a[12:15], v[88:91], v[92:95]
    ds_read_b128 v[84:87], v1 offset:40960
    v_fma_f32 v109, -v61, v135, v109
    v_add_f32 v117, 1.0, v117
    v_mfma_f32_16x16x32_bf16 v[96:99], a[76:79], v[88:91], v[96:99]
    v_add_f32 v24, v24, v26
    v_add_f32 v25, v25, v27
    v_add_f32 v28, v28, v30
    v_mfma_f32_16x16x32_bf16 v[100:103], a[140:143], v[88:91], v[100:103]
    s_waitcnt lgkmcnt(4)
    v_add_f32 v29, v29, v31
    v_add_f32 v32, v32, v34
    v_add_f32 v33, v33, v35
    v_mfma_f32_16x16x32_bf16 v[92:95], a[16:19], v[68:71], v[92:95]
    ds_read_b128 v[88:91], v1 offset:41984
    v_add_f32 v36, v36, v38
    v_add_f32 v37, v37, v39
    v_mfma_f32_16x16x32_bf16 v[96:99], a[80:83], v[68:71], v[96:99]
    v_add_f32 v24, v24, v28
    v_add_f32 v25, v25, v29
    v_add_f32 v32, v32, v36
    v_mfma_f32_16x16x32_bf16 v[100:103], a[144:147], v[68:71], v[100:103]
    s_waitcnt lgkmcnt(4)
    v_add_f32 v33, v33, v37
    v_add_f32 v24, v24, v32
    v_add_f32 v25, v25, v33
    v_mfma_f32_16x16x32_bf16 v[92:95], a[20:23], v[72:75], v[92:95]
    ds_read_b128 v[68:71], v1 offset:43008
    v_mul_f32 v24, 0x3b000000, v24
    v_mul_f32 v25, 0x3b000000, v25
    v_mfma_f32_16x16x32_bf16 v[96:99], a[84:87], v[72:75], v[96:99]
    v_fma_f32 v25, -v24, v24, v25
    v_max_f32 v25, 0, v25
    v_add_f32 v25, 0x3727c5ac, v25
    v_mfma_f32_16x16x32_bf16 v[100:103], a[148:151], v[72:75], v[100:103]
    s_waitcnt lgkmcnt(4)
    v_rsq_f32 v40, v25
    s_nop 0
    v_mul_f32 v40, 0x3fb8aa3b, v40
    v_mfma_f32_16x16x32_bf16 v[92:95], a[24:27], v[76:79], v[92:95]
    ds_read_b128 v[72:75], v1 offset:44032
    v_mul_f32 v41, v24, v40
    v_mov_b32 v140, v40
    v_mfma_f32_16x16x32_bf16 v[96:99], a[88:91], v[76:79], v[96:99]
    v_mov_b32 v142, v41
    s_nop 0
    v_permlane32_swap_b32 v40, v140
    v_mfma_f32_16x16x32_bf16 v[100:103], a[152:155], v[76:79], v[100:103]
    s_waitcnt lgkmcnt(4)
    v_permlane32_swap_b32 v41, v142
    v_mov_b32 v141, v140
    v_mov_b32 v143, v142
    v_mfma_f32_16x16x32_bf16 v[92:95], a[28:31], v[80:83], v[92:95]
    ds_read_b128 v[76:79], v1 offset:45056
    s_nop 0
    v_permlane16_swap_b32 v140, v141
    v_mfma_f32_16x16x32_bf16 v[96:99], a[92:95], v[80:83], v[96:99]
    v_permlane16_swap_b32 v142, v143
    v_mul_f32 v112, v112, v139
    v_exp_f32 v120, -v108
    v_mfma_f32_16x16x32_bf16 v[100:103], a[156:159], v[80:83], v[100:103]
    s_waitcnt lgkmcnt(4)
    v_fma_f32 v110, -v62, v135, v110
    v_add_f32 v118, 1.0, v118
    v_rcp_f32 v116, v116
    v_mfma_f32_16x16x32_bf16 v[92:95], a[32:35], v[84:87], v[92:95]
    ds_read_b128 v[80:83], v1 offset:46080
    v_mul_f32 v113, v113, v139
    v_exp_f32 v121, -v109
    v_mfma_f32_16x16x32_bf16 v[96:99], a[96:99], v[84:87], v[96:99]
    s_waitcnt vmcnt(3)
    s_barrier
    v_fma_f32 v111, -v63, v135, v111
    v_mfma_f32_16x16x32_bf16 v[100:103], a[160:163], v[84:87], v[100:103]
    s_waitcnt lgkmcnt(4)
    v_add_f32 v119, 1.0, v119
    v_rcp_f32 v117, v117
    v_mfma_f32_16x16x32_bf16 v[92:95], a[36:39], v[88:91], v[92:95]
    ds_read_b128 v[84:87], v1 offset:47104
    v_mul_f32 v114, v114, v139
    v_exp_f32 v122, -v110
    v_mfma_f32_16x16x32_bf16 v[96:99], a[100:103], v[88:91], v[96:99]
    v_fma_f32 v112, -v64, v135, v112
    v_add_f32 v120, 1.0, v120
    v_rcp_f32 v118, v118
    v_mfma_f32_16x16x32_bf16 v[100:103], a[164:167], v[88:91], v[100:103]
    s_waitcnt lgkmcnt(4)
    v_mul_f32 v104, v104, v116
    v_mul_f32 v115, v115, v139
    v_exp_f32 v123, -v111
    v_mfma_f32_16x16x32_bf16 v[92:95], a[40:43], v[68:71], v[92:95]
    ds_read_b128 v[88:91], v1 offset:48128
    v_fma_f32 v113, -v65, v135, v113
    v_add_f32 v121, 1.0, v121
    v_mfma_f32_16x16x32_bf16 v[96:99], a[104:107], v[68:71], v[96:99]
    v_rcp_f32 v119, v119
    v_mul_f32 v105, v105, v117
    v_mfma_f32_16x16x32_bf16 v[100:103], a[168:171], v[68:71], v[100:103]
    s_waitcnt lgkmcnt(4)
    v_exp_f32 v124, -v112
    v_fma_f32 v114, -v66, v135, v114
    v_mfma_f32_16x16x32_bf16 v[92:95], a[44:47], v[72:75], v[92:95]
    ds_read_b128 v[68:71], v1 offset:49152
    v_add_f32 v122, 1.0, v122
    v_rcp_f32 v120, v120
    v_mfma_f32_16x16x32_bf16 v[96:99], a[108:111], v[72:75], v[96:99]
    v_mul_f32 v106, v106, v118
    v_exp_f32 v125, -v113
    v_mfma_f32_16x16x32_bf16 v[100:103], a[172:175], v[72:75], v[100:103]
    s_waitcnt lgkmcnt(4)
    v_fma_f32 v115, -v67, v135, v115
    v_add_f32 v123, 1.0, v123
    v_rcp_f32 v121, v121
    v_mfma_f32_16x16x32_bf16 v[92:95], a[48:51], v[76:79], v[92:95]
    ds_read_b128 v[72:75], v1 offset:50176
    v_mul_f32 v107, v107, v119
    v_cvt_pk_bf16_f32 v128, v104, v105
    v_mfma_f32_16x16x32_bf16 v[96:99], a[112:115], v[76:79], v[96:99]
    v_exp_f32 v126, -v114
    v_add_f32 v124, 1.0, v124
    v_mfma_f32_16x16x32_bf16 v[100:103], a[176:179], v[76:79], v[100:103]
    s_waitcnt lgkmcnt(4)
    v_rcp_f32 v122, v122
    v_mul_f32 v108, v108, v120
    v_mfma_f32_16x16x32_bf16 v[92:95], a[52:55], v[80:83], v[92:95]
    ds_read_b128 v[76:79], v1 offset:51200
    v_exp_f32 v127, -v115
    v_mfma_f32_16x16x32_bf16 v[96:99], a[116:119], v[80:83], v[96:99]
    s_waitcnt vmcnt(0)
    s_barrier
    s_cmp_lg_u32 s14, 0
    s_cbranch_scc1 FS_25
    s_cmp_lg_u32 s23, 0
    s_cbranch_scc1 FSS_26
    s_mov_b64 exec, 1
    buffer_store_dword v7, off, s[4:7], s19 offset:256
    s_mov_b64 exec, -1
FS_25:
    v_add_f32 v125, 1.0, v125
    v_mfma_f32_16x16x32_bf16 v[100:103], a[180:183], v[80:83], v[100:103]
    s_waitcnt lgkmcnt(4)
    v_rcp_f32 v123, v123
    v_mul_f32 v109, v109, v121
    v_cvt_pk_bf16_f32 v129, v106, v107
    v_mfma_f32_16x16x32_bf16 v[92:95], a[56:59], v[84:87], v[92:95]
    ds_read_b128 v[80:83], v1 offset:52224
    v_add_f32 v126, 1.0, v126
    v_rcp_f32 v124, v124
    v_mfma_f32_16x16x32_bf16 v[96:99], a[120:123], v[84:87], v[96:99]
    v_mul_f32 v110, v110, v122
    v_add_f32 v127, 1.0, v127
    v_rcp_f32 v125, v125
    v_mfma_f32_16x16x32_bf16 v[100:103], a[184:187], v[84:87], v[100:103]
    s_waitcnt lgkmcnt(4)
    v_mul_f32 v111, v111, v123
    v_cvt_pk_bf16_f32 v130, v108, v109
    v_rcp_f32 v126, v126
    v_mfma_f32_16x16x32_bf16 v[92:95], a[60:63], v[88:91], v[92:95]
    ds_read_b128 v[84:87], v1 offset:53248
    v_mul_f32 v112, v112, v124
    v_rcp_f32 v127, v127
    v_mfma_f32_16x16x32_bf16 v[96:99], a[124:127], v[88:91], v[96:99]
    v_mul_f32 v113, v113, v125
    v_cvt_pk_bf16_f32 v131, v110, v111
    v_mul_f32 v114, v114, v126
    v_mfma_f32_16x16x32_bf16 v[100:103], a[188:191], v[88:91], v[100:103]
    s_waitcnt lgkmcnt(4)
    v_mul_f32 v115, v115, v127
    v_cvt_pk_bf16_f32 v132, v112, v113
    v_cvt_pk_bf16_f32 v133, v114, v115
    v_mfma_f32_16x16x32_bf16 v[104:107], a[0:3], v[68:71], 0
    ds_read_b128 v[88:91], v1 offset:54272
    v_mfma_f32_16x16x32_bf16 v[108:111], a[64:67], v[68:71], 0
    buffer_store_dwordx4 v[128:131], v1, s[4:7], s56 offen sc1
    buffer_store_dwordx2 v[132:133], v5, s[4:7], s57 offen sc1
    v_mfma_f32_16x16x32_bf16 v[112:115], a[128:131], v[68:71], 0
    s_waitcnt lgkmcnt(4)
    v_mul_f32 v92, v92, v140
    v_mul_f32 v93, v93, v140
    v_mul_f32 v94, v94, v140
    v_mfma_f32_16x16x32_bf16 v[104:107], a[4:7], v[72:75], v[104:107]
    ds_read_b128 v[68:71], v1 offset:55296
    v_fma_f32 v92, -v56, v142, v92
    v_mul_f32 v95, v95, v140
    v_mfma_f32_16x16x32_bf16 v[108:111], a[68:71], v[72:75], v[108:111]
    s_add_u32 s56, s56, 45056
    v_fma_f32 v93, -v57, v142, v93
    v_mul_f32 v96, v96, v140
    v_mfma_f32_16x16x32_bf16 v[112:115], a[132:135], v[72:75], v[112:115]
    s_waitcnt lgkmcnt(4)
    v_exp_f32 v116, -v92
    v_fma_f32 v94, -v58, v142, v94
    v_mfma_f32_16x16x32_bf16 v[104:107], a[8:11], v[76:79], v[104:107]
    ds_read_b128 v[72:75], v1 offset:56320
    v_mul_f32 v97, v97, v140
    v_mfma_f32_16x16x32_bf16 v[108:111], a[72:75], v[76:79], v[108:111]
    s_add_u32 s57, s57, 45056
    v_exp_f32 v117, -v93
    v_fma_f32 v95, -v59, v142, v95
    v_mfma_f32_16x16x32_bf16 v[112:115], a[136:139], v[76:79], v[112:115]
    s_waitcnt lgkmcnt(4)
    v_mul_f32 v98, v98, v140
    v_exp_f32 v118, -v94
    v_mfma_f32_16x16x32_bf16 v[104:107], a[12:15], v[80:83], v[104:107]
    ds_read_b128 v[76:79], v1 offset:57344
    v_fma_f32 v96, -v60, v142, v96
    v_mfma_f32_16x16x32_bf16 v[108:111], a[76:79], v[80:83], v[108:111]
    s_buffer_load_dwordx8 s[80:87], s[4:7], s88
    v_add_f32 v116, 1.0, v116
    v_mfma_f32_16x16x32_bf16 v[112:115], a[140:143], v[80:83], v[112:115]
    s_waitcnt lgkmcnt(4)
    v_mul_f32 v99, v99, v140
    v_exp_f32 v119, -v95
    v_mfma_f32_16x16x32_bf16 v[104:107], a[16:19], v[84:87], v[104:107]
    ds_read_b128 v[80:83], v1 offset:58368
    v_fma_f32 v97, -v61, v142, v97
    v_add_f32 v117, 1.0, v117
    v_mfma_f32_16x16x32_bf16 v[108:111], a[80:83], v[84:87], v[108:111]
    v_mul_f32 v100, v100, v140
    v_exp_f32 v120, -v96
    v_mfma_f32_16x16x32_bf16 v[112:115], a[144:147], v[84:87], v[112:115]
    s_waitcnt lgkmcnt(4)
    v_fma_f32 v98, -v62, v142, v98
    v_add_f32 v118, 1.0, v118
    v_mfma_f32_16x16x32_bf16 v[104:107], a[20:23], v[88:91], v[104:107]
    ds_read_b128 v[84:87], v1 offset:59392
    v_rcp_f32 v116, v116
    v_mfma_f32_16x16x32_bf16 v[108:111], a[84:87], v[88:91], v[108:111]
    v_mul_f32 v101, v101, v140
    v_exp_f32 v121, -v97
    v_mfma_f32_16x16x32_bf16 v[112:115], a[148:151], v[88:91], v[112:115]
    s_waitcnt lgkmcnt(4)
    v_fma_f32 v99, -v63, v142, v99
    v_add_f32 v119, 1.0, v119
    v_mfma_f32_16x16x32_bf16 v[104:107], a[24:27], v[68:71], v[104:107]
    ds_read_b128 v[88:91], v1 offset:60416
    v_rcp_f32 v117, v117
    v_mfma_f32_16x16x32_bf16 v[108:111], a[88:91], v[68:71], v[108:111]
    v_mul_f32 v102, v102, v140
    v_exp_f32 v122, -v98
    v_mfma_f32_16x16x32_bf16 v[112:115], a[152:155], v[68:71], v[112:115]
    s_waitcnt lgkmcnt(4)
    v_fma_f32 v100, -v64, v142, v100
    v_add_f32 v120, 1.0, v120
    v_mfma_f32_16x16x32_bf16 v[104:107], a[28:31], v[72:75], v[104:107]
    ds_read_b128 v[68:71], v1 offset:61440
    v_rcp_f32 v118, v118
    v_mfma_f32_16x16x32_bf16 v[108:111], a[92:95], v[72:75], v[108:111]
    v_mul_f32 v92, v92, v116
    v_mul_f32 v103, v103, v140
    v_mfma_f32_16x16x32_bf16 v[112:115], a[156:159], v[72:75], v[112:115]
    s_waitcnt lgkmcnt(4)
    v_exp_f32 v123, -v99
    v_fma_f32 v101, -v65, v142, v101
    v_mfma_f32_16x16x32_bf16 v[104:107], a[32:35], v[76:79], v[104:107]
    ds_read_b128 v[72:75], v1 offset:62464
    v_add_f32 v121, 1.0, v121
    v_mfma_f32_16x16x32_bf16 v[108:111], a[96:99], v[76:79], v[108:111]
    v_rcp_f32 v119, v119
    v_mul_f32 v93, v93, v117
    v_mfma_f32_16x16x32_bf16 v[112:115], a[160:163], v[76:79], v[112:115]
    s_waitcnt lgkmcnt(4)
    v_exp_f32 v124, -v100
    v_fma_f32 v102, -v66, v142, v102
    v_mfma_f32_16x16x32_bf16 v[104:107], a[36:39], v[80:83], v[104:107]
    ds_read_b128 v[76:79], v1 offset:63488
    v_add_f32 v122, 1.0, v122
    v_mfma_f32_16x16x32_bf16 v[108:111], a[100:103], v[80:83], v[108:111]
    s_waitcnt lgkmcnt(0)
    s_and_b64 s[24:25], s[80:81], s[82:83]
    s_and_b64 s[26:27], s[84:85], s[86:87]
    s_and_b64 s[24:25], s[24:25], s[26:27]
    s_or_b64 s[80:81], s[80:81], s[82:83]
    s_or_b64 s[84:85], s[84:85], s[86:87]
    s_or_b64 s[80:81], s[80:81], s[84:85]
    s_and_b32 s24, s24, s25
    s_or_b32 s25, s80, s81
    s_cmp_eq_u64 s[24:25], s[100:101]
    s_cbranch_scc0 HSLOW_27
HOK_28:
    v_mfma_f32_16x16x32_bf16 v[112:115], a[164:167], v[80:83], v[112:115]
    buffer_load_dwordx4 v[24:27], v1, s[4:7], s58 offen offset:0 sc1
    v_mfma_f32_16x16x32_bf16 v[104:107], a[40:43], v[84:87], v[104:107]
    ds_read_b128 v[80:83], v1 offset:64512
    v_rcp_f32 v120, v120
    v_mfma_f32_16x16x32_bf16 v[108:111], a[104:107], v[84:87], v[108:111]
    v_mul_f32 v94, v94, v118
    v_exp_f32 v125, -v101
    v_mfma_f32_16x16x32_bf16 v[112:115], a[168:171], v[84:87], v[112:115]
    buffer_load_dwordx4 v[28:31], v1, s[4:7], s58 offen offset:1024 sc1
    v_fma_f32 v103, -v67, v142, v103
    v_mfma_f32_16x16x32_bf16 v[104:107], a[44:47], v[88:91], v[104:107]
    v_add_f32 v123, 1.0, v123
    v_mfma_f32_16x16x32_bf16 v[108:111], a[108:111], v[88:91], v[108:111]
    v_rcp_f32 v121, v121
    v_mul_f32 v95, v95, v119
    v_mfma_f32_16x16x32_bf16 v[112:115], a[172:175], v[88:91], v[112:115]
    buffer_load_dwordx4 v[32:35], v1, s[4:7], s58 offen offset:2048 sc1
    v_cvt_pk_bf16_f32 v128, v92, v93
    v_mfma_f32_16x16x32_bf16 v[104:107], a[48:51], v[68:71], v[104:107]
    v_exp_f32 v126, -v102
    v_mfma_f32_16x16x32_bf16 v[108:111], a[112:115], v[68:71], v[108:111]
    v_add_f32 v124, 1.0, v124
    v_rcp_f32 v122, v122
    v_mfma_f32_16x16x32_bf16 v[112:115], a[176:179], v[68:71], v[112:115]
    buffer_load_dwordx4 v[36:39], v1, s[4:7], s58 offen offset:3072 sc1
    v_mul_f32 v96, v96, v120
    v_mfma_f32_16x16x32_bf16 v[104:107], a[52:55], v[72:75], v[104:107]
    v_exp_f32 v127, -v103
    v_mfma_f32_16x16x32_bf16 v[108:111], a[116:119], v[72:75], v[108:111]
    s_waitcnt vmcnt(4)
    s_barrier
    s_cmp_lg_u32 s14, 0
    s_cbranch_scc1 FS_29
    s_cmp_lg_u32 s23, 0
    s_cbranch_scc1 FSS_30
    s_mov_b64 exec, 1
    buffer_store_dword v7, off, s[4:7], s19 offset:384
    s_mov_b64 exec, -1
FS_29:
    v_add_f32 v125, 1.0, v125
    v_mfma_f32_16x16x32_bf16 v[112:115], a[180:183], v[72:75], v[112:115]
    s_add_u32 s58, s58, 4096
    buffer_load_dwordx4 v[40:43], v1, s[4:7], s58 offen offset:0 sc1
    v_rcp_f32 v123, v123
    v_mfma_f32_16x16x32_bf16 v[104:107], a[56:59], v[76:79], v[104:107]
    v_mul_f32 v97, v97, v121
    v_cvt_pk_bf16_f32 v129, v94, v95
    v_add_f32 v126, 1.0, v126
    v_mfma_f32_16x16x32_bf16 v[108:111], a[120:123], v[76:79], v[108:111]
    buffer_load_dwordx4 v[44:47], v1, s[4:7], s58 offen offset:1024 sc1
    v_rcp_f32 v124, v124
    v_mfma_f32_16x16x32_bf16 v[112:115], a[184:187], v[76:79], v[112:115]
    s_waitcnt lgkmcnt(0)
    buffer_load_dwordx4 v[48:51], v1, s[4:7], s58 offen offset:2048 sc1
    v_mul_f32 v98, v98, v122
    v_add_f32 v127, 1.0, v127
    v_mfma_f32_16x16x32_bf16 v[104:107], a[60:63], v[80:83], v[104:107]
    v_rcp_f32 v125, v125
    v_mul_f32 v99, v99, v123
    v_cvt_pk_bf16_f32 v130, v96, v97
    v_mfma_f32_16x16x32_bf16 v[108:111], a[124:127], v[80:83], v[108:111]
    buffer_load_dwordx4 v[52:55], v1, s[4:7], s58 offen offset:3072 sc1
    v_rcp_f32 v126, v126
    v_mul_f32 v100, v100, v124
    v_mfma_f32_16x16x32_bf16 v[112:115], a[188:191], v[80:83], v[112:115]
    v_rcp_f32 v127, v127
    v_mul_f32 v101, v101, v125
    v_cvt_pk_bf16_f32 v131, v98, v99
    v_mul_f32 v102, v102, v126
    v_mul_f32 v103, v103, v127
    v_cvt_pk_bf16_f32 v132, v100, v101
    v_cvt_pk_bf16_f32 v133, v102, v103
    buffer_store_dwordx4 v[128:131], v1, s[4:7], s56 offen sc1
    buffer_store_dwordx2 v[132:133], v5, s[4:7], s57 offen sc1
    s_add_u32 s56, s56, 45056
    s_add_u32 s57, s57, 45056
    v_pk_mul_f32 v[104:105], v[104:105], v[140:141] op_sel:[0,1] op_sel_hi:[1,1]
    v_pk_mul_f32 v[106:107], v[106:107], v[140:141] op_sel:[0,1] op_sel_hi:[1,1]
    v_pk_mul_f32 v[108:109], v[108:109], v[140:141] op_sel:[0,1] op_sel_hi:[1,1]
    v_pk_mul_f32 v[110:111], v[110:111], v[140:141] op_sel:[0,1] op_sel_hi:[1,1]
    v_pk_mul_f32 v[112:113], v[112:113], v[140:141] op_sel:[0,1] op_sel_hi:[1,1]
    v_pk_mul_f32 v[114:115], v[114:115], v[140:141] op_sel:[0,1] op_sel_hi:[1,1]
    v_pk_fma_f32 v[104:105], v[56:57], v[142:143], v[104:105] op_sel:[0,1,0] op_sel_hi:[1,1,1] neg_lo:[1,0,0] neg_hi:[1,0,0]
    v_pk_fma_f32 v[106:107], v[58:59], v[142:143], v[106:107] op_sel:[0,1,0] op_sel_hi:[1,1,1] neg_lo:[1,0,0] neg_hi:[1,0,0]
    v_pk_fma_f32 v[108:109], v[60:61], v[142:143], v[108:109] op_sel:[0,1,0] op_sel_hi:[1,1,1] neg_lo:[1,0,0] neg_hi:[1,0,0]
    v_pk_fma_f32 v[110:111], v[62:63], v[142:143], v[110:111] op_sel:[0,1,0] op_sel_hi:[1,1,1] neg_lo:[1,0,0] neg_hi:[1,0,0]
    v_pk_fma_f32 v[112:113], v[64:65], v[142:143], v[112:113] op_sel:[0,1,0] op_sel_hi:[1,1,1] neg_lo:[1,0,0] neg_hi:[1,0,0]
    v_pk_fma_f32 v[114:115], v[66:67], v[142:143], v[114:115] op_sel:[0,1,0] op_sel_hi:[1,1,1] neg_lo:[1,0,0] neg_hi:[1,0,0]
    s_add_u32 s58, s58, 4096
    buffer_load_dwordx4 v[56:59], v1, s[4:7], s58 offen offset:0 sc1
    buffer_load_dwordx4 v[60:63], v1, s[4:7], s58 offen offset:1024 sc1
    buffer_load_dwordx4 v[64:67], v1, s[4:7], s58 offen offset:2048 sc1
    s_add_u32 s58, s58, 36864
    v_exp_f32 v116, -v104
    v_exp_f32 v117, -v105
    v_exp_f32 v118, -v106
    v_exp_f32 v119, -v107
    v_exp_f32 v120, -v108
    v_exp_f32 v121, -v109
    v_exp_f32 v122, -v110
    v_exp_f32 v123, -v111
    v_exp_f32 v124, -v112
    v_exp_f32 v125, -v113
    v_exp_f32 v126, -v114
    v_exp_f32 v127, -v115
    v_pk_add_f32 v[116:117], v[116:117], 1.0 op_sel_hi:[1,0]
    v_pk_add_f32 v[118:119], v[118:119], 1.0 op_sel_hi:[1,0]
    v_pk_add_f32 v[120:121], v[120:121], 1.0 op_sel_hi:[1,0]
    v_pk_add_f32 v[122:123], v[122:123], 1.0 op_sel_hi:[1,0]
    v_pk_add_f32 v[124:125], v[124:125], 1.0 op_sel_hi:[1,0]
    v_pk_add_f32 v[126:127], v[126:127], 1.0 op_sel_hi:[1,0]
    v_rcp_f32 v116, v116
    v_rcp_f32 v117, v117
    s_buffer_load_dwordx8 s[80:87], s[4:7], s89
    v_rcp_f32 v118, v118
    v_rcp_f32 v119, v119
    v_rcp_f32 v120, v120
    v_rcp_f32 v121, v121
    v_rcp_f32 v122, v122
    v_rcp_f32 v123, v123
    v_rcp_f32 v124, v124
    v_rcp_f32 v125, v125
    v_rcp_f32 v126, v126
    v_rcp_f32 v127, v127
    v_pk_mul_f32 v[104:105], v[104:105], v[116:117]
    v_pk_mul_f32 v[106:107], v[106:107], v[118:119]
    v_pk_mul_f32 v[108:109], v[108:109], v[120:121]
    v_pk_mul_f32 v[110:111], v[110:111], v[122:123]
    v_pk_mul_f32 v[112:113], v[112:113], v[124:125]
    v_pk_mul_f32 v[114:115], v[114:115], v[126:127]
    v_cvt_pk_bf16_f32 v128, v104, v105
    v_cvt_pk_bf16_f32 v129, v106, v107
    v_cvt_pk_bf16_f32 v130, v108, v109
    v_cvt_pk_bf16_f32 v131, v110, v111
    v_cvt_pk_bf16_f32 v132, v112, v113
    v_cvt_pk_bf16_f32 v133, v114, v115
    buffer_store_dwordx4 v[128:131], v1, s[4:7], s56 offen sc1
    buffer_store_dwordx2 v[132:133], v5, s[4:7], s57 offen sc1
    s_waitcnt vmcnt(14)
    v_mfma_f32_16x16x32_bf16 v[112:115], a[192:195], v[24:27], 0
    v_mfma_f32_16x16x32_bf16 v[116:119], a[196:199], v[24:27], 0
    v_mfma_f32_16x16x32_bf16 v[120:123], a[200:203], v[24:27], 0
    v_mfma_f32_16x16x32_bf16 v[124:127], a[204:207], v[24:27], 0
    s_waitcnt vmcnt(13)
    v_mfma_f32_16x16x32_bf16 v[112:115], a[208:211], v[28:31], v[112:115]
    v_mfma_f32_16x16x32_bf16 v[116:119], a[212:215], v[28:31], v[116:119]
    v_mfma_f32_16x16x32_bf16 v[120:123], a[216:219], v[28:31], v[120:123]
    v_mfma_f32_16x16x32_bf16 v[124:127], a[220:223], v[28:31], v[124:127]
    s_waitcnt vmcnt(12)
    v_mfma_f32_16x16x32_bf16 v[112:115], a[224:227], v[32:35], v[112:115]
    v_mfma_f32_16x16x32_bf16 v[116:119], a[228:231], v[32:35], v[116:119]
    v_mfma_f32_16x16x32_bf16 v[120:123], a[232:235], v[32:35], v[120:123]
    v_mfma_f32_16x16x32_bf16 v[124:127], a[236:239], v[32:35], v[124:127]
    s_waitcnt vmcnt(11)
    v_mfma_f32_16x16x32_bf16 v[112:115], a[240:243], v[36:39], v[112:115]
    s_waitcnt lgkmcnt(0)
    s_and_b64 s[24:25], s[80:81], s[82:83]
    s_and_b64 s[26:27], s[84:85], s[86:87]
    s_and_b64 s[24:25], s[24:25], s[26:27]
    s_or_b64 s[80:81], s[80:81], s[82:83]
    s_or_b64 s[84:85], s[84:85], s[86:87]
    s_or_b64 s[80:81], s[80:81], s[84:85]
    s_and_b32 s24, s24, s25
    s_or_b32 s25, s80, s81
    s_cmp_eq_u64 s[24:25], s[100:101]
    s_cbranch_scc0 HSLOW_31
HOK_32:
    v_mfma_f32_16x16x32_bf16 v[116:119], a[244:247], v[36:39], v[116:119]
    buffer_load_dwordx4 v[68:71], v1, s[4:7], s58 offen offset:0 sc1
    v_mfma_f32_16x16x32_bf16 v[120:123], a[248:251], v[36:39], v[120:123]
    v_mfma_f32_16x16x32_bf16 v[124:127], a[252:255], v[36:39], v[124:127]
    buffer_load_dwordx4 v[72:75], v1, s[4:7], s58 offen offset:1024 sc1
    s_waitcnt vmcnt(12)
    v_mfma_f32_16x16x32_bf16 v[112:115], v[152:155], v[40:43], v[112:115]
    s_waitcnt vmcnt(7)
    s_barrier
    s_cmp_lg_u32 s14, 0
    s_cbranch_scc1 FS_33
    s_cmp_lg_u32 s23, 0
    s_cbranch_scc1 FSS_34
    s_mov_b64 exec, 1
    buffer_store_dword v7, off, s[4:7], s19 offset:512
    s_mov_b64 exec, -1
FS_33:
    v_mfma_f32_16x16x32_bf16 v[116:119], v[156:159], v[40:43], v[116:119]
    buffer_load_dwordx4 v[76:79], v1, s[4:7], s58 offen offset:2048 sc1
    v_mfma_f32_16x16x32_bf16 v[120:123], v[160:163], v[40:43], v[120:123]
    v_mfma_f32_16x16x32_bf16 v[124:127], v[164:167], v[40:43], v[124:127]
    buffer_load_dwordx4 v[80:83], v1, s[4:7], s58 offen offset:3072 sc1
    v_mfma_f32_16x16x32_bf16 v[112:115], v[168:171], v[44:47], v[112:115]
    v_mfma_f32_16x16x32_bf16 v[116:119], v[172:175], v[44:47], v[116:119]
    s_add_u32 s58, s58, 4096
    buffer_load_dwordx4 v[84:87], v1, s[4:7], s58 offen offset:0 sc1
    v_mfma_f32_16x16x32_bf16 v[120:123], v[176:179], v[44:47], v[120:123]
    v_mfma_f32_16x16x32_bf16 v[124:127], v[180:183], v[44:47], v[124:127]
    v_mfma_f32_16x16x32_bf16 v[112:115], v[184:187], v[48:51], v[112:115]
    v_mfma_f32_16x16x32_bf16 v[116:119], v[188:191], v[48:51], v[116:119]
    buffer_load_dwordx4 v[88:91], v1, s[4:7], s58 offen offset:1024 sc1
    v_mfma_f32_16x16x32_bf16 v[120:123], v[192:195], v[48:51], v[120:123]
    v_mfma_f32_16x16x32_bf16 v[124:127], v[196:199], v[48:51], v[124:127]
    v_mfma_f32_16x16x32_bf16 v[112:115], v[200:203], v[52:55], v[112:115]
    v_mfma_f32_16x16x32_bf16 v[116:119], v[204:207], v[52:55], v[116:119]
    buffer_load_dwordx4 v[92:95], v1, s[4:7], s58 offen offset:2048 sc1
    v_mfma_f32_16x16x32_bf16 v[120:123], v[208:211], v[52:55], v[120:123]
    v_mfma_f32_16x16x32_bf16 v[124:127], v[212:215], v[52:55], v[124:127]
    s_waitcnt vmcnt(11)
    v_mfma_f32_16x16x32_bf16 v[112:115], v[216:219], v[56:59], v[112:115]
    v_mfma_f32_16x16x32_bf16 v[116:119], v[220:223], v[56:59], v[116:119]
    buffer_load_dwordx4 v[96:99], v1, s[4:7], s58 offen offset:3072 sc1
    v_mfma_f32_16x16x32_bf16 v[120:123], v[224:227], v[56:59], v[120:123]
    v_mfma_f32_16x16x32_bf16 v[124:127], v[228:231], v[56:59], v[124:127]
    s_waitcnt vmcnt(11)
    v_mfma_f32_16x16x32_bf16 v[112:115], v[232:235], v[60:63], v[112:115]
    v_mfma_f32_16x16x32_bf16 v[116:119], v[236:239], v[60:63], v[116:119]
    s_add_u32 s58, s58, 4096
    buffer_load_dwordx4 v[100:103], v1, s[4:7], s58 offen offset:0 sc1
    v_mfma_f32_16x16x32_bf16 v[120:123], v[240:243], v[60:63], v[120:123]
    s_buffer_load_dwordx8 s[80:87], s[4:7], s90
    v_mfma_f32_16x16x32_bf16 v[124:127], v[244:247], v[60:63], v[124:127]
    s_waitcnt vmcnt(11)
    v_mfma_f32_16x16x32_bf16 v[112:115], v[248:251], v[64:67], v[112:115]
    s_waitcnt vmcnt(9)
    s_barrier
    s_cmp_lg_u32 s14, 0
    s_cbranch_scc1 FS_35
    s_cmp_lg_u32 s23, 0
    s_cbranch_scc1 FSS_36
    s_mov_b64 exec, 1
    buffer_store_dword v7, off, s[4:7], s19 offset:640
    s_mov_b64 exec, -1
FS_35:
    v_add_u32 v5, s28, v1
    v_mfma_f32_16x16x32_bf16 v[116:119], v[252:255], v[64:67], v[116:119]
    buffer_load_dwordx4 v[104:107], v1, s[4:7], s58 offen offset:1024 sc1
    v_mfma_f32_16x16x32_bf16 v[120:123], v[144:147], v[64:67], v[120:123]
    v_mfma_f32_16x16x32_bf16 v[124:127], v[148:151], v[64:67], v[124:127]
    s_waitcnt vmcnt(9)
    v_mfma_f32_16x16x32_bf16 v[128:131], a[192:195], v[68:71], 0
    v_mfma_f32_16x16x32_bf16 v[132:135], a[196:199], v[68:71], 0
    buffer_load_dwordx4 v[108:111], v1, s[4:7], s58 offen offset:2048 sc1
    s_add_u32 s58, s58, 36864
    v_mfma_f32_16x16x32_bf16 v[136:139], a[200:203], v[68:71], 0
    v_mfma_f32_16x16x32_bf16 v[140:143], a[204:207], v[68:71], 0
    s_waitcnt vmcnt(9)
    v_mfma_f32_16x16x32_bf16 v[128:131], a[208:211], v[72:75], v[128:131]
    v_mfma_f32_16x16x32_bf16 v[132:135], a[212:215], v[72:75], v[132:135]
    v_mfma_f32_16x16x32_bf16 v[136:139], a[216:219], v[72:75], v[136:139]
    v_mfma_f32_16x16x32_bf16 v[140:143], a[220:223], v[72:75], v[140:143]
    s_waitcnt vmcnt(8)
    v_mfma_f32_16x16x32_bf16 v[128:131], a[224:227], v[76:79], v[128:131]
    v_mfma_f32_16x16x32_bf16 v[132:135], a[228:231], v[76:79], v[132:135]
    v_mfma_f32_16x16x32_bf16 v[136:139], a[232:235], v[76:79], v[136:139]
    v_mfma_f32_16x16x32_bf16 v[140:143], a[236:239], v[76:79], v[140:143]
    s_waitcnt vmcnt(7)
    v_mfma_f32_16x16x32_bf16 v[128:131], a[240:243], v[80:83], v[128:131]
    s_waitcnt lgkmcnt(0)
    s_and_b64 s[24:25], s[80:81], s[82:83]
    s_and_b64 s[26:27], s[84:85], s[86:87]
    s_and_b64 s[24:25], s[24:25], s[26:27]
    s_or_b64 s[80:81], s[80:81], s[82:83]
    s_or_b64 s[84:85], s[84:85], s[86:87]
    s_or_b64 s[80:81], s[80:81], s[84:85]
    s_and_b32 s24, s24, s25
    s_or_b32 s25, s80, s81
    s_cmp_eq_u64 s[24:25], s[100:101]
    s_cbranch_scc0 HSLOW_37
HOK_38:
    v_mfma_f32_16x16x32_bf16 v[132:135], a[244:247], v[80:83], v[132:135]
    buffer_load_dwordx4 v[24:27], v1, s[4:7], s58 offen offset:0 sc1
    v_mfma_f32_16x16x32_bf16 v[136:139], a[248:251], v[80:83], v[136:139]
    ds_write_b128 v5, v[112:115] offset:0
    v_mfma_f32_16x16x32_bf16 v[140:143], a[252:255], v[80:83], v[140:143]
    buffer_load_dwordx4 v[28:31], v1, s[4:7], s58 offen offset:1024 sc1
    s_waitcnt vmcnt(8)
    v_mfma_f32_16x16x32_bf16 v[128:131], v[152:155], v[84:87], v[128:131]
    v_mfma_f32_16x16x32_bf16 v[132:135], v[156:159], v[84:87], v[132:135]
    buffer_load_dwordx4 v[32:35], v1, s[4:7], s58 offen offset:2048 sc1
    v_mfma_f32_16x16x32_bf16 v[136:139], v[160:163], v[84:87], v[136:139]
    s_buffer_load_dwordx8 s[80:87], s[4:7], s91
    v_mfma_f32_16x16x32_bf16 v[140:143], v[164:167], v[84:87], v[140:143]
    buffer_load_dwordx4 v[36:39], v1, s[4:7], s58 offen offset:3072 sc1
    s_waitcnt vmcnt(9)
    v_mfma_f32_16x16x32_bf16 v[128:131], v[168:171], v[88:91], v[128:131]
    v_mfma_f32_16x16x32_bf16 v[132:135], v[172:175], v[88:91], v[132:135]
    s_add_u32 s58, s58, 4096
    buffer_load_dwordx4 v[40:43], v1, s[4:7], s58 offen offset:0 sc1
    v_mfma_f32_16x16x32_bf16 v[136:139], v[176:179], v[88:91], v[136:139]
    ds_write_b128 v5, v[116:119] offset:1024
    v_mfma_f32_16x16x32_bf16 v[140:143], v[180:183], v[88:91], v[140:143]
    s_waitcnt vmcnt(9)
    v_mfma_f32_16x16x32_bf16 v[128:131], v[184:187], v[92:95], v[128:131]
    v_mfma_f32_16x16x32_bf16 v[132:135], v[188:191], v[92:95], v[132:135]
    buffer_load_dwordx4 v[44:47], v1, s[4:7], s58 offen offset:1024 sc1
    v_mfma_f32_16x16x32_bf16 v[136:139], v[192:195], v[92:95], v[136:139]
    ds_write_b128 v5, v[120:123] offset:2048
    v_mfma_f32_16x16x32_bf16 v[140:143], v[196:199], v[92:95], v[140:143]
    s_waitcnt vmcnt(9)
    v_mfma_f32_16x16x32_bf16 v[128:131], v[200:203], v[96:99], v[128:131]
    v_mfma_f32_16x16x32_bf16 v[132:135], v[204:207], v[96:99], v[132:135]
    buffer_load_dwordx4 v[48:51], v1, s[4:7], s58 offen offset:2048 sc1
    v_mfma_f32_16x16x32_bf16 v[136:139], v[208:211], v[96:99], v[136:139]
    ds_write_b128 v5, v[124:127] offset:3072
    v_mfma_f32_16x16x32_bf16 v[140:143], v[212:215], v[96:99], v[140:143]
    s_waitcnt vmcnt(9)
    v_mfma_f32_16x16x32_bf16 v[128:131], v[216:219], v[100:103], v[128:131]
    v_mfma_f32_16x16x32_bf16 v[132:135], v[220:223], v[100:103], v[132:135]
    buffer_load_dwordx4 v[52:55], v1, s[4:7], s58 offen offset:3072 sc1
    v_mfma_f32_16x16x32_bf16 v[136:139], v[224:227], v[100:103], v[136:139]
    v_mfma_f32_16x16x32_bf16 v[140:143], v[228:231], v[100:103], v[140:143]
    s_waitcnt vmcnt(9)
    v_mfma_f32_16x16x32_bf16 v[128:131], v[232:235], v[104:107], v[128:131]
    s_waitcnt lgkmcnt(0)
    s_and_b64 s[24:25], s[80:81], s[82:83]
    s_and_b64 s[26:27], s[84:85], s[86:87]
    s_and_b64 s[24:25], s[24:25], s[26:27]
    s_or_b64 s[80:81], s[80:81], s[82:83]
    s_or_b64 s[84:85], s[84:85], s[86:87]
    s_or_b64 s[80:81], s[80:81], s[84:85]
    s_and_b32 s24, s24, s25
    s_or_b32 s25, s80, s81
    s_cmp_eq_u64 s[24:25], s[100:101]
    s_cbranch_scc0 HSLOW_39
HOK_40:
    v_mfma_f32_16x16x32_bf16 v[132:135], v[236:239], v[104:107], v[132:135]
    s_add_u32 s58, s58, 4096
    buffer_load_dwordx4 v[56:59], v1, s[4:7], s58 offen offset:0 sc1
    v_mfma_f32_16x16x32_bf16 v[136:139], v[240:243], v[104:107], v[136:139]
    v_mfma_f32_16x16x32_bf16 v[140:143], v[244:247], v[104:107], v[140:143]
    s_waitcnt vmcnt(9)
    v_mfma_f32_16x16x32_bf16 v[128:131], v[248:251], v[108:111], v[128:131]
    v_mfma_f32_16x16x32_bf16 v[132:135], v[252:255], v[108:111], v[132:135]
    buffer_load_dwordx4 v[60:63], v1, s[4:7], s58 offen offset:1024 sc1
    v_mfma_f32_16x16x32_bf16 v[136:139], v[144:147], v[108:111], v[136:139]
    v_mfma_f32_16x16x32_bf16 v[140:143], v[148:151], v[108:111], v[140:143]
    s_waitcnt vmcnt(9)
    v_mfma_f32_16x16x32_bf16 v[112:115], a[192:195], v[24:27], 0
    v_mfma_f32_16x16x32_bf16 v[116:119], a[196:199], v[24:27], 0
    buffer_load_dwordx4 v[64:67], v1, s[4:7], s58 offen offset:2048 sc1
    s_add_u32 s58, s58, 36864
    v_mfma_f32_16x16x32_bf16 v[120:123], a[200:203], v[24:27], 0
    v_mfma_f32_16x16x32_bf16 v[124:127], a[204:207], v[24:27], 0
    s_waitcnt vmcnt(9)
    v_mfma_f32_16x16x32_bf16 v[112:115], a[208:211], v[28:31], v[112:115]
    v_mfma_f32_16x16x32_bf16 v[116:119], a[212:215], v[28:31], v[116:119]
    buffer_load_dwordx4 v[68:71], v1, s[4:7], s58 offen offset:0 sc1
    v_mfma_f32_16x16x32_bf16 v[120:123], a[216:219], v[28:31], v[120:123]
    v_mfma_f32_16x16x32_bf16 v[124:127], a[220:223], v[28:31], v[124:127]
    s_waitcnt vmcnt(9)
    v_mfma_f32_16x16x32_bf16 v[112:115], a[224:227], v[32:35], v[112:115]
    v_mfma_f32_16x16x32_bf16 v[116:119], a[228:231], v[32:35], v[116:119]
    buffer_load_dwordx4 v[72:75], v1, s[4:7], s58 offen offset:1024 sc1
    v_mfma_f32_16x16x32_bf16 v[120:123], a[232:235], v[32:35], v[120:123]
    v_mfma_f32_16x16x32_bf16 v[124:127], a[236:239], v[32:35], v[124:127]
    s_waitcnt vmcnt(9)
    v_mfma_f32_16x16x32_bf16 v[112:115], a[240:243], v[36:39], v[112:115]
    v_mfma_f32_16x16x32_bf16 v[116:119], a[244:247], v[36:39], v[116:119]
    buffer_load_dwordx4 v[76:79], v1, s[4:7], s58 offen offset:2048 sc1
    v_mfma_f32_16x16x32_bf16 v[120:123], a[248:251], v[36:39], v[120:123]
    ds_write_b128 v5, v[128:131] offset:16384
    v_mfma_f32_16x16x32_bf16 v[124:127], a[252:255], v[36:39], v[124:127]
    s_waitcnt vmcnt(9)
    v_mfma_f32_16x16x32_bf16 v[112:115], v[152:155], v[40:43], v[112:115]
    v_mfma_f32_16x16x32_bf16 v[116:119], v[156:159], v[40:43], v[116:119]
    buffer_load_dwordx4 v[80:83], v1, s[4:7], s58 offen offset:3072 sc1
    v_mfma_f32_16x16x32_bf16 v[120:123], v[160:163], v[40:43], v[120:123]
    ds_write_b128 v5, v[132:135] offset:17408
    v_mfma_f32_16x16x32_bf16 v[124:127], v[164:167], v[40:43], v[124:127]
    s_waitcnt vmcnt(9)
    v_mfma_f32_16x16x32_bf16 v[112:115], v[168:171], v[44:47], v[112:115]
    v_mfma_f32_16x16x32_bf16 v[116:119], v[172:175], v[44:47], v[116:119]
    s_add_u32 s58, s58, 4096
    buffer_load_dwordx4 v[84:87], v1, s[4:7], s58 offen offset:0 sc1
    v_mfma_f32_16x16x32_bf16 v[120:123], v[176:179], v[44:47], v[120:123]
    ds_write_b128 v5, v[136:139] offset:18432
    v_mfma_f32_16x16x32_bf16 v[124:127], v[180:183], v[44:47], v[124:127]
    s_waitcnt vmcnt(9)
    v_mfma_f32_16x16x32_bf16 v[112:115], v[184:187], v[48:51], v[112:115]
    v_mfma_f32_16x16x32_bf16 v[116:119], v[188:191], v[48:51], v[116:119]
    buffer_load_dwordx4 v[88:91], v1, s[4:7], s58 offen offset:1024 sc1
    v_mfma_f32_16x16x32_bf16 v[120:123], v[192:195], v[48:51], v[120:123]
    ds_write_b128 v5, v[140:143] offset:19456
    v_mfma_f32_16x16x32_bf16 v[124:127], v[196:199], v[48:51], v[124:127]
    s_waitcnt vmcnt(9)
    v_mfma_f32_16x16x32_bf16 v[112:115], v[200:203], v[52:55], v[112:115]
    v_mfma_f32_16x16x32_bf16 v[116:119], v[204:207], v[52:55], v[116:119]
    buffer_load_dwordx4 v[92:95], v1, s[4:7], s58 offen offset:2048 sc1
    v_mfma_f32_16x16x32_bf16 v[120:123], v[208:211], v[52:55], v[120:123]
    v_mfma_f32_16x16x32_bf16 v[124:127], v[212:215], v[52:55], v[124:127]
    s_waitcnt vmcnt(9)
    v_mfma_f32_16x16x32_bf16 v[112:115], v[216:219], v[56:59], v[112:115]
    v_mfma_f32_16x16x32_bf16 v[116:119], v[220:223], v[56:59], v[116:119]
    buffer_load_dwordx4 v[96:99], v1, s[4:7], s58 offen offset:3072 sc1
    v_mfma_f32_16x16x32_bf16 v[120:123], v[224:227], v[56:59], v[120:123]
    v_mfma_f32_16x16x32_bf16 v[124:127], v[228:231], v[56:59], v[124:127]
    s_waitcnt vmcnt(9)
    v_mfma_f32_16x16x32_bf16 v[112:115], v[232:235], v[60:63], v[112:115]
    v_mfma_f32_16x16x32_bf16 v[116:119], v[236:239], v[60:63], v[116:119]
    s_add_u32 s58, s58, 4096
    buffer_load_dwordx4 v[100:103], v1, s[4:7], s58 offen offset:0 sc1
    v_mfma_f32_16x16x32_bf16 v[120:123], v[240:243], v[60:63], v[120:123]
    v_mfma_f32_16x16x32_bf16 v[124:127], v[244:247], v[60:63], v[124:127]
    s_waitcnt vmcnt(9)
    v_mfma_f32_16x16x32_bf16 v[112:115], v[248:251], v[64:67], v[112:115]
    v_mfma_f32_16x16x32_bf16 v[116:119], v[252:255], v[64:67], v[116:119]
    buffer_load_dwordx4 v[104:107], v1, s[4:7], s58 offen offset:1024 sc1
    v_mfma_f32_16x16x32_bf16 v[120:123], v[144:147], v[64:67], v[120:123]
    v_mfma_f32_16x16x32_bf16 v[124:127], v[148:151], v[64:67], v[124:127]
    s_waitcnt vmcnt(9)
    v_mfma_f32_16x16x32_bf16 v[128:131], a[192:195], v[68:71], 0
    v_mfma_f32_16x16x32_bf16 v[132:135], a[196:199], v[68:71], 0
    buffer_load_dwordx4 v[108:111], v1, s[4:7], s58 offen offset:2048 sc1
    s_add_u32 s58, s58, 36864
    v_mfma_f32_16x16x32_bf16 v[136:139], a[200:203], v[68:71], 0
    v_mfma_f32_16x16x32_bf16 v[140:143], a[204:207], v[68:71], 0
    s_waitcnt vmcnt(9)
    v_mfma_f32_16x16x32_bf16 v[128:131], a[208:211], v[72:75], v[128:131]
    v_mfma_f32_16x16x32_bf16 v[132:135], a[212:215], v[72:75], v[132:135]
    v_mfma_f32_16x16x32_bf16 v[136:139], a[216:219], v[72:75], v[136:139]
    v_mfma_f32_16x16x32_bf16 v[140:143], a[220:223], v[72:75], v[140:143]
    s_waitcnt vmcnt(8)
    v_mfma_f32_16x16x32_bf16 v[128:131], a[224:227], v[76:79], v[128:131]
    v_mfma_f32_16x16x32_bf16 v[132:135], a[228:231], v[76:79], v[132:135]
    v_mfma_f32_16x16x32_bf16 v[136:139], a[232:235], v[76:79], v[136:139]
    v_mfma_f32_16x16x32_bf16 v[140:143], a[236:239], v[76:79], v[140:143]
    s_waitcnt vmcnt(7)
    v_mfma_f32_16x16x32_bf16 v[128:131], a[240:243], v[80:83], v[128:131]
    v_mfma_f32_16x16x32_bf16 v[132:135], a[244:247], v[80:83], v[132:135]
    v_mfma_f32_16x16x32_bf16 v[136:139], a[248:251], v[80:83], v[136:139]
    ds_write_b128 v5, v[112:115] offset:32768
    v_mfma_f32_16x16x32_bf16 v[140:143], a[252:255], v[80:83], v[140:143]
    s_waitcnt vmcnt(6)
    v_mfma_f32_16x16x32_bf16 v[128:131], v[152:155], v[84:87], v[128:131]
    v_mfma_f32_16x16x32_bf16 v[132:135], v[156:159], v[84:87], v[132:135]
    v_mfma_f32_16x16x32_bf16 v[136:139], v[160:163], v[84:87], v[136:139]
    ds_write_b128 v5, v[116:119] offset:33792
    v_mfma_f32_16x16x32_bf16 v[140:143], v[164:167], v[84:87], v[140:143]
    s_waitcnt vmcnt(5)
    v_mfma_f32_16x16x32_bf16 v[128:131], v[168:171], v[88:91], v[128:131]
    v_mfma_f32_16x16x32_bf16 v[132:135], v[172:175], v[88:91], v[132:135]
    v_mfma_f32_16x16x32_bf16 v[136:139], v[176:179], v[88:91], v[136:139]
    ds_write_b128 v5, v[120:123] offset:34816
    v_mfma_f32_16x16x32_bf16 v[140:143], v[180:183], v[88:91], v[140:143]
    s_waitcnt vmcnt(4)
    v_mfma_f32_16x16x32_bf16 v[128:131], v[184:187], v[92:95], v[128:131]
    v_mfma_f32_16x16x32_bf16 v[132:135], v[188:191], v[92:95], v[132:135]
    v_mfma_f32_16x16x32_bf16 v[136:139], v[192:195], v[92:95], v[136:139]
    ds_write_b128 v5, v[124:127] offset:35840
    v_mfma_f32_16x16x32_bf16 v[140:143], v[196:199], v[92:95], v[140:143]
    s_waitcnt vmcnt(3)
    v_mfma_f32_16x16x32_bf16 v[128:131], v[200:203], v[96:99], v[128:131]
    v_mfma_f32_16x16x32_bf16 v[132:135], v[204:207], v[96:99], v[132:135]
    v_mfma_f32_16x16x32_bf16 v[136:139], v[208:211], v[96:99], v[136:139]
    v_mfma_f32_16x16x32_bf16 v[140:143], v[212:215], v[96:99], v[140:143]
    s_waitcnt vmcnt(2)
    v_mfma_f32_16x16x32_bf16 v[128:131], v[216:219], v[100:103], v[128:131]
    v_mfma_f32_16x16x32_bf16 v[132:135], v[220:223], v[100:103], v[132:135]
    v_mfma_f32_16x16x32_bf16 v[136:139], v[224:227], v[100:103], v[136:139]
    v_mfma_f32_16x16x32_bf16 v[140:143], v[228:231], v[100:103], v[140:143]
    s_waitcnt vmcnt(1)
    v_mfma_f32_16x16x32_bf16 v[128:131], v[232:235], v[104:107], v[128:131]
    v_mfma_f32_16x16x32_bf16 v[132:135], v[236:239], v[104:107], v[132:135]
    v_mfma_f32_16x16x32_bf16 v[136:139], v[240:243], v[104:107], v[136:139]
    v_mfma_f32_16x16x32_bf16 v[140:143], v[244:247], v[104:107], v[140:143]
    s_waitcnt vmcnt(0)
    v_mfma_f32_16x16x32_bf16 v[128:131], v[248:251], v[108:111], v[128:131]
    v_mfma_f32_16x16x32_bf16 v[132:135], v[252:255], v[108:111], v[132:135]
    v_mfma_f32_16x16x32_bf16 v[136:139], v[144:147], v[108:111], v[136:139]
    v_mfma_f32_16x16x32_bf16 v[140:143], v[148:151], v[108:111], v[140:143]
    s_lshl_b32 s24, s14, 14
    v_add_u32 v4, s24, v1
    s_mov_b32 s24, 0x3f317218
    s_mov_b32 s25, 0x3f317218
    s_nop 0
    ds_write_b128 v5, v[128:131] offset:49152
    ds_write_b128 v5, v[132:135] offset:50176
    ds_write_b128 v5, v[136:139] offset:51200
    ds_write_b128 v5, v[140:143] offset:52224
    s_waitcnt lgkmcnt(0)
    s_barrier
    buffer_load_dwordx4 v[124:127], v1, s[4:7], s96 offen offset:0 sc1
    buffer_load_dwordx4 v[128:131], v1, s[4:7], s96 offen offset:1024 sc1
    buffer_load_dwordx4 v[132:135], v1, s[4:7], s96 offen offset:2048 sc1
    buffer_load_dwordx4 v[144:147], v1, s[4:7], s96 offen offset:3072 sc1
    buffer_load_dwordx4 v[148:151], v1, s[4:7], s97 offen offset:0 sc1
    ds_read_b128 v[24:27], v4 offset:0
    ds_read_b128 v[40:43], v4 offset:4096
    ds_read_b128 v[56:59], v4 offset:8192
    ds_read_b128 v[72:75], v4 offset:12288
    ds_read_b128 v[28:31], v4 offset:1024
    ds_read_b128 v[44:47], v4 offset:5120
    ds_read_b128 v[60:63], v4 offset:9216
    ds_read_b128 v[76:79], v4 offset:13312
    ds_read_b128 v[32:35], v4 offset:2048
    ds_read_b128 v[48:51], v4 offset:6144
    ds_read_b128 v[64:67], v4 offset:10240
    ds_read_b128 v[80:83], v4 offset:14336
    ds_read_b128 v[36:39], v4 offset:3072
    ds_read_b128 v[52:55], v4 offset:7168
    ds_read_b128 v[68:71], v4 offset:11264
    ds_read_b128 v[84:87], v4 offset:15360
    s_waitcnt lgkmcnt(12)
    v_pk_add_f32 v[24:25], v[24:25], v[40:41]
    v_pk_add_f32 v[56:57], v[56:57], v[72:73]
    v_pk_add_f32 v[26:27], v[26:27], v[42:43]
    v_pk_add_f32 v[58:59], v[58:59], v[74:75]
    v_pk_add_f32 v[24:25], v[24:25], v[56:57]
    v_pk_add_f32 v[26:27], v[26:27], v[58:59]
    v_pk_fma_f32 v[8:9], v[24:25], s[24:25], v[8:9]
    v_pk_fma_f32 v[10:11], v[26:27], s[24:25], v[10:11]
    s_waitcnt lgkmcnt(8)
    v_pk_add_f32 v[28:29], v[28:29], v[44:45]
    v_pk_add_f32 v[60:61], v[60:61], v[76:77]
    v_pk_add_f32 v[30:31], v[30:31], v[46:47]
    v_pk_add_f32 v[62:63], v[62:63], v[78:79]
    v_pk_add_f32 v[28:29], v[28:29], v[60:61]
    v_pk_add_f32 v[30:31], v[30:31], v[62:63]
    v_pk_fma_f32 v[12:13], v[28:29], s[24:25], v[12:13]
    v_pk_fma_f32 v[14:15], v[30:31], s[24:25], v[14:15]
    s_waitcnt lgkmcnt(4)
    v_pk_add_f32 v[32:33], v[32:33], v[48:49]
    v_pk_add_f32 v[64:65], v[64:65], v[80:81]
    v_pk_add_f32 v[34:35], v[34:35], v[50:51]
    v_pk_add_f32 v[66:67], v[66:67], v[82:83]
    v_pk_add_f32 v[32:33], v[32:33], v[64:65]
    v_pk_add_f32 v[34:35], v[34:35], v[66:67]
    v_pk_fma_f32 v[16:17], v[32:33], s[24:25], v[16:17]
    v_pk_fma_f32 v[18:19], v[34:35], s[24:25], v[18:19]
    s_waitcnt lgkmcnt(0)
    v_pk_add_f32 v[36:37], v[36:37], v[52:53]
    v_pk_add_f32 v[68:69], v[68:69], v[84:85]
    v_pk_add_f32 v[38:39], v[38:39], v[54:55]
    v_pk_add_f32 v[70:71], v[70:71], v[86:87]
    v_pk_add_f32 v[36:37], v[36:37], v[68:69]
    v_pk_add_f32 v[38:39], v[38:39], v[70:71]
    v_pk_fma_f32 v[20:21], v[36:37], s[24:25], v[20:21]
    v_pk_fma_f32 v[22:23], v[38:39], s[24:25], v[22:23]
    s_cmp_eq_u32 s3, 0
    s_cbranch_scc1 NEXT_LAYER
    s_lshl_b32 s24, s12, 16
    s_lshl_b32 s25, s14, 14
    s_add_u32 s24, s24, s25
    s_lshl_b32 s25, s13, 7
    s_add_u32 s24, s24, s25
    v_lshlrev_b32 v4, 10, v2
    v_lshrrev_b32 v5, 1, v3
    v_lshl_add_u32 v4, v5, 4, v4
    v_and_b32 v5, 1, v3
    v_lshl_add_u32 v4, v5, 5, v4
    v_cvt_pk_bf16_f32 v24, v8, v9
    v_cvt_pk_bf16_f32 v25, v10, v11
    v_cvt_pk_bf16_f32 v26, v12, v13
    v_cvt_pk_bf16_f32 v27, v14, v15
    s_nop 0
    v_permlane16_swap_b32 v24, v26
    v_permlane16_swap_b32 v25, v27
    buffer_store_dwordx4 v[24:27], v4, s[8:11], s24 offen offset:0
    v_cvt_pk_bf16_f32 v28, v16, v17
    v_cvt_pk_bf16_f32 v29, v18, v19
    v_cvt_pk_bf16_f32 v30, v20, v21
    v_cvt_pk_bf16_f32 v31, v22, v23
    s_nop 0
    v_permlane16_swap_b32 v28, v30
    v_permlane16_swap_b32 v29, v31
    buffer_store_dwordx4 v[28:31], v4, s[8:11], s24 offen offset:64
MAIN_END:
    s_endpgm
NEXT_LAYER:
    v_lshrrev_b32 v137, 1, v3
    v_lshlrev_b32 v137, 2, v137
    v_lshl_add_u32 v137, v2, 3, v137
    v_cvt_pk_bf16_f32 v24, v8, v9
    v_cvt_pk_bf16_f32 v25, v10, v11
    v_cvt_pk_bf16_f32 v26, v12, v13
    v_cvt_pk_bf16_f32 v27, v14, v15
    buffer_store_dwordx4 v[24:27], v1, s[4:7], s52 offen offset:0
    v_cvt_pk_bf16_f32 v28, v16, v17
    v_cvt_pk_bf16_f32 v29, v18, v19
    v_cvt_pk_bf16_f32 v30, v20, v21
    v_cvt_pk_bf16_f32 v31, v22, v23
    buffer_store_dwordx4 v[28:31], v1, s[4:7], s52 offen offset:1024
    v_pk_add_f32 v[120:121], v[8:9], v[10:11]
    v_pk_mul_f32 v[122:123], v[8:9], v[8:9]
    v_pk_fma_f32 v[122:123], v[10:11], v[10:11], v[122:123]
    v_pk_add_f32 v[120:121], v[120:121], v[12:13]
    v_pk_fma_f32 v[122:123], v[12:13], v[12:13], v[122:123]
    v_pk_add_f32 v[120:121], v[120:121], v[14:15]
    v_pk_fma_f32 v[122:123], v[14:15], v[14:15], v[122:123]
    v_pk_add_f32 v[120:121], v[120:121], v[16:17]
    v_pk_fma_f32 v[122:123], v[16:17], v[16:17], v[122:123]
    v_pk_add_f32 v[120:121], v[120:121], v[18:19]
    v_pk_fma_f32 v[122:123], v[18:19], v[18:19], v[122:123]
    v_pk_add_f32 v[120:121], v[120:121], v[20:21]
    v_pk_fma_f32 v[122:123], v[20:21], v[20:21], v[122:123]
    v_pk_add_f32 v[120:121], v[120:121], v[22:23]
    v_pk_fma_f32 v[122:123], v[22:23], v[22:23], v[122:123]
    v_add_f32 v120, v120, v121
    v_add_f32 v122, v122, v123
    s_nop 1
    v_permlane32_swap_b32 v120, v122
    v_add_f32 v120, v120, v122
    v_mov_b32 v122, v120
    s_nop 1
    v_permlane16_swap_b32 v120, v122
    v_add_f32 v120, v120, v122
    buffer_store_dword v120, v137, s[4:7], s53 offen
    s_cmp_lg_u32 s23, 0
    s_cbranch_scc1 DS_41
DB_42:
    v_add_u32 v140, 65536, v1
    v_add_u32 v141, 106496, v1
    v_lshlrev_b32 v142, 3, v2
    v_lshl_add_u32 v142, v3, 10, v142
    v_add_u32 v143, s16, v1
    ds_read_b128 v[64:67], v140 offset:0
    ds_read_b128 v[68:71], v140 offset:1024
    ds_read_b128 v[72:75], v140 offset:2048
    ds_read_b128 v[76:79], v140 offset:3072
    ds_read_b128 v[80:83], v140 offset:4096
    ds_read_b128 v[84:87], v140 offset:5120
    ds_read_b128 v[88:91], v140 offset:6144
    ds_read_b128 v[92:95], v140 offset:7168
    ds_read_b128 v[96:99], v140 offset:8192
    ds_read_b128 v[100:103], v140 offset:9216
    ds_read_b128 v[104:107], v140 offset:10240
    ds_read_b128 v[108:111], v140 offset:11264
    ds_read_b128 v[112:115], v140 offset:12288
    ds_read_b128 v[116:119], v140 offset:13312
    s_waitcnt vmcnt(0)
    s_barrier
    s_cmp_lg_u32 s14, 0
    s_cbranch_scc1 FS_46
    s_cmp_lg_u32 s23, 0
    s_cbranch_scc1 FSS_47
    s_mov_b64 exec, 1
    buffer_store_dword v7, off, s[4:7], s19 offset:768
    s_mov_b64 exec, -1
FS_46:
    s_cmp_lg_u32 s14, 1
    s_cbranch_scc1 POLLS_45
    s_mov_b32 s25, 0
POLL_43:
    buffer_load_dword v5, v6, s[4:7], s22 offen offset:768 sc1
    s_add_u32 s25, s25, 1
    s_waitcnt vmcnt(0)
    s_cmp_gt_u32 s25, 400000
    s_cbranch_scc1 POLLD_44
    v_cmp_ne_u32 vcc, s43, v5
    s_nop 1
    s_cbranch_vccnz POLL_43
POLLD_44:
POLLS_45:
    s_barrier
    buffer_load_dwordx2 v[120:121], v142, s[4:7], s67 offen offset:0 sc1
    buffer_load_dwordx2 v[122:123], v142, s[4:7], s67 offen offset:512 sc1
    s_bitcmp1_b32 s13, 0
    s_cbranch_scc1 P4_GV
    buffer_load_dwordx4 v[32:35], v143, s[4:7], s44 offen offset:0 sc1
    buffer_load_dwordx4 v[36:39], v143, s[4:7], s44 offen offset:1024 sc1
    buffer_load_dwordx4 v[40:43], v143, s[4:7], s45 offen offset:0 sc1
    buffer_load_dwordx4 v[44:47], v143, s[4:7], s45 offen offset:1024 sc1
    buffer_load_dwordx4 v[48:51], v143, s[4:7], s46 offen offset:0 sc1
    buffer_load_dwordx4 v[52:55], v143, s[4:7], s46 offen offset:1024 sc1
    buffer_load_dwordx4 v[56:59], v143, s[4:7], s47 offen offset:0 sc1
    s_waitcnt vmcnt(6) lgkmcnt(9)
    v_mfma_f32_16x16x32_bf16 v[8:11], v[64:67], v[32:35], 0
    ds_read_b128 v[64:67], v140 offset:14336
    v_mfma_f32_16x16x32_bf16 v[12:15], v[68:71], v[32:35], 0
    buffer_load_dwordx4 v[60:63], v143, s[4:7], s47 offen offset:1024 sc1
    ds_read_b128 v[68:71], v140 offset:15360
    v_mfma_f32_16x16x32_bf16 v[16:19], v[72:75], v[32:35], 0
    ds_read_b128 v[72:75], v140 offset:16384
    v_mfma_f32_16x16x32_bf16 v[20:23], v[76:79], v[32:35], 0
    ds_read_b128 v[76:79], v140 offset:17408
    v_mfma_f32_16x16x32_bf16 v[24:27], v[80:83], v[32:35], 0
    s_waitcnt vmcnt(6) lgkmcnt(8)
    ds_read_b128 v[80:83], v140 offset:18432
    v_mfma_f32_16x16x32_bf16 v[8:11], v[84:87], v[36:39], v[8:11]
    ds_read_b128 v[84:87], v140 offset:19456
    v_mfma_f32_16x16x32_bf16 v[12:15], v[88:91], v[36:39], v[12:15]
    buffer_load_dwordx4 v[32:35], v143, s[4:7], s48 offen offset:0 sc1
    ds_read_b128 v[88:91], v140 offset:20480
    v_mfma_f32_16x16x32_bf16 v[16:19], v[92:95], v[36:39], v[16:19]
    ds_read_b128 v[92:95], v140 offset:21504
    v_mfma_f32_16x16x32_bf16 v[20:23], v[96:99], v[36:39], v[20:23]
    ds_read_b128 v[96:99], v140 offset:22528
    v_mfma_f32_16x16x32_bf16 v[24:27], v[100:103], v[36:39], v[24:27]
    s_waitcnt vmcnt(6) lgkmcnt(8)
    ds_read_b128 v[100:103], v140 offset:23552
    v_mfma_f32_16x16x32_bf16 v[8:11], v[104:107], v[40:43], v[8:11]
    ds_read_b128 v[104:107], v140 offset:24576
    v_add_f32 v120, v120, v122
    v_mfma_f32_16x16x32_bf16 v[12:15], v[108:111], v[40:43], v[12:15]
    buffer_load_dwordx4 v[36:39], v143, s[4:7], s48 offen offset:1024 sc1
    ds_read_b128 v[108:111], v140 offset:25600
    v_mfma_f32_16x16x32_bf16 v[16:19], v[112:115], v[40:43], v[16:19]
    ds_read_b128 v[112:115], v140 offset:26624
    v_add_f32 v121, v121, v123
    v_mfma_f32_16x16x32_bf16 v[20:23], v[116:119], v[40:43], v[20:23]
    ds_read_b128 v[116:119], v140 offset:27648
    v_mov_b32 v122, v120
    v_mfma_f32_16x16x32_bf16 v[24:27], v[64:67], v[40:43], v[24:27]
    s_waitcnt vmcnt(6) lgkmcnt(8)
    ds_read_b128 v[64:67], v140 offset:28672
    v_mov_b32 v123, v121
    v_mfma_f32_16x16x32_bf16 v[8:11], v[68:71], v[44:47], v[8:11]
    ds_read_b128 v[68:71], v140 offset:29696
    v_permlane32_swap_b32 v120, v122
    v_mfma_f32_16x16x32_bf16 v[12:15], v[72:75], v[44:47], v[12:15]
    buffer_load_dwordx4 v[40:43], v143, s[4:7], s49 offen offset:0 sc1
    ds_read_b128 v[72:75], v140 offset:30720
    v_mfma_f32_16x16x32_bf16 v[16:19], v[76:79], v[44:47], v[16:19]
    ds_read_b128 v[76:79], v140 offset:31744
    v_permlane32_swap_b32 v121, v123
    v_mfma_f32_16x16x32_bf16 v[20:23], v[80:83], v[44:47], v[20:23]
    ds_read_b128 v[80:83], v140 offset:32768
    v_add_f32 v120, v120, v122
    v_mfma_f32_16x16x32_bf16 v[24:27], v[84:87], v[44:47], v[24:27]
    s_waitcnt vmcnt(6) lgkmcnt(8)
    ds_read_b128 v[84:87], v140 offset:33792
    v_add_f32 v121, v121, v123
    v_mfma_f32_16x16x32_bf16 v[8:11], v[88:91], v[48:51], v[8:11]
    ds_read_b128 v[88:91], v140 offset:34816
    v_mov_b32 v122, v120
    v_mfma_f32_16x16x32_bf16 v[12:15], v[92:95], v[48:51], v[12:15]
    buffer_load_dwordx4 v[44:47], v143, s[4:7], s49 offen offset:1024 sc1
    ds_read_b128 v[92:95], v140 offset:35840
    v_mfma_f32_16x16x32_bf16 v[16:19], v[96:99], v[48:51], v[16:19]
    ds_read_b128 v[96:99], v140 offset:36864
    v_mov_b32 v123, v121
    v_mfma_f32_16x16x32_bf16 v[20:23], v[100:103], v[48:51], v[20:23]
    ds_read_b128 v[100:103], v140 offset:37888
    v_permlane16_swap_b32 v120, v122
    v_mfma_f32_16x16x32_bf16 v[24:27], v[104:107], v[48:51], v[24:27]
    s_waitcnt vmcnt(6) lgkmcnt(8)
    ds_read_b128 v[104:107], v140 offset:38912
    v_permlane16_swap_b32 v121, v123
    v_mfma_f32_16x16x32_bf16 v[8:11], v[108:111], v[52:55], v[8:11]
    ds_read_b128 v[108:111], v140 offset:39936
    v_add_f32 v120, v120, v122
    v_mfma_f32_16x16x32_bf16 v[12:15], v[112:115], v[52:55], v[12:15]
    buffer_load_dwordx4 v[48:51], v143, s[4:7], s50 offen offset:0 sc1
    ds_read_b128 v[112:115], v141 offset:0
    v_mfma_f32_16x16x32_bf16 v[16:19], v[116:119], v[52:55], v[16:19]
    ds_read_b128 v[116:119], v141 offset:1024
    v_add_f32 v121, v121, v123
    v_mfma_f32_16x16x32_bf16 v[20:23], v[64:67], v[52:55], v[20:23]
    ds_read_b128 v[64:67], v141 offset:2048
    v_mul_f32 v120, 0x3b000000, v120
    v_mfma_f32_16x16x32_bf16 v[24:27], v[68:71], v[52:55], v[24:27]
    s_waitcnt vmcnt(6) lgkmcnt(8)
    ds_read_b128 v[68:71], v141 offset:3072
    v_mul_f32 v121, 0x3b000000, v121
    v_mfma_f32_16x16x32_bf16 v[8:11], v[72:75], v[56:59], v[8:11]
    ds_read_b128 v[72:75], v141 offset:4096
    v_fma_f32 v121, -v120, v120, v121
    v_mfma_f32_16x16x32_bf16 v[12:15], v[76:79], v[56:59], v[12:15]
    buffer_load_dwordx4 v[52:55], v143, s[4:7], s50 offen offset:1024 sc1
    ds_read_b128 v[76:79], v141 offset:5120
    v_mfma_f32_16x16x32_bf16 v[16:19], v[80:83], v[56:59], v[16:19]
    ds_read_b128 v[80:83], v141 offset:6144
    v_max_f32 v121, 0, v121
    v_mfma_f32_16x16x32_bf16 v[20:23], v[84:87], v[56:59], v[20:23]
    ds_read_b128 v[84:87], v141 offset:7168
    v_add_f32 v121, 0x3727c5ac, v121
    v_mfma_f32_16x16x32_bf16 v[24:27], v[88:91], v[56:59], v[24:27]
    s_waitcnt vmcnt(6) lgkmcnt(8)
    ds_read_b128 v[88:91], v141 offset:8192
    v_rsq_f32 v136, v121
    v_mfma_f32_16x16x32_bf16 v[8:11], v[92:95], v[60:63], v[8:11]
    ds_read_b128 v[92:95], v141 offset:9216
    v_lshrrev_b32 v122, 1, v3
    v_mfma_f32_16x16x32_bf16 v[12:15], v[96:99], v[60:63], v[12:15]
    buffer_load_dwordx4 v[56:59], v143, s[4:7], s51 offen offset:0 sc1
    ds_read_b128 v[96:99], v141 offset:10240
    v_mfma_f32_16x16x32_bf16 v[16:19], v[100:103], v[60:63], v[16:19]
    ds_read_b128 v[100:103], v141 offset:11264
    v_mul_f32 v137, v120, v136
    v_mfma_f32_16x16x32_bf16 v[20:23], v[104:107], v[60:63], v[20:23]
    ds_read_b128 v[104:107], v141 offset:12288
    v_and_b32 v123, 1, v3
    v_mfma_f32_16x16x32_bf16 v[24:27], v[108:111], v[60:63], v[24:27]
    s_waitcnt vmcnt(6) lgkmcnt(8)
    ds_read_b128 v[108:111], v141 offset:13312
    v_mul_f32 v138, 0x3eb8aa3b, v136
    v_mfma_f32_16x16x32_bf16 v[8:11], v[112:115], v[32:35], v[8:11]
    ds_read_b128 v[112:115], v141 offset:14336
    v_mul_f32 v139, 0x3eb8aa3b, v137
    v_mfma_f32_16x16x32_bf16 v[12:15], v[116:119], v[32:35], v[12:15]
    buffer_load_dwordx4 v[60:63], v143, s[4:7], s51 offen offset:1024 sc1
    ds_read_b128 v[116:119], v141 offset:15360
    v_mfma_f32_16x16x32_bf16 v[16:19], v[64:67], v[32:35], v[16:19]
    ds_read_b128 v[64:67], v141 offset:16384
    v_lshlrev_b32 v5, 9, v122
    v_mfma_f32_16x16x32_bf16 v[20:23], v[68:71], v[32:35], v[20:23]
    ds_read_b128 v[68:71], v141 offset:17408
    v_lshl_add_u32 v5, v2, 4, v5
    v_mfma_f32_16x16x32_bf16 v[24:27], v[72:75], v[32:35], v[24:27]
    s_waitcnt vmcnt(6) lgkmcnt(8)
    ds_read_b128 v[72:75], v141 offset:18432
    v_lshl_add_u32 v5, v123, 3, v5
    v_mfma_f32_16x16x32_bf16 v[8:11], v[76:79], v[36:39], v[8:11]
    ds_read_b128 v[76:79], v141 offset:19456
    v_lshlrev_b32 v142, 8, v123
    v_mfma_f32_16x16x32_bf16 v[12:15], v[80:83], v[36:39], v[12:15]
    ds_read_b128 v[80:83], v141 offset:20480
    v_mfma_f32_16x16x32_bf16 v[16:19], v[84:87], v[36:39], v[16:19]
    ds_read_b128 v[84:87], v141 offset:21504
    v_lshl_add_u32 v142, v2, 4, v142
    v_mfma_f32_16x16x32_bf16 v[20:23], v[88:91], v[36:39], v[20:23]
    ds_read_b128 v[88:91], v141 offset:22528
    v_lshl_add_u32 v142, v122, 3, v142
    v_mfma_f32_16x16x32_bf16 v[24:27], v[92:95], v[36:39], v[24:27]
    s_waitcnt vmcnt(5) lgkmcnt(8)
    ds_read_b128 v[92:95], v141 offset:23552
    v_lshlrev_b32 v4, 4, v3
    v_mfma_f32_16x16x32_bf16 v[8:11], v[96:99], v[40:43], v[8:11]
    ds_read_b128 v[96:99], v141 offset:24576
    v_mfma_f32_16x16x32_bf16 v[12:15], v[100:103], v[40:43], v[12:15]
    ds_read_b128 v[100:103], v141 offset:25600
    v_mfma_f32_16x16x32_bf16 v[16:19], v[104:107], v[40:43], v[16:19]
    ds_read_b128 v[104:107], v141 offset:26624
    v_mfma_f32_16x16x32_bf16 v[20:23], v[108:111], v[40:43], v[20:23]
    ds_read_b128 v[108:111], v141 offset:27648
    v_mfma_f32_16x16x32_bf16 v[24:27], v[112:115], v[40:43], v[24:27]
    s_waitcnt vmcnt(4) lgkmcnt(8)
    ds_read_b128 v[112:115], v141 offset:28672
    v_mfma_f32_16x16x32_bf16 v[8:11], v[116:119], v[44:47], v[8:11]
    ds_read_b128 v[116:119], v141 offset:29696
    v_mfma_f32_16x16x32_bf16 v[12:15], v[64:67], v[44:47], v[12:15]
    ds_read_b128 v[64:67], v141 offset:30720
    v_mfma_f32_16x16x32_bf16 v[16:19], v[68:71], v[44:47], v[16:19]
    ds_read_b128 v[68:71], v141 offset:31744
    v_mfma_f32_16x16x32_bf16 v[20:23], v[72:75], v[44:47], v[20:23]
    ds_read_b128 v[72:75], v141 offset:32768
    v_mfma_f32_16x16x32_bf16 v[24:27], v[76:79], v[44:47], v[24:27]
    s_waitcnt vmcnt(3) lgkmcnt(8)
    ds_read_b128 v[76:79], v141 offset:33792
    v_mfma_f32_16x16x32_bf16 v[8:11], v[80:83], v[48:51], v[8:11]
    ds_read_b128 v[80:83], v141 offset:34816
    v_mfma_f32_16x16x32_bf16 v[12:15], v[84:87], v[48:51], v[12:15]
    ds_read_b128 v[84:87], v141 offset:35840
    v_mfma_f32_16x16x32_bf16 v[16:19], v[88:91], v[48:51], v[16:19]
    ds_read_b128 v[88:91], v141 offset:36864
    v_mfma_f32_16x16x32_bf16 v[20:23], v[92:95], v[48:51], v[20:23]
    ds_read_b128 v[92:95], v141 offset:37888
    v_mfma_f32_16x16x32_bf16 v[24:27], v[96:99], v[48:51], v[24:27]
    s_waitcnt vmcnt(2) lgkmcnt(8)
    ds_read_b128 v[96:99], v141 offset:38912
    v_mfma_f32_16x16x32_bf16 v[8:11], v[100:103], v[52:55], v[8:11]
    ds_read_b128 v[100:103], v141 offset:39936
    v_mfma_f32_16x16x32_bf16 v[12:15], v[104:107], v[52:55], v[12:15]
    v_mfma_f32_16x16x32_bf16 v[16:19], v[108:111], v[52:55], v[16:19]
    v_mfma_f32_16x16x32_bf16 v[20:23], v[112:115], v[52:55], v[20:23]
    v_mfma_f32_16x16x32_bf16 v[24:27], v[116:119], v[52:55], v[24:27]
    s_waitcnt vmcnt(1) lgkmcnt(5)
    v_mfma_f32_16x16x32_bf16 v[8:11], v[64:67], v[56:59], v[8:11]
    v_mfma_f32_16x16x32_bf16 v[12:15], v[68:71], v[56:59], v[12:15]
    v_mfma_f32_16x16x32_bf16 v[16:19], v[72:75], v[56:59], v[16:19]
    v_mfma_f32_16x16x32_bf16 v[20:23], v[76:79], v[56:59], v[20:23]
    v_mfma_f32_16x16x32_bf16 v[24:27], v[80:83], v[56:59], v[24:27]
    s_waitcnt vmcnt(0) lgkmcnt(0)
    v_mfma_f32_16x16x32_bf16 v[8:11], v[84:87], v[60:63], v[8:11]
    v_mfma_f32_16x16x32_bf16 v[12:15], v[88:91], v[60:63], v[12:15]
    v_mfma_f32_16x16x32_bf16 v[16:19], v[92:95], v[60:63], v[16:19]
    v_mfma_f32_16x16x32_bf16 v[20:23], v[96:99], v[60:63], v[20:23]
    v_mfma_f32_16x16x32_bf16 v[24:27], v[100:103], v[60:63], v[24:27]
    s_branch P4_GJ
P4_GV:
    buffer_load_dwordx4 v[32:35], v143, s[4:7], s44 offen offset:0 sc1
    buffer_load_dwordx4 v[36:39], v143, s[4:7], s44 offen offset:1024 sc1
    buffer_load_dwordx4 v[40:43], v143, s[4:7], s45 offen offset:0 sc1
    buffer_load_dwordx4 v[44:47], v143, s[4:7], s45 offen offset:1024 sc1
    buffer_load_dwordx4 v[48:51], v143, s[4:7], s46 offen offset:0 sc1
    buffer_load_dwordx4 v[52:55], v143, s[4:7], s46 offen offset:1024 sc1
    buffer_load_dwordx4 v[56:59], v143, s[4:7], s47 offen offset:0 sc1
    s_waitcnt vmcnt(6) lgkmcnt(9)
    v_mfma_f32_16x16x32_bf16 v[8:11], v[64:67], v[32:35], 0
    ds_read_b128 v[64:67], v140 offset:14336
    v_mfma_f32_16x16x32_bf16 v[12:15], v[68:71], v[32:35], 0
    buffer_load_dwordx4 v[60:63], v143, s[4:7], s47 offen offset:1024 sc1
    ds_read_b128 v[68:71], v140 offset:15360
    v_mfma_f32_16x16x32_bf16 v[16:19], v[72:75], v[32:35], 0
    ds_read_b128 v[72:75], v140 offset:16384
    v_mfma_f32_16x16x32_bf16 v[20:23], v[76:79], v[32:35], 0
    ds_read_b128 v[76:79], v140 offset:17408
    v_mfma_f32_16x16x32_bf16 v[24:27], v[32:35], v[80:83], 0
    s_waitcnt vmcnt(6) lgkmcnt(8)
    ds_read_b128 v[80:83], v140 offset:18432
    v_mfma_f32_16x16x32_bf16 v[8:11], v[84:87], v[36:39], v[8:11]
    ds_read_b128 v[84:87], v140 offset:19456
    v_mfma_f32_16x16x32_bf16 v[12:15], v[88:91], v[36:39], v[12:15]
    buffer_load_dwordx4 v[32:35], v143, s[4:7], s48 offen offset:0 sc1
    ds_read_b128 v[88:91], v140 offset:20480
    v_mfma_f32_16x16x32_bf16 v[16:19], v[92:95], v[36:39], v[16:19]
    ds_read_b128 v[92:95], v140 offset:21504
    v_mfma_f32_16x16x32_bf16 v[20:23], v[96:99], v[36:39], v[20:23]
    ds_read_b128 v[96:99], v140 offset:22528
    v_mfma_f32_16x16x32_bf16 v[24:27], v[36:39], v[100:103], v[24:27]
    s_waitcnt vmcnt(6) lgkmcnt(8)
    ds_read_b128 v[100:103], v140 offset:23552
    v_mfma_f32_16x16x32_bf16 v[8:11], v[104:107], v[40:43], v[8:11]
    ds_read_b128 v[104:107], v140 offset:24576
    v_add_f32 v120, v120, v122
    v_mfma_f32_16x16x32_bf16 v[12:15], v[108:111], v[40:43], v[12:15]
    buffer_load_dwordx4 v[36:39], v143, s[4:7], s48 offen offset:1024 sc1
    ds_read_b128 v[108:111], v140 offset:25600
    v_mfma_f32_16x16x32_bf16 v[16:19], v[112:115], v[40:43], v[16:19]
    ds_read_b128 v[112:115], v140 offset:26624
    v_add_f32 v121, v121, v123
    v_mfma_f32_16x16x32_bf16 v[20:23], v[116:119], v[40:43], v[20:23]
    ds_read_b128 v[116:119], v140 offset:27648
    v_mov_b32 v122, v120
    v_mfma_f32_16x16x32_bf16 v[24:27], v[40:43], v[64:67], v[24:27]
    s_waitcnt vmcnt(6) lgkmcnt(8)
    ds_read_b128 v[64:67], v140 offset:28672
    v_mov_b32 v123, v121
    v_mfma_f32_16x16x32_bf16 v[8:11], v[68:71], v[44:47], v[8:11]
    ds_read_b128 v[68:71], v140 offset:29696
    v_permlane32_swap_b32 v120, v122
    v_mfma_f32_16x16x32_bf16 v[12:15], v[72:75], v[44:47], v[12:15]
    buffer_load_dwordx4 v[40:43], v143, s[4:7], s49 offen offset:0 sc1
    ds_read_b128 v[72:75], v140 offset:30720
    v_mfma_f32_16x16x32_bf16 v[16:19], v[76:79], v[44:47], v[16:19]
    ds_read_b128 v[76:79], v140 offset:31744
    v_permlane32_swap_b32 v121, v123
    v_mfma_f32_16x16x32_bf16 v[20:23], v[80:83], v[44:47], v[20:23]
    ds_read_b128 v[80:83], v140 offset:32768
    v_add_f32 v120, v120, v122
    v_mfma_f32_16x16x32_bf16 v[24:27], v[44:47], v[84:87], v[24:27]
    s_waitcnt vmcnt(6) lgkmcnt(8)
    ds_read_b128 v[84:87], v140 offset:33792
    v_add_f32 v121, v121, v123
    v_mfma_f32_16x16x32_bf16 v[8:11], v[88:91], v[48:51], v[8:11]
    ds_read_b128 v[88:91], v140 offset:34816
    v_mov_b32 v122, v120
    v_mfma_f32_16x16x32_bf16 v[12:15], v[92:95], v[48:51], v[12:15]
    buffer_load_dwordx4 v[44:47], v143, s[4:7], s49 offen offset:1024 sc1
    ds_read_b128 v[92:95], v140 offset:35840
    v_mfma_f32_16x16x32_bf16 v[16:19], v[96:99], v[48:51], v[16:19]
    ds_read_b128 v[96:99], v140 offset:36864
    v_mov_b32 v123, v121
    v_mfma_f32_16x16x32_bf16 v[20:23], v[100:103], v[48:51], v[20:23]
    ds_read_b128 v[100:103], v140 offset:37888
    v_permlane16_swap_b32 v120, v122
    v_mfma_f32_16x16x32_bf16 v[24:27], v[48:51], v[104:107], v[24:27]
    s_waitcnt vmcnt(6) lgkmcnt(8)
    ds_read_b128 v[104:107], v140 offset:38912
    v_permlane16_swap_b32 v121, v123
    v_mfma_f32_16x16x32_bf16 v[8:11], v[108:111], v[52:55], v[8:11]
    ds_read_b128 v[108:111], v140 offset:39936
    v_add_f32 v120, v120, v122
    v_mfma_f32_16x16x32_bf16 v[12:15], v[112:115], v[52:55], v[12:15]
    buffer_load_dwordx4 v[48:51], v143, s[4:7], s50 offen offset:0 sc1
    ds_read_b128 v[112:115], v141 offset:0
    v_mfma_f32_16x16x32_bf16 v[16:19], v[116:119], v[52:55], v[16:19]
    ds_read_b128 v[116:119], v141 offset:1024
    v_add_f32 v121, v121, v123
    v_mfma_f32_16x16x32_bf16 v[20:23], v[64:67], v[52:55], v[20:23]
    ds_read_b128 v[64:67], v141 offset:2048
    v_mul_f32 v120, 0x3b000000, v120
    v_mfma_f32_16x16x32_bf16 v[24:27], v[52:55], v[68:71], v[24:27]
    s_waitcnt vmcnt(6) lgkmcnt(8)
    ds_read_b128 v[68:71], v141 offset:3072
    v_mul_f32 v121, 0x3b000000, v121
    v_mfma_f32_16x16x32_bf16 v[8:11], v[72:75], v[56:59], v[8:11]
    ds_read_b128 v[72:75], v141 offset:4096
    v_fma_f32 v121, -v120, v120, v121
    v_mfma_f32_16x16x32_bf16 v[12:15], v[76:79], v[56:59], v[12:15]
    buffer_load_dwordx4 v[52:55], v143, s[4:7], s50 offen offset:1024 sc1
    ds_read_b128 v[76:79], v141 offset:5120
    v_mfma_f32_16x16x32_bf16 v[16:19], v[80:83], v[56:59], v[16:19]
    ds_read_b128 v[80:83], v141 offset:6144
    v_max_f32 v121, 0, v121
    v_mfma_f32_16x16x32_bf16 v[20:23], v[84:87], v[56:59], v[20:23]
    ds_read_b128 v[84:87], v141 offset:7168
    v_add_f32 v121, 0x3727c5ac, v121
    v_mfma_f32_16x16x32_bf16 v[24:27], v[56:59], v[88:91], v[24:27]
    s_waitcnt vmcnt(6) lgkmcnt(8)
    ds_read_b128 v[88:91], v141 offset:8192
    v_rsq_f32 v136, v121
    v_mfma_f32_16x16x32_bf16 v[8:11], v[92:95], v[60:63], v[8:11]
    ds_read_b128 v[92:95], v141 offset:9216
    v_lshrrev_b32 v122, 1, v3
    v_mfma_f32_16x16x32_bf16 v[12:15], v[96:99], v[60:63], v[12:15]
    buffer_load_dwordx4 v[56:59], v143, s[4:7], s51 offen offset:0 sc1
    ds_read_b128 v[96:99], v141 offset:10240
    v_mfma_f32_16x16x32_bf16 v[16:19], v[100:103], v[60:63], v[16:19]
    ds_read_b128 v[100:103], v141 offset:11264
    v_mul_f32 v137, v120, v136
    v_mfma_f32_16x16x32_bf16 v[20:23], v[104:107], v[60:63], v[20:23]
    ds_read_b128 v[104:107], v141 offset:12288
    v_and_b32 v123, 1, v3
    v_mfma_f32_16x16x32_bf16 v[24:27], v[60:63], v[108:111], v[24:27]
    s_waitcnt vmcnt(6) lgkmcnt(8)
    ds_read_b128 v[108:111], v141 offset:13312
    v_mul_f32 v138, 0x3eb8aa3b, v136
    v_mfma_f32_16x16x32_bf16 v[8:11], v[112:115], v[32:35], v[8:11]
    ds_read_b128 v[112:115], v141 offset:14336
    v_mul_f32 v139, 0x3eb8aa3b, v137
    v_mfma_f32_16x16x32_bf16 v[12:15], v[116:119], v[32:35], v[12:15]
    buffer_load_dwordx4 v[60:63], v143, s[4:7], s51 offen offset:1024 sc1
    ds_read_b128 v[116:119], v141 offset:15360
    v_mfma_f32_16x16x32_bf16 v[16:19], v[64:67], v[32:35], v[16:19]
    ds_read_b128 v[64:67], v141 offset:16384
    v_lshlrev_b32 v5, 9, v122
    v_mfma_f32_16x16x32_bf16 v[20:23], v[68:71], v[32:35], v[20:23]
    ds_read_b128 v[68:71], v141 offset:17408
    v_lshl_add_u32 v5, v2, 4, v5
    v_mfma_f32_16x16x32_bf16 v[24:27], v[32:35], v[72:75], v[24:27]
    s_waitcnt vmcnt(6) lgkmcnt(8)
    ds_read_b128 v[72:75], v141 offset:18432
    v_lshl_add_u32 v5, v123, 3, v5
    v_mfma_f32_16x16x32_bf16 v[8:11], v[76:79], v[36:39], v[8:11]
    ds_read_b128 v[76:79], v141 offset:19456
    v_lshlrev_b32 v142, 8, v123
    v_mfma_f32_16x16x32_bf16 v[12:15], v[80:83], v[36:39], v[12:15]
    ds_read_b128 v[80:83], v141 offset:20480
    v_mfma_f32_16x16x32_bf16 v[16:19], v[84:87], v[36:39], v[16:19]
    ds_read_b128 v[84:87], v141 offset:21504
    v_lshl_add_u32 v142, v2, 4, v142
    v_mfma_f32_16x16x32_bf16 v[20:23], v[88:91], v[36:39], v[20:23]
    ds_read_b128 v[88:91], v141 offset:22528
    v_lshl_add_u32 v142, v122, 3, v142
    v_mfma_f32_16x16x32_bf16 v[24:27], v[36:39], v[92:95], v[24:27]
    s_waitcnt vmcnt(5) lgkmcnt(8)
    ds_read_b128 v[92:95], v141 offset:23552
    v_lshlrev_b32 v4, 4, v3
    v_mfma_f32_16x16x32_bf16 v[8:11], v[96:99], v[40:43], v[8:11]
    ds_read_b128 v[96:99], v141 offset:24576
    v_mfma_f32_16x16x32_bf16 v[12:15], v[100:103], v[40:43], v[12:15]
    ds_read_b128 v[100:103], v141 offset:25600
    v_mfma_f32_16x16x32_bf16 v[16:19], v[104:107], v[40:43], v[16:19]
    ds_read_b128 v[104:107], v141 offset:26624
    v_mfma_f32_16x16x32_bf16 v[20:23], v[108:111], v[40:43], v[20:23]
    ds_read_b128 v[108:111], v141 offset:27648
    v_mfma_f32_16x16x32_bf16 v[24:27], v[40:43], v[112:115], v[24:27]
    s_waitcnt vmcnt(4) lgkmcnt(8)
    ds_read_b128 v[112:115], v141 offset:28672
    v_mfma_f32_16x16x32_bf16 v[8:11], v[116:119], v[44:47], v[8:11]
    ds_read_b128 v[116:119], v141 offset:29696
    v_mfma_f32_16x16x32_bf16 v[12:15], v[64:67], v[44:47], v[12:15]
    ds_read_b128 v[64:67], v141 offset:30720
    v_mfma_f32_16x16x32_bf16 v[16:19], v[68:71], v[44:47], v[16:19]
    ds_read_b128 v[68:71], v141 offset:31744
    v_mfma_f32_16x16x32_bf16 v[20:23], v[72:75], v[44:47], v[20:23]
    ds_read_b128 v[72:75], v141 offset:32768
    v_mfma_f32_16x16x32_bf16 v[24:27], v[44:47], v[76:79], v[24:27]
    s_waitcnt vmcnt(3) lgkmcnt(8)
    ds_read_b128 v[76:79], v141 offset:33792
    v_mfma_f32_16x16x32_bf16 v[8:11], v[80:83], v[48:51], v[8:11]
    ds_read_b128 v[80:83], v141 offset:34816
    v_mfma_f32_16x16x32_bf16 v[12:15], v[84:87], v[48:51], v[12:15]
    ds_read_b128 v[84:87], v141 offset:35840
    v_mfma_f32_16x16x32_bf16 v[16:19], v[88:91], v[48:51], v[16:19]
    ds_read_b128 v[88:91], v141 offset:36864
    v_mfma_f32_16x16x32_bf16 v[20:23], v[92:95], v[48:51], v[20:23]
    ds_read_b128 v[92:95], v141 offset:37888
    v_mfma_f32_16x16x32_bf16 v[24:27], v[48:51], v[96:99], v[24:27]
    s_waitcnt vmcnt(2) lgkmcnt(8)
    ds_read_b128 v[96:99], v141 offset:38912
    v_mfma_f32_16x16x32_bf16 v[8:11], v[100:103], v[52:55], v[8:11]
    ds_read_b128 v[100:103], v141 offset:39936
    v_mfma_f32_16x16x32_bf16 v[12:15], v[104:107], v[52:55], v[12:15]
    v_mfma_f32_16x16x32_bf16 v[16:19], v[108:111], v[52:55], v[16:19]
    v_mfma_f32_16x16x32_bf16 v[20:23], v[112:115], v[52:55], v[20:23]
    v_mfma_f32_16x16x32_bf16 v[24:27], v[52:55], v[116:119], v[24:27]
    s_waitcnt vmcnt(1) lgkmcnt(5)
    v_mfma_f32_16x16x32_bf16 v[8:11], v[64:67], v[56:59], v[8:11]
    v_mfma_f32_16x16x32_bf16 v[12:15], v[68:71], v[56:59], v[12:15]
    v_mfma_f32_16x16x32_bf16 v[16:19], v[72:75], v[56:59], v[16:19]
    v_mfma_f32_16x16x32_bf16 v[20:23], v[76:79], v[56:59], v[20:23]
    v_mfma_f32_16x16x32_bf16 v[24:27], v[56:59], v[80:83], v[24:27]
    s_waitcnt vmcnt(0) lgkmcnt(0)
    v_mfma_f32_16x16x32_bf16 v[8:11], v[84:87], v[60:63], v[8:11]
    v_mfma_f32_16x16x32_bf16 v[12:15], v[88:91], v[60:63], v[12:15]
    v_mfma_f32_16x16x32_bf16 v[16:19], v[92:95], v[60:63], v[16:19]
    v_mfma_f32_16x16x32_bf16 v[20:23], v[96:99], v[60:63], v[20:23]
    v_mfma_f32_16x16x32_bf16 v[24:27], v[60:63], v[100:103], v[24:27]
P4_GJ:
    s_nop 5
    s_bitcmp1_b32 s13, 0
    s_cbranch_scc1 P4_EV
    v_mul_f32 v24, v24, v136
    v_fma_f32 v24, -v148, v137, v24
    v_mul_f32 v25, v25, v136
    v_fma_f32 v25, -v149, v137, v25
    v_mul_f32 v26, v26, v136
    v_fma_f32 v26, -v150, v137, v26
    v_mul_f32 v27, v27, v136
    v_fma_f32 v27, -v151, v137, v27
    v_cvt_pk_bf16_f32 v24, v24, v25
    v_cvt_pk_bf16_f32 v25, v26, v27
    buffer_store_dwordx2 v[24:25], v5, s[4:7], s62 offen sc1
    s_branch P4_EJ
P4_EV:
    ds_bpermute_b32 v64, v4, v136 offset:0
    ds_bpermute_b32 v68, v4, v137 offset:0
    ds_bpermute_b32 v65, v4, v136 offset:4
    ds_bpermute_b32 v69, v4, v137 offset:4
    ds_bpermute_b32 v66, v4, v136 offset:8
    ds_bpermute_b32 v70, v4, v137 offset:8
    ds_bpermute_b32 v67, v4, v136 offset:12
    ds_bpermute_b32 v71, v4, v137 offset:12
    s_waitcnt lgkmcnt(0)
    v_mul_f32 v24, v24, v64
    v_fma_f32 v24, -v148, v68, v24
    v_mul_f32 v25, v25, v65
    v_fma_f32 v25, -v148, v69, v25
    v_mul_f32 v26, v26, v66
    v_fma_f32 v26, -v148, v70, v26
    v_mul_f32 v27, v27, v67
    v_fma_f32 v27, -v148, v71, v27
    v_cvt_pk_bf16_f32 v24, v24, v25
    v_cvt_pk_bf16_f32 v25, v26, v27
    buffer_store_dwordx2 v[24:25], v142, s[4:7], s62 offen sc1
P4_EJ:
    v_add_u32 v5, s60, v5
    v_pk_mul_f32 v[8:9], v[8:9], v[138:139] op_sel_hi:[1,0]
    v_pk_mul_f32 v[10:11], v[10:11], v[138:139] op_sel_hi:[1,0]
    v_pk_fma_f32 v[8:9], v[124:125], v[138:139], v[8:9] op_sel:[0,1,0] op_sel_hi:[1,1,1] neg_lo:[1,0,0] neg_hi:[1,0,0]
    v_pk_fma_f32 v[10:11], v[126:127], v[138:139], v[10:11] op_sel:[0,1,0] op_sel_hi:[1,1,1] neg_lo:[1,0,0] neg_hi:[1,0,0]
    v_cvt_pk_bf16_f32 v8, v8, v9
    v_cvt_pk_bf16_f32 v9, v10, v11
    ds_write_b64 v5, v[8:9] offset:0
    v_pk_mul_f32 v[12:13], v[12:13], v[138:139] op_sel_hi:[1,0]
    v_pk_mul_f32 v[14:15], v[14:15], v[138:139] op_sel_hi:[1,0]
    v_pk_fma_f32 v[12:13], v[128:129], v[138:139], v[12:13] op_sel:[0,1,0] op_sel_hi:[1,1,1] neg_lo:[1,0,0] neg_hi:[1,0,0]
    v_pk_fma_f32 v[14:15], v[130:131], v[138:139], v[14:15] op_sel:[0,1,0] op_sel_hi:[1,1,1] neg_lo:[1,0,0] neg_hi:[1,0,0]
    v_cvt_pk_bf16_f32 v12, v12, v13
    v_cvt_pk_bf16_f32 v13, v14, v15
    ds_write_b64 v5, v[12:13] offset:2048
    v_pk_mul_f32 v[16:17], v[16:17], v[138:139] op_sel_hi:[1,0]
    v_pk_mul_f32 v[18:19], v[18:19], v[138:139] op_sel_hi:[1,0]
    v_pk_fma_f32 v[16:17], v[132:133], v[138:139], v[16:17] op_sel:[0,1,0] op_sel_hi:[1,1,1] neg_lo:[1,0,0] neg_hi:[1,0,0]
    v_pk_fma_f32 v[18:19], v[134:135], v[138:139], v[18:19] op_sel:[0,1,0] op_sel_hi:[1,1,1] neg_lo:[1,0,0] neg_hi:[1,0,0]
    v_cvt_pk_bf16_f32 v16, v16, v17
    v_cvt_pk_bf16_f32 v17, v18, v19
    ds_write_b64 v5, v[16:17] offset:4096
    v_pk_mul_f32 v[20:21], v[20:21], v[138:139] op_sel_hi:[1,0]
    v_pk_mul_f32 v[22:23], v[22:23], v[138:139] op_sel_hi:[1,0]
    v_pk_fma_f32 v[20:21], v[144:145], v[138:139], v[20:21] op_sel:[0,1,0] op_sel_hi:[1,1,1] neg_lo:[1,0,0] neg_hi:[1,0,0]
    v_pk_fma_f32 v[22:23], v[146:147], v[138:139], v[22:23] op_sel:[0,1,0] op_sel_hi:[1,1,1] neg_lo:[1,0,0] neg_hi:[1,0,0]
    v_cvt_pk_bf16_f32 v20, v20, v21
    v_cvt_pk_bf16_f32 v21, v22, v23
    ds_write_b64 v5, v[20:21] offset:6144
    s_mov_b32 s3, 1
    v_mov_b32 v28, s43
    s_mul_i32 s15, s3, 0
    s_mul_i32 s24, s12, 524288
    s_add_u32 s15, s15, s24
    s_add_u32 s15, s15, 8388608
    s_add_u32 s16, s15, 0
    s_mul_i32 s17, s3, 131072
    s_add_u32 s17, s17, 4063232
    s_add_u32 s18, s17, 131072
    s_and_b32 s24, s2, 7
    s_lshl_b32 s24, s24, 7
    s_lshl_b32 s25, s3, 11
    s_add_u32 s24, s24, s25
    s_add_u32 s39, s24, 4390912
    s_add_u32 s69, s39, 1024
    s_lshr_b32 s25, s2, 3
    s_lshl_b32 s25, s25, 2
    s_add_u32 s68, s39, s25
    s_lshr_b32 s26, s14, 1
    s_lshl_b32 s25, s26, 11
    s_add_u32 s31, s25, s17
    s_and_b32 s30, s2, 7
    s_lshl_b32 s30, s30, 14
    s_and_b32 s25, s13, 3
    s_lshl_b32 s25, s25, 2
    s_add_u32 s25, s25, s14
    s_lshl_b32 s25, s25, 13
    s_add_u32 s99, s25, s17
    s_add_u32 s31, s31, s4
    s_addc_u32 s38, s5, 0
    v_bfe_u32 v26, v1, 2, 7
    v_lshrrev_b32 v4, 1, v3
    v_lshlrev_b32 v4, 8, v4
    v_lshl_add_u32 v7, v2, 4, v4
    v_and_b32 v4, 432, v1
    v_cmp_eq_u32 vcc, 256, v4
    v_mov_b32 v4, 0x3f803f80
    s_nop 0
    v_cndmask_b32 v4, 0, v4, vcc
    v_mov_b32 v132, v4
    v_mov_b32 v133, v4
    v_mov_b32 v134, v4
    v_mov_b32 v135, v4
    v_mov_b32 v136, v4
    v_mov_b32 v137, v4
    v_mov_b32 v138, v4
    v_mov_b32 v139, v4
    v_mov_b32 v144, v4
    v_mov_b32 v145, v4
    v_mov_b32 v146, v4
    v_mov_b32 v147, v4
    v_mov_b32 v148, v4
    v_mov_b32 v149, v4
    v_mov_b32 v150, v4
    v_mov_b32 v151, v4
    s_add_u32 s32, s30, s31
    s_addc_u32 s33, s38, 0
    s_waitcnt vmcnt(0) lgkmcnt(0)
    s_barrier
    s_cmp_lg_u32 s14, 0
    s_cbranch_scc1 FS_48
    s_cmp_lg_u32 s23, 0
    s_cbranch_scc1 FSS_49
    s_mov_b64 exec, 1
    buffer_store_dword v28, off, s[4:7], s68 offset:0
    s_mov_b64 exec, -1
FS_48:
    s_lshr_b32 s26, s14, 1
    s_and_b32 s27, s14, 1
    s_lshl_b32 s24, s27, 12
    s_add_u32 s24, s24, 155648
    s_lshl_b32 s25, s26, 11
    s_xor_b32 s28, s25, 2048
    s_add_u32 s25, s25, s24
    s_add_u32 s28, s28, s24
    v_add_u32 v24, s28, v1
    v_add_u32 v25, s25, v1
    ds_read_b128 v[8:11], v24 offset:0
    ds_read_b128 v[12:15], v24 offset:1024
    ds_read_b128 v[16:19], v25 offset:0
    ds_read_b128 v[20:23], v25 offset:1024
    s_lshl_b32 s29, s14, 13
    s_add_u32 s29, s29, 131072
    v_add_u32 v4, s29, v1
    v_bfe_u32 v6, v1, 2, 5
    s_cmp_lg_u32 s14, 1
    s_cbranch_scc1 XL1_SKIP
    s_mov_b32 s25, 0
XL1_POLL:
    buffer_load_dword v27, v26, s[4:7], s39 offen sc1
    s_add_u32 s25, s25, 1
    s_waitcnt vmcnt(0)
    s_cmp_gt_u32 s25, 400000
    s_cbranch_scc1 XL1_DONE
    v_cmp_ne_u32 vcc, s43, v27
    s_nop 1
    s_cbranch_vccnz XL1_POLL
XL1_DONE:
    s_cmp_ge_u32 s2, 8
    s_cbranch_scc1 XL1_SKIP
    s_lshl_b32 s25, s2, 2
    s_add_u32 s24, s25, 4393984
    v_lshlrev_b32 v27, 3, v1
    v_mov_b32 v5, s43
    s_mov_b64 exec, 0xff
    buffer_store_dword v5, v27, s[4:7], s24 offen sc1
    s_mov_b64 exec, -1
XL1_SKIP:
    s_barrier
    global_load_dwordx4 v[128:131], v1, s[32:33]
    s_mov_b64 exec, s[20:21]
    global_load_dwordx4 v[132:135], v7, s[32:33] offset:1024
    global_load_dwordx4 v[136:139], v7, s[32:33] offset:1536
    s_mov_b64 exec, -1
    s_add_u32 s30, s30, 4096
    s_and_b32 s30, s30, 0x1ffff
    s_add_u32 s32, s30, s31
    s_addc_u32 s33, s38, 0
    global_load_dwordx4 v[140:143], v1, s[32:33]
    s_lshl_b32 s24, s3, 15
    s_lshl_b32 s29, s12, 10
    s_add_u32 s24, s24, s29
    s_add_u32 s22, s24, 4325376
    s_lshl_b32 s29, s13, 2
    s_add_u32 s19, s22, s29
    s_lshl_b32 s24, s14, 7
    s_add_u32 s24, s24, s16
    s_add_u32 s67, s24, 442368
    s_lshl_b32 s24, s14, 14
    s_lshl_b32 s25, s13, 11
    s_add_u32 s24, s24, s25
    s_add_u32 s24, s24, s15
    s_add_u32 s52, s24, 0
    s_lshl_b32 s25, s13, 9
    s_lshl_b32 s26, s14, 7
    s_add_u32 s25, s25, s26
    s_add_u32 s25, s25, s15
    s_add_u32 s53, s25, 442368
    s_lshl_b32 s24, s13, 4
    s_lshl_b32 s25, s14, 2
    s_add_u32 s24, s24, s25
    s_add_u32 s54, s24, s22
    s_lshl_b32 s24, s13, 1
    s_and_b32 s25, s14, 1
    s_add_u32 s24, s24, s25
    s_lshl_b32 s24, s24, 10
    s_lshr_b32 s25, s14, 1
    s_lshl_b32 s25, s25, 9
    s_add_u32 s24, s24, s25
    s_add_u32 s24, s24, s15
    s_add_u32 s36, s24, 131072
    s_add_u32 s37, s36, 32768
    s_lshr_b32 s24, s13, 1
    s_mul_i32 s24, s24, 11
    s_and_b32 s25, s13, 1
    s_lshl_b32 s26, s25, 2
    s_add_u32 s26, s26, s14
    s_add_u32 s26, s26, s24
    s_lshl_b32 s26, s26, 10
    s_add_u32 s27, s15, 262144
    s_add_u32 s56, s26, s27
    s_mul_i32 s25, s25, 3
    s_add_u32 s25, s25, s14
    s_lshl_b32 s25, s25, 9
    s_add_u32 s24, s24, 8
    s_lshl_b32 s24, s24, 10
    s_add_u32 s24, s24, s25
    s_add_u32 s24, s24, s27
    s_cmp_eq_u32 s14, 3
    s_cselect_b32 s57, 25165824, s24
    s_mul_i32 s24, s14, 11264
    s_add_u32 s58, s24, s27
    s_lshl_b32 s25, s14, 12
    s_add_u32 s26, s25, s15
    s_add_u32 s59, s26, 0
    s_lshl_b32 s25, s14, 10
    s_add_u32 s26, s25, s15
    s_add_u32 s66, s26, 442368
    s_waitcnt vmcnt(3) lgkmcnt(0)
    v_mfma_f32_32x32x16_bf16 v[24:39], v[128:131], v[8:11], 0
    s_nop 7
    v_mfma_f32_32x32x16_bf16 v[40:55], v[128:131], v[12:15], 0
    s_waitcnt vmcnt(1)
    s_nop 1
    v_exp_f32 v24, v24
    v_exp_f32 v25, v25
    v_exp_f32 v26, v26
    v_exp_f32 v27, v27
    v_cvt_pk_bf16_f32 v56, v24, v25
    v_exp_f32 v28, v28
    s_mov_b64 exec, s[20:21]
    global_load_dwordx4 v[144:147], v7, s[32:33] offset:1024
    global_load_dwordx4 v[148:151], v7, s[32:33] offset:1536
    s_mov_b64 exec, -1
    v_exp_f32 v29, v29
    v_cvt_pk_bf16_f32 v57, v26, v27
    v_exp_f32 v30, v30
    v_exp_f32 v31, v31
    v_cvt_pk_bf16_f32 v58, v28, v29
    v_exp_f32 v32, v32
    v_cvt_pk_bf16_f32 v59, v30, v31
    v_exp_f32 v33, v33
    v_exp_f32 v34, v34
    v_mfma_f32_32x32x16_bf16 v[64:79], v[132:135], v[56:59], 0
    v_cvt_pk_bf16_f32 v60, v32, v33
    v_exp_f32 v35, v35
    v_exp_f32 v36, v36
    v_cvt_pk_bf16_f32 v61, v34, v35
    v_exp_f32 v37, v37
    v_exp_f32 v38, v38
    v_exp_f32 v39, v39
    v_cvt_pk_bf16_f32 v62, v36, v37
    v_cvt_pk_bf16_f32 v63, v38, v39
    v_mfma_f32_32x32x16_bf16 v[24:39], v[128:131], v[16:19], 0
    s_add_u32 s30, s30, 4096
    v_exp_f32 v40, v40
    v_exp_f32 v41, v41
    v_exp_f32 v42, v42
    v_exp_f32 v43, v43
    v_cvt_pk_bf16_f32 v56, v40, v41
    v_exp_f32 v44, v44
    v_mfma_f32_32x32x16_bf16 v[64:79], v[136:139], v[60:63], v[64:79]
    v_exp_f32 v45, v45
    v_cvt_pk_bf16_f32 v57, v42, v43
    v_exp_f32 v46, v46
    v_exp_f32 v47, v47
    v_cvt_pk_bf16_f32 v58, v44, v45
    v_exp_f32 v48, v48
    v_cvt_pk_bf16_f32 v59, v46, v47
    v_exp_f32 v49, v49
    v_exp_f32 v50, v50
    v_mfma_f32_32x32x16_bf16 v[80:95], v[132:135], v[56:59], 0
    s_and_b32 s30, s30, 0x1ffff
    v_cvt_pk_bf16_f32 v60, v48, v49
    v_exp_f32 v51, v51
    v_exp_f32 v52, v52
    v_cvt_pk_bf16_f32 v61, v50, v51
    v_exp_f32 v53, v53
    v_exp_f32 v54, v54
    v_exp_f32 v55, v55
    v_cvt_pk_bf16_f32 v62, v52, v53
    v_cvt_pk_bf16_f32 v63, v54, v55
    v_mfma_f32_32x32x16_bf16 v[40:55], v[128:131], v[20:23], 0
    s_add_u32 s32, s30, s31
    v_exp_f32 v24, v24
    v_exp_f32 v25, v25
    v_exp_f32 v26, v26
    v_exp_f32 v27, v27
    v_cvt_pk_bf16_f32 v56, v24, v25
    v_exp_f32 v28, v28
    v_mfma_f32_32x32x16_bf16 v[80:95], v[136:139], v[60:63], v[80:95]
    s_addc_u32 s33, s38, 0
    v_exp_f32 v29, v29
    v_cvt_pk_bf16_f32 v57, v26, v27
    v_exp_f32 v30, v30
    v_exp_f32 v31, v31
    v_cvt_pk_bf16_f32 v58, v28, v29
    v_exp_f32 v32, v32
    v_cvt_pk_bf16_f32 v59, v30, v31
    v_exp_f32 v33, v33
    v_exp_f32 v34, v34
    v_mfma_f32_32x32x16_bf16 v[96:111], v[132:135], v[56:59], 0
    s_waitcnt vmcnt(2)
    v_cvt_pk_bf16_f32 v60, v32, v33
    v_exp_f32 v35, v35
    v_exp_f32 v36, v36
    v_cvt_pk_bf16_f32 v61, v34, v35
    v_exp_f32 v37, v37
    v_exp_f32 v38, v38
    v_exp_f32 v39, v39
    v_cvt_pk_bf16_f32 v62, v36, v37
    v_cvt_pk_bf16_f32 v63, v38, v39
    v_mfma_f32_32x32x16_bf16 v[24:39], v[140:143], v[8:11], 0
    global_load_dwordx4 v[128:131], v1, s[32:33]
    v_exp_f32 v40, v40
    v_exp_f32 v41, v41
    v_exp_f32 v42, v42
    v_exp_f32 v43, v43
    v_cvt_pk_bf16_f32 v56, v40, v41
    v_exp_f32 v44, v44
    v_mfma_f32_32x32x16_bf16 v[96:111], v[136:139], v[60:63], v[96:111]
    s_add_u32 s34, s4, s72
    v_exp_f32 v45, v45
    v_cvt_pk_bf16_f32 v57, v42, v43
    v_exp_f32 v46, v46
    v_exp_f32 v47, v47
    v_cvt_pk_bf16_f32 v58, v44, v45
    v_exp_f32 v48, v48
    v_cvt_pk_bf16_f32 v59, v46, v47
    v_exp_f32 v49, v49
    v_exp_f32 v50, v50
    v_mfma_f32_32x32x16_bf16 v[112:127], v[132:135], v[56:59], 0
    s_addc_u32 s35, s5, 0
    v_cvt_pk_bf16_f32 v60, v48, v49
    v_exp_f32 v51, v51
    v_exp_f32 v52, v52
    v_cvt_pk_bf16_f32 v61, v50, v51
    v_exp_f32 v53, v53
    v_exp_f32 v54, v54
    v_exp_f32 v55, v55
    v_cvt_pk_bf16_f32 v62, v52, v53
    v_cvt_pk_bf16_f32 v63, v54, v55
    v_mfma_f32_32x32x16_bf16 v[40:55], v[140:143], v[12:15], 0
    s_waitcnt vmcnt(1)
    v_exp_f32 v24, v24
    v_exp_f32 v25, v25
    v_exp_f32 v26, v26
    v_exp_f32 v27, v27
    v_cvt_pk_bf16_f32 v56, v24, v25
    v_exp_f32 v28, v28
    v_mfma_f32_32x32x16_bf16 v[112:127], v[136:139], v[60:63], v[112:127]
    s_mov_b64 exec, s[20:21]
    global_load_dwordx4 v[132:135], v7, s[32:33] offset:1024
    global_load_dwordx4 v[136:139], v7, s[32:33] offset:1536
    s_mov_b64 exec, -1
    v_exp_f32 v29, v29
    v_cvt_pk_bf16_f32 v57, v26, v27
    v_exp_f32 v30, v30
    v_exp_f32 v31, v31
    v_cvt_pk_bf16_f32 v58, v28, v29
    v_exp_f32 v32, v32
    v_cvt_pk_bf16_f32 v59, v30, v31
    v_exp_f32 v33, v33
    v_exp_f32 v34, v34
    v_mfma_f32_32x32x16_bf16 v[64:79], v[144:147], v[56:59], v[64:79]
    s_lshl_b32 m0, s76, 2
    v_cvt_pk_bf16_f32 v60, v32, v33
    v_exp_f32 v35, v35
    v_exp_f32 v36, v36
    v_cvt_pk_bf16_f32 v61, v34, v35
    v_exp_f32 v37, v37
    v_exp_f32 v38, v38
    v_exp_f32 v39, v39
    v_cvt_pk_bf16_f32 v62, v36, v37
    v_cvt_pk_bf16_f32 v63, v38, v39
    v_mfma_f32_32x32x16_bf16 v[24:39], v[140:143], v[16:19], 0
    s_add_u32 s30, s30, 4096
    v_exp_f32 v40, v40
    v_exp_f32 v41, v41
    v_exp_f32 v42, v42
    v_exp_f32 v43, v43
    v_cvt_pk_bf16_f32 v56, v40, v41
    v_exp_f32 v44, v44
    v_mfma_f32_32x32x16_bf16 v[64:79], v[148:151], v[60:63], v[64:79]
    global_load_lds_dwordx4 v1, s[34:35] offset:0
    global_load_lds_dwordx4 v1, s[34:35] offset:1024
    global_load_lds_dwordx4 v1, s[34:35] offset:2048
    v_exp_f32 v45, v45
    v_cvt_pk_bf16_f32 v57, v42, v43
    v_exp_f32 v46, v46
    v_exp_f32 v47, v47
    v_cvt_pk_bf16_f32 v58, v44, v45
    v_exp_f32 v48, v48
    v_cvt_pk_bf16_f32 v59, v46, v47
    v_exp_f32 v49, v49
    v_exp_f32 v50, v50
    v_mfma_f32_32x32x16_bf16 v[80:95], v[144:147], v[56:59], v[80:95]
    s_and_b32 s30, s30, 0x1ffff
    v_cvt_pk_bf16_f32 v60, v48, v49
    v_exp_f32 v51, v51
    v_exp_f32 v52, v52
    v_cvt_pk_bf16_f32 v61, v50, v51
    v_exp_f32 v53, v53
    v_exp_f32 v54, v54
    v_exp_f32 v55, v55
    v_cvt_pk_bf16_f32 v62, v52, v53
    v_cvt_pk_bf16_f32 v63, v54, v55
    v_mfma_f32_32x32x16_bf16 v[40:55], v[140:143], v[20:23], 0
    s_add_u32 s32, s30, s31
    v_exp_f32 v24, v24
    v_exp_f32 v25, v25
    v_exp_f32 v26, v26
    v_exp_f32 v27, v27
    v_cvt_pk_bf16_f32 v56, v24, v25
    v_exp_f32 v28, v28
    v_mfma_f32_32x32x16_bf16 v[80:95], v[148:151], v[60:63], v[80:95]
    s_addc_u32 s33, s38, 0
    v_exp_f32 v29, v29
    v_cvt_pk_bf16_f32 v57, v26, v27
    v_exp_f32 v30, v30
    v_exp_f32 v31, v31
    v_cvt_pk_bf16_f32 v58, v28, v29
    v_exp_f32 v32, v32
    v_cvt_pk_bf16_f32 v59, v30, v31
    v_exp_f32 v33, v33
    v_exp_f32 v34, v34
    v_mfma_f32_32x32x16_bf16 v[96:111], v[144:147], v[56:59], v[96:111]
    s_waitcnt vmcnt(5)
    v_cvt_pk_bf16_f32 v60, v32, v33
    v_exp_f32 v35, v35
    v_exp_f32 v36, v36
    v_cvt_pk_bf16_f32 v61, v34, v35
    v_exp_f32 v37, v37
    v_exp_f32 v38, v38
    v_exp_f32 v39, v39
    v_cvt_pk_bf16_f32 v62, v36, v37
    v_cvt_pk_bf16_f32 v63, v38, v39
    v_mfma_f32_32x32x16_bf16 v[24:39], v[128:131], v[8:11], 0
    global_load_dwordx4 v[140:143], v1, s[32:33]
    buffer_load_dword v5, v6, s[4:7], s69 offen sc1
    v_exp_f32 v40, v40
    v_exp_f32 v41, v41
    v_exp_f32 v42, v42
    v_exp_f32 v43, v43
    v_cvt_pk_bf16_f32 v56, v40, v41
    v_exp_f32 v44, v44
    v_mfma_f32_32x32x16_bf16 v[96:111], v[148:151], v[60:63], v[96:111]
    v_exp_f32 v45, v45
    v_cvt_pk_bf16_f32 v57, v42, v43
    v_exp_f32 v46, v46
    v_exp_f32 v47, v47
    v_cvt_pk_bf16_f32 v58, v44, v45
    v_exp_f32 v48, v48
    v_cvt_pk_bf16_f32 v59, v46, v47
    v_exp_f32 v49, v49
    v_exp_f32 v50, v50
    v_mfma_f32_32x32x16_bf16 v[112:127], v[144:147], v[56:59], v[112:127]
    v_cvt_pk_bf16_f32 v60, v48, v49
    v_exp_f32 v51, v51
    v_exp_f32 v52, v52
    v_cvt_pk_bf16_f32 v61, v50, v51
    v_exp_f32 v53, v53
    v_exp_f32 v54, v54
    v_exp_f32 v55, v55
    v_cvt_pk_bf16_f32 v62, v52, v53
    v_cvt_pk_bf16_f32 v63, v54, v55
    v_mfma_f32_32x32x16_bf16 v[40:55], v[128:131], v[12:15], 0
    s_waitcnt vmcnt(5)
    v_exp_f32 v24, v24
    v_exp_f32 v25, v25
    v_exp_f32 v26, v26
    v_exp_f32 v27, v27
    v_cvt_pk_bf16_f32 v56, v24, v25
    v_exp_f32 v28, v28
    v_mfma_f32_32x32x16_bf16 v[112:127], v[148:151], v[60:63], v[112:127]
    s_mov_b64 exec, s[20:21]
    global_load_dwordx4 v[144:147], v7, s[32:33] offset:1024
    global_load_dwordx4 v[148:151], v7, s[32:33] offset:1536
    s_mov_b64 exec, -1
    v_exp_f32 v29, v29
    v_cvt_pk_bf16_f32 v57, v26, v27
    v_exp_f32 v30, v30
    v_exp_f32 v31, v31
    v_cvt_pk_bf16_f32 v58, v28, v29
    v_exp_f32 v32, v32
    v_cvt_pk_bf16_f32 v59, v30, v31
    v_exp_f32 v33, v33
    v_exp_f32 v34, v34
    v_mfma_f32_32x32x16_bf16 v[64:79], v[132:135], v[56:59], v[64:79]
    v_cvt_pk_bf16_f32 v60, v32, v33
    v_exp_f32 v35, v35
    v_exp_f32 v36, v36
    v_cvt_pk_bf16_f32 v61, v34, v35
    v_exp_f32 v37, v37
    v_exp_f32 v38, v38
    v_exp_f32 v39, v39
    v_cvt_pk_bf16_f32 v62, v36, v37
    v_cvt_pk_bf16_f32 v63, v38, v39
    v_mfma_f32_32x32x16_bf16 v[24:39], v[128:131], v[16:19], 0
    s_add_u32 s30, s30, 4096
    v_exp_f32 v40, v40
    v_exp_f32 v41, v41
    v_exp_f32 v42, v42
    v_exp_f32 v43, v43
    v_cvt_pk_bf16_f32 v56, v40, v41
    v_exp_f32 v44, v44
    v_mfma_f32_32x32x16_bf16 v[64:79], v[136:139], v[60:63], v[64:79]
    v_exp_f32 v45, v45
    v_cvt_pk_bf16_f32 v57, v42, v43
    v_exp_f32 v46, v46
    v_exp_f32 v47, v47
    v_cvt_pk_bf16_f32 v58, v44, v45
    v_exp_f32 v48, v48
    v_cvt_pk_bf16_f32 v59, v46, v47
    v_exp_f32 v49, v49
    v_exp_f32 v50, v50
    v_mfma_f32_32x32x16_bf16 v[80:95], v[132:135], v[56:59], v[80:95]
    s_and_b32 s30, s30, 0x1ffff
    v_cvt_pk_bf16_f32 v60, v48, v49
    v_exp_f32 v51, v51
    v_exp_f32 v52, v52
    v_cvt_pk_bf16_f32 v61, v50, v51
    v_exp_f32 v53, v53
    v_exp_f32 v54, v54
    v_exp_f32 v55, v55
    v_cvt_pk_bf16_f32 v62, v52, v53
    v_cvt_pk_bf16_f32 v63, v54, v55
    v_mfma_f32_32x32x16_bf16 v[40:55], v[128:131], v[20:23], 0
    s_add_u32 s32, s30, s31
    v_exp_f32 v24, v24
    v_exp_f32 v25, v25
    v_exp_f32 v26, v26
    v_exp_f32 v27, v27
    v_cvt_pk_bf16_f32 v56, v24, v25
    v_exp_f32 v28, v28
    v_mfma_f32_32x32x16_bf16 v[80:95], v[136:139], v[60:63], v[80:95]
    s_addc_u32 s33, s38, 0
    v_exp_f32 v29, v29
    v_cvt_pk_bf16_f32 v57, v26, v27
    v_exp_f32 v30, v30
    v_exp_f32 v31, v31
    v_cvt_pk_bf16_f32 v58, v28, v29
    v_exp_f32 v32, v32
    v_cvt_pk_bf16_f32 v59, v30, v31
    v_exp_f32 v33, v33
    v_exp_f32 v34, v34
    v_mfma_f32_32x32x16_bf16 v[96:111], v[132:135], v[56:59], v[96:111]
    s_waitcnt vmcnt(3)
    s_waitcnt vmcnt(2)
    v_cmp_ne_u32 vcc, s43, v5
    s_nop 1
    s_cbranch_vccnz XG1_SLOW
XG1_OK:
    v_cvt_pk_bf16_f32 v60, v32, v33
    v_exp_f32 v35, v35
    v_exp_f32 v36, v36
    v_cvt_pk_bf16_f32 v61, v34, v35
    v_exp_f32 v37, v37
    v_exp_f32 v38, v38
    v_exp_f32 v39, v39
    v_cvt_pk_bf16_f32 v62, v36, v37
    v_cvt_pk_bf16_f32 v63, v38, v39
    v_mfma_f32_32x32x16_bf16 v[24:39], v[140:143], v[8:11], 0
    global_load_dwordx4 v[128:131], v1, s[32:33]
    v_exp_f32 v40, v40
    v_exp_f32 v41, v41
    v_exp_f32 v42, v42
    v_exp_f32 v43, v43
    v_cvt_pk_bf16_f32 v56, v40, v41
    v_exp_f32 v44, v44
    v_mfma_f32_32x32x16_bf16 v[96:111], v[136:139], v[60:63], v[96:111]
    s_add_u32 s34, s34, 2048
    v_lshlrev_b32 v5, 3, v1
    v_exp_f32 v45, v45
    v_cvt_pk_bf16_f32 v57, v42, v43
    v_exp_f32 v46, v46
    v_exp_f32 v47, v47
    v_cvt_pk_bf16_f32 v58, v44, v45
    v_exp_f32 v48, v48
    v_cvt_pk_bf16_f32 v59, v46, v47
    v_exp_f32 v49, v49
    v_exp_f32 v50, v50
    v_mfma_f32_32x32x16_bf16 v[112:127], v[132:135], v[56:59], v[112:127]
    s_addc_u32 s35, s35, 0
    buffer_load_dword v5, v5, s[4:7], s99 offen
    v_cvt_pk_bf16_f32 v60, v48, v49
    v_exp_f32 v51, v51
    v_exp_f32 v52, v52
    v_cvt_pk_bf16_f32 v61, v50, v51
    v_exp_f32 v53, v53
    v_exp_f32 v54, v54
    v_exp_f32 v55, v55
    v_cvt_pk_bf16_f32 v62, v52, v53
    v_cvt_pk_bf16_f32 v63, v54, v55
    v_mfma_f32_32x32x16_bf16 v[40:55], v[140:143], v[12:15], 0
    s_waitcnt vmcnt(2)
    v_exp_f32 v24, v24
    v_exp_f32 v25, v25
    v_exp_f32 v26, v26
    v_exp_f32 v27, v27
    v_cvt_pk_bf16_f32 v56, v24, v25
    v_exp_f32 v28, v28
    v_mfma_f32_32x32x16_bf16 v[112:127], v[136:139], v[60:63], v[112:127]
    s_mov_b64 exec, s[20:21]
    global_load_dwordx4 v[132:135], v7, s[32:33] offset:1024
    global_load_dwordx4 v[136:139], v7, s[32:33] offset:1536
    s_mov_b64 exec, -1
    v_exp_f32 v29, v29
    v_cvt_pk_bf16_f32 v57, v26, v27
    v_exp_f32 v30, v30
    v_exp_f32 v31, v31
    v_cvt_pk_bf16_f32 v58, v28, v29
    v_exp_f32 v32, v32
    v_cvt_pk_bf16_f32 v59, v30, v31
    v_exp_f32 v33, v33
    v_exp_f32 v34, v34
    v_mfma_f32_32x32x16_bf16 v[64:79], v[144:147], v[56:59], v[64:79]
    s_add_u32 m0, m0, 2048
    v_cvt_pk_bf16_f32 v60, v32, v33
    v_exp_f32 v35, v35
    v_exp_f32 v36, v36
    v_cvt_pk_bf16_f32 v61, v34, v35
    v_exp_f32 v37, v37
    v_exp_f32 v38, v38
    v_exp_f32 v39, v39
    v_cvt_pk_bf16_f32 v62, v36, v37
    v_cvt_pk_bf16_f32 v63, v38, v39
    v_mfma_f32_32x32x16_bf16 v[24:39], v[140:143], v[16:19], 0
    s_add_u32 s30, s30, 4096
    v_exp_f32 v40, v40
    v_exp_f32 v41, v41
    v_exp_f32 v42, v42
    v_exp_f32 v43, v43
    v_cvt_pk_bf16_f32 v56, v40, v41
    v_exp_f32 v44, v44
    v_mfma_f32_32x32x16_bf16 v[64:79], v[148:151], v[60:63], v[64:79]
    v_exp_f32 v45, v45
    v_cvt_pk_bf16_f32 v57, v42, v43
    v_exp_f32 v46, v46
    v_exp_f32 v47, v47
    v_cvt_pk_bf16_f32 v58, v44, v45
    v_exp_f32 v48, v48
    v_cvt_pk_bf16_f32 v59, v46, v47
    v_exp_f32 v49, v49
    v_exp_f32 v50, v50
    v_mfma_f32_32x32x16_bf16 v[80:95], v[144:147], v[56:59], v[80:95]
    s_and_b32 s30, s30, 0x1ffff
    v_cvt_pk_bf16_f32 v60, v48, v49
    v_exp_f32 v51, v51
    v_exp_f32 v52, v52
    v_cvt_pk_bf16_f32 v61, v50, v51
    v_exp_f32 v53, v53
    v_exp_f32 v54, v54
    v_exp_f32 v55, v55
    v_cvt_pk_bf16_f32 v62, v52, v53
    v_cvt_pk_bf16_f32 v63, v54, v55
    v_mfma_f32_32x32x16_bf16 v[40:55], v[140:143], v[20:23], 0
    s_add_u32 s32, s30, s31
    v_exp_f32 v24, v24
    v_exp_f32 v25, v25
    v_exp_f32 v26, v26
    v_exp_f32 v27, v27
    v_cvt_pk_bf16_f32 v56, v24, v25
    v_exp_f32 v28, v28
    v_mfma_f32_32x32x16_bf16 v[80:95], v[148:151], v[60:63], v[80:95]
    s_addc_u32 s33, s38, 0
    v_exp_f32 v29, v29
    v_cvt_pk_bf16_f32 v57, v26, v27
    v_exp_f32 v30, v30
    v_exp_f32 v31, v31
    v_cvt_pk_bf16_f32 v58, v28, v29
    v_exp_f32 v32, v32
    v_cvt_pk_bf16_f32 v59, v30, v31
    v_exp_f32 v33, v33
    v_exp_f32 v34, v34
    v_mfma_f32_32x32x16_bf16 v[96:111], v[144:147], v[56:59], v[96:111]
    s_waitcnt vmcnt(3)
    v_cvt_pk_bf16_f32 v60, v32, v33
    v_exp_f32 v35, v35
    v_exp_f32 v36, v36
    v_cvt_pk_bf16_f32 v61, v34, v35
    v_exp_f32 v37, v37
    v_exp_f32 v38, v38
    v_exp_f32 v39, v39
    v_cvt_pk_bf16_f32 v62, v36, v37
    v_cvt_pk_bf16_f32 v63, v38, v39
    v_mfma_f32_32x32x16_bf16 v[24:39], v[128:131], v[8:11], 0
    global_load_dwordx4 v[140:143], v1, s[32:33]
    v_exp_f32 v40, v40
    v_exp_f32 v41, v41
    v_exp_f32 v42, v42
    v_exp_f32 v43, v43
    v_cvt_pk_bf16_f32 v56, v40, v41
    v_exp_f32 v44, v44
    v_mfma_f32_32x32x16_bf16 v[96:111], v[148:151], v[60:63], v[96:111]
    s_add_u32 s34, s34, 1024
    v_exp_f32 v45, v45
    v_cvt_pk_bf16_f32 v57, v42, v43
    v_exp_f32 v46, v46
    v_exp_f32 v47, v47
    v_cvt_pk_bf16_f32 v58, v44, v45
    v_exp_f32 v48, v48
    v_cvt_pk_bf16_f32 v59, v46, v47
    v_exp_f32 v49, v49
    v_exp_f32 v50, v50
    v_mfma_f32_32x32x16_bf16 v[112:127], v[144:147], v[56:59], v[112:127]
    s_addc_u32 s35, s35, 0
    v_cvt_pk_bf16_f32 v60, v48, v49
    v_exp_f32 v51, v51
    v_exp_f32 v52, v52
    v_cvt_pk_bf16_f32 v61, v50, v51
    v_exp_f32 v53, v53
    v_exp_f32 v54, v54
    v_exp_f32 v55, v55
    v_cvt_pk_bf16_f32 v62, v52, v53
    v_cvt_pk_bf16_f32 v63, v54, v55
    s_mov_b32 s28, 13
.p2align 6
ATT1_LOOP:
    v_mfma_f32_32x32x16_bf16 v[40:55], v[128:131], v[12:15], 0
    s_waitcnt vmcnt(1)
    v_exp_f32 v24, v24
    v_exp_f32 v25, v25
    v_exp_f32 v26, v26
    v_exp_f32 v27, v27
    v_cvt_pk_bf16_f32 v56, v24, v25
    v_exp_f32 v28, v28
    v_mfma_f32_32x32x16_bf16 v[112:127], v[148:151], v[60:63], v[112:127]
    s_mov_b64 exec, s[20:21]
    global_load_dwordx4 v[144:147], v7, s[32:33] offset:1024
    global_load_dwordx4 v[148:151], v7, s[32:33] offset:1536
    s_mov_b64 exec, -1
    v_exp_f32 v29, v29
    v_cvt_pk_bf16_f32 v57, v26, v27
    v_exp_f32 v30, v30
    v_exp_f32 v31, v31
    v_cvt_pk_bf16_f32 v58, v28, v29
    v_exp_f32 v32, v32
    v_cvt_pk_bf16_f32 v59, v30, v31
    v_exp_f32 v33, v33
    v_exp_f32 v34, v34
    v_mfma_f32_32x32x16_bf16 v[64:79], v[132:135], v[56:59], v[64:79]
    s_add_u32 m0, m0, 1024
    v_cvt_pk_bf16_f32 v60, v32, v33
    v_exp_f32 v35, v35
    v_exp_f32 v36, v36
    v_cvt_pk_bf16_f32 v61, v34, v35
    v_exp_f32 v37, v37
    v_exp_f32 v38, v38
    v_exp_f32 v39, v39
    v_cvt_pk_bf16_f32 v62, v36, v37
    v_cvt_pk_bf16_f32 v63, v38, v39
    v_mfma_f32_32x32x16_bf16 v[24:39], v[128:131], v[16:19], 0
    s_add_u32 s30, s30, 4096
    v_exp_f32 v40, v40
    v_exp_f32 v41, v41
    v_exp_f32 v42, v42
    v_exp_f32 v43, v43
    v_cvt_pk_bf16_f32 v56, v40, v41
    v_exp_f32 v44, v44
    v_mfma_f32_32x32x16_bf16 v[64:79], v[136:139], v[60:63], v[64:79]
    global_load_lds_dwordx4 v1, s[34:35] offset:0
    v_exp_f32 v45, v45
    v_cvt_pk_bf16_f32 v57, v42, v43
    v_exp_f32 v46, v46
    v_exp_f32 v47, v47
    v_cvt_pk_bf16_f32 v58, v44, v45
    v_exp_f32 v48, v48
    v_cvt_pk_bf16_f32 v59, v46, v47
    v_exp_f32 v49, v49
    v_exp_f32 v50, v50
    v_mfma_f32_32x32x16_bf16 v[80:95], v[132:135], v[56:59], v[80:95]
    s_and_b32 s30, s30, 0x1ffff
    v_cvt_pk_bf16_f32 v60, v48, v49
    v_exp_f32 v51, v51
    v_exp_f32 v52, v52
    v_cvt_pk_bf16_f32 v61, v50, v51
    v_exp_f32 v53, v53
    v_exp_f32 v54, v54
    v_exp_f32 v55, v55
    v_cvt_pk_bf16_f32 v62, v52, v53
    v_cvt_pk_bf16_f32 v63, v54, v55
    v_mfma_f32_32x32x16_bf16 v[40:55], v[128:131], v[20:23], 0
    s_add_u32 s32, s30, s31
    v_exp_f32 v24, v24
    v_exp_f32 v25, v25
    v_exp_f32 v26, v26
    v_exp_f32 v27, v27
    v_cvt_pk_bf16_f32 v56, v24, v25
    v_exp_f32 v28, v28
    v_mfma_f32_32x32x16_bf16 v[80:95], v[136:139], v[60:63], v[80:95]
    s_addc_u32 s33, s38, 0
    v_exp_f32 v29, v29
    v_cvt_pk_bf16_f32 v57, v26, v27
    v_exp_f32 v30, v30
    v_exp_f32 v31, v31
    v_cvt_pk_bf16_f32 v58, v28, v29
    v_exp_f32 v32, v32
    v_cvt_pk_bf16_f32 v59, v30, v31
    v_exp_f32 v33, v33
    v_exp_f32 v34, v34
    v_mfma_f32_32x32x16_bf16 v[96:111], v[132:135], v[56:59], v[96:111]
    s_waitcnt vmcnt(3)
    v_cvt_pk_bf16_f32 v60, v32, v33
    v_exp_f32 v35, v35
    v_exp_f32 v36, v36
    v_cvt_pk_bf16_f32 v61, v34, v35
    v_exp_f32 v37, v37
    v_exp_f32 v38, v38
    v_exp_f32 v39, v39
    v_cvt_pk_bf16_f32 v62, v36, v37
    v_cvt_pk_bf16_f32 v63, v38, v39
    v_mfma_f32_32x32x16_bf16 v[24:39], v[140:143], v[8:11], 0
    global_load_dwordx4 v[128:131], v1, s[32:33]
    v_exp_f32 v40, v40
    v_exp_f32 v41, v41
    v_exp_f32 v42, v42
    v_exp_f32 v43, v43
    v_cvt_pk_bf16_f32 v56, v40, v41
    v_exp_f32 v44, v44
    v_mfma_f32_32x32x16_bf16 v[96:111], v[136:139], v[60:63], v[96:111]
    v_exp_f32 v45, v45
    v_cvt_pk_bf16_f32 v57, v42, v43
    v_exp_f32 v46, v46
    v_exp_f32 v47, v47
    v_cvt_pk_bf16_f32 v58, v44, v45
    v_exp_f32 v48, v48
    v_cvt_pk_bf16_f32 v59, v46, v47
    v_exp_f32 v49, v49
    v_exp_f32 v50, v50
    v_mfma_f32_32x32x16_bf16 v[112:127], v[132:135], v[56:59], v[112:127]
    v_cvt_pk_bf16_f32 v60, v48, v49
    v_exp_f32 v51, v51
    v_exp_f32 v52, v52
    v_cvt_pk_bf16_f32 v61, v50, v51
    v_exp_f32 v53, v53
    v_exp_f32 v54, v54
    v_exp_f32 v55, v55
    v_cvt_pk_bf16_f32 v62, v52, v53
    v_cvt_pk_bf16_f32 v63, v54, v55
    v_mfma_f32_32x32x16_bf16 v[40:55], v[140:143], v[12:15], 0
    s_waitcnt vmcnt(2)
    v_exp_f32 v24, v24
    v_exp_f32 v25, v25
    v_exp_f32 v26, v26
    v_exp_f32 v27, v27
    v_cvt_pk_bf16_f32 v56, v24, v25
    v_exp_f32 v28, v28
    v_mfma_f32_32x32x16_bf16 v[112:127], v[136:139], v[60:63], v[112:127]
    s_mov_b64 exec, s[20:21]
    global_load_dwordx4 v[132:135], v7, s[32:33] offset:1024
    global_load_dwordx4 v[136:139], v7, s[32:33] offset:1536
    s_mov_b64 exec, -1
    v_exp_f32 v29, v29
    v_cvt_pk_bf16_f32 v57, v26, v27
    v_exp_f32 v30, v30
    v_exp_f32 v31, v31
    v_cvt_pk_bf16_f32 v58, v28, v29
    v_exp_f32 v32, v32
    v_cvt_pk_bf16_f32 v59, v30, v31
    v_exp_f32 v33, v33
    v_exp_f32 v34, v34
    v_mfma_f32_32x32x16_bf16 v[64:79], v[144:147], v[56:59], v[64:79]
    s_sub_u32 s28, s28, 1
    v_cvt_pk_bf16_f32 v60, v32, v33
    v_exp_f32 v35, v35
    v_exp_f32 v36, v36
    v_cvt_pk_bf16_f32 v61, v34, v35
    v_exp_f32 v37, v37
    v_exp_f32 v38, v38
    v_exp_f32 v39, v39
    v_cvt_pk_bf16_f32 v62, v36, v37
    v_cvt_pk_bf16_f32 v63, v38, v39
    v_mfma_f32_32x32x16_bf16 v[24:39], v[140:143], v[16:19], 0
    s_add_u32 s30, s30, 4096
    v_exp_f32 v40, v40
    v_exp_f32 v41, v41
    v_exp_f32 v42, v42
    v_exp_f32 v43, v43
    v_cvt_pk_bf16_f32 v56, v40, v41
    v_exp_f32 v44, v44
    v_mfma_f32_32x32x16_bf16 v[64:79], v[148:151], v[60:63], v[64:79]
    v_exp_f32 v45, v45
    v_cvt_pk_bf16_f32 v57, v42, v43
    v_exp_f32 v46, v46
    v_exp_f32 v47, v47
    v_cvt_pk_bf16_f32 v58, v44, v45
    v_exp_f32 v48, v48
    v_cvt_pk_bf16_f32 v59, v46, v47
    v_exp_f32 v49, v49
    v_exp_f32 v50, v50
    v_mfma_f32_32x32x16_bf16 v[80:95], v[144:147], v[56:59], v[80:95]
    s_and_b32 s30, s30, 0x1ffff
    v_cvt_pk_bf16_f32 v60, v48, v49
    v_exp_f32 v51, v51
    v_exp_f32 v52, v52
    v_cvt_pk_bf16_f32 v61, v50, v51
    v_exp_f32 v53, v53
    v_exp_f32 v54, v54
    v_exp_f32 v55, v55
    v_cvt_pk_bf16_f32 v62, v52, v53
    v_cvt_pk_bf16_f32 v63, v54, v55
    v_mfma_f32_32x32x16_bf16 v[40:55], v[140:143], v[20:23], 0
    s_add_u32 s32, s30, s31
    v_exp_f32 v24, v24
    v_exp_f32 v25, v25
    v_exp_f32 v26, v26
    v_exp_f32 v27, v27
    v_cvt_pk_bf16_f32 v56, v24, v25
    v_exp_f32 v28, v28
    v_mfma_f32_32x32x16_bf16 v[80:95], v[148:151], v[60:63], v[80:95]
    s_addc_u32 s33, s38, 0
    v_exp_f32 v29, v29
    v_cvt_pk_bf16_f32 v57, v26, v27
    v_exp_f32 v30, v30
    v_exp_f32 v31, v31
    v_cvt_pk_bf16_f32 v58, v28, v29
    v_exp_f32 v32, v32
    v_cvt_pk_bf16_f32 v59, v30, v31
    v_exp_f32 v33, v33
    v_exp_f32 v34, v34
    v_mfma_f32_32x32x16_bf16 v[96:111], v[144:147], v[56:59], v[96:111]
    s_waitcnt vmcnt(2)
    v_cvt_pk_bf16_f32 v60, v32, v33
    v_exp_f32 v35, v35
    v_exp_f32 v36, v36
    v_cvt_pk_bf16_f32 v61, v34, v35
    v_exp_f32 v37, v37
    v_exp_f32 v38, v38
    v_exp_f32 v39, v39
    v_cvt_pk_bf16_f32 v62, v36, v37
    v_cvt_pk_bf16_f32 v63, v38, v39
    v_mfma_f32_32x32x16_bf16 v[24:39], v[128:131], v[8:11], 0
    global_load_dwordx4 v[140:143], v1, s[32:33]
    v_exp_f32 v40, v40
    v_exp_f32 v41, v41
    v_exp_f32 v42, v42
    v_exp_f32 v43, v43
    v_cvt_pk_bf16_f32 v56, v40, v41
    v_exp_f32 v44, v44
    v_mfma_f32_32x32x16_bf16 v[96:111], v[148:151], v[60:63], v[96:111]
    s_add_u32 s34, s34, 1024
    v_exp_f32 v45, v45
    v_cvt_pk_bf16_f32 v57, v42, v43
    v_exp_f32 v46, v46
    v_exp_f32 v47, v47
    v_cvt_pk_bf16_f32 v58, v44, v45
    v_exp_f32 v48, v48
    v_cvt_pk_bf16_f32 v59, v46, v47
    v_exp_f32 v49, v49
    v_exp_f32 v50, v50
    v_mfma_f32_32x32x16_bf16 v[112:127], v[144:147], v[56:59], v[112:127]
    s_addc_u32 s35, s35, 0
    v_cvt_pk_bf16_f32 v60, v48, v49
    v_exp_f32 v51, v51
    v_exp_f32 v52, v52
    v_cvt_pk_bf16_f32 v61, v50, v51
    v_exp_f32 v53, v53
    v_exp_f32 v54, v54
    v_exp_f32 v55, v55
    v_cvt_pk_bf16_f32 v62, v52, v53
    v_cvt_pk_bf16_f32 v63, v54, v55
    s_cmp_lg_u32 s28, 0
    s_cbranch_scc1 ATT1_LOOP
    s_branch ATT_TAIL
FALLBACK:
    s_waitcnt vmcnt(0) lgkmcnt(0)
    v_mov_b32 v140, 0x3f803f80
    v_mov_b32 v141, 0x3f803f80
    v_mov_b32 v142, 0x3f803f80
    v_mov_b32 v143, 0x3f803f80
    v_mov_b32 v144, 0x3f803f80
    v_mov_b32 v145, 0x3f803f80
    v_mov_b32 v146, 0x3f803f80
    v_mov_b32 v147, 0x3f803f80
    s_cmp_eq_u32 s55, 0
    s_cbranch_scc1 FBS_52
    v_mov_b32 v56, 0xff800000
    s_mov_b32 s24, s17
    s_add_u32 s25, s17, 131072
FB1_50:
    buffer_load_dwordx4 v[136:139], v1, s[4:7], s24 offen
    s_waitcnt vmcnt(0) lgkmcnt(0)
    v_mfma_f32_32x32x16_bf16 v[24:39], v[136:139], v[16:19], 0
    s_nop 11
    v_max3_f32 v56, v24, v25, v56
    v_max3_f32 v56, v26, v27, v56
    v_max3_f32 v56, v28, v29, v56
    v_max3_f32 v56, v30, v31, v56
    v_max3_f32 v56, v32, v33, v56
    v_max3_f32 v56, v34, v35, v56
    v_max3_f32 v56, v36, v37, v56
    v_max3_f32 v56, v38, v39, v56
    s_add_u32 s24, s24, 2048
    s_cmp_lt_u32 s24, s25
    s_cbranch_scc1 FB1_50
    v_mov_b32 v57, v56
    s_nop 1
    v_permlane32_swap_b32 v56, v57
    v_max_f32 v56, v56, v57
    v_sub_f32 v80, 0, v56
    v_mov_b32 v96, 0
    v_sub_f32 v81, 0, v56
    v_mov_b32 v97, 0
    v_sub_f32 v82, 0, v56
    v_mov_b32 v98, 0
    v_sub_f32 v83, 0, v56
    v_mov_b32 v99, 0
    v_sub_f32 v84, 0, v56
    v_mov_b32 v100, 0
    v_sub_f32 v85, 0, v56
    v_mov_b32 v101, 0
    v_sub_f32 v86, 0, v56
    v_mov_b32 v102, 0
    v_sub_f32 v87, 0, v56
    v_mov_b32 v103, 0
    v_sub_f32 v88, 0, v56
    v_mov_b32 v104, 0
    v_sub_f32 v89, 0, v56
    v_mov_b32 v105, 0
    v_sub_f32 v90, 0, v56
    v_mov_b32 v106, 0
    v_sub_f32 v91, 0, v56
    v_mov_b32 v107, 0
    v_sub_f32 v92, 0, v56
    v_mov_b32 v108, 0
    v_sub_f32 v93, 0, v56
    v_mov_b32 v109, 0
    v_sub_f32 v94, 0, v56
    v_mov_b32 v110, 0
    v_sub_f32 v95, 0, v56
    v_mov_b32 v111, 0
    s_mov_b32 s24, s17
FB2_51:
    buffer_load_dwordx4 v[136:139], v1, s[4:7], s24 offen
    s_mov_b64 exec, s[20:21]
    buffer_load_dwordx4 v[140:143], v7, s[4:7], s24 offen offset:1024
    buffer_load_dwordx4 v[144:147], v7, s[4:7], s24 offen offset:1536
    s_mov_b64 exec, -1
    s_waitcnt vmcnt(0) lgkmcnt(0)
    v_mfma_f32_32x32x16_bf16 v[24:39], v[136:139], v[16:19], v[80:95]
    s_nop 11
    v_exp_f32 v24, v24
    v_exp_f32 v25, v25
    v_exp_f32 v26, v26
    v_exp_f32 v27, v27
    v_exp_f32 v28, v28
    v_exp_f32 v29, v29
    v_exp_f32 v30, v30
    v_exp_f32 v31, v31
    v_exp_f32 v32, v32
    v_exp_f32 v33, v33
    v_exp_f32 v34, v34
    v_exp_f32 v35, v35
    v_exp_f32 v36, v36
    v_exp_f32 v37, v37
    v_exp_f32 v38, v38
    v_exp_f32 v39, v39
    v_cvt_pk_bf16_f32 v56, v24, v25
    v_cvt_pk_bf16_f32 v57, v26, v27
    v_cvt_pk_bf16_f32 v58, v28, v29
    v_cvt_pk_bf16_f32 v59, v30, v31
    v_cvt_pk_bf16_f32 v60, v32, v33
    v_cvt_pk_bf16_f32 v61, v34, v35
    v_cvt_pk_bf16_f32 v62, v36, v37
    v_cvt_pk_bf16_f32 v63, v38, v39
    v_mfma_f32_32x32x16_bf16 v[96:111], v[140:143], v[56:59], v[96:111]
    s_nop 0
    v_mfma_f32_32x32x16_bf16 v[96:111], v[144:147], v[60:63], v[96:111]
    s_add_u32 s24, s24, 2048
    s_cmp_lt_u32 s24, s25
    s_nop 15
    s_cbranch_scc1 FB2_51
    s_nop 15
    v_rcp_f32 v106, v104
    s_nop 0
    v_pk_mul_f32 v[96:97], v[96:97], v[106:107] op_sel_hi:[1,0]
    v_pk_mul_f32 v[98:99], v[98:99], v[106:107] op_sel_hi:[1,0]
    v_pk_mul_f32 v[100:101], v[100:101], v[106:107] op_sel_hi:[1,0]
    v_pk_mul_f32 v[102:103], v[102:103], v[106:107] op_sel_hi:[1,0]
    v_cvt_pk_bf16_f32 v76, v96, v97
    v_cvt_pk_bf16_f32 v77, v98, v99
    v_cvt_pk_bf16_f32 v78, v100, v101
    v_cvt_pk_bf16_f32 v79, v102, v103
    buffer_store_dwordx4 v[76:79], v5, s[4:7], s36 offen sc1
    buffer_load_dwordx4 v[96:99], v1, s[4:7], s52 offen sc1
    buffer_load_dwordx4 v[100:103], v1, s[4:7], s52 offen offset:1024 sc1
    s_waitcnt vmcnt(0) lgkmcnt(0)
    s_cmp_lg_u32 s23, 0
    s_mov_b64 exec, 1
    s_cbranch_scc1 WS_53
    buffer_store_dword v74, off, s[4:7], s54 offset:0
WB_54:
    s_mov_b64 exec, -1
FBS_52:
    s_cmp_eq_u32 s63, 0
    s_cbranch_scc1 FBS_57
    v_mov_b32 v56, 0xff800000
    s_mov_b32 s24, s17
    s_add_u32 s25, s17, 131072
FB1_55:
    buffer_load_dwordx4 v[136:139], v1, s[4:7], s24 offen
    s_waitcnt vmcnt(0) lgkmcnt(0)
    v_mfma_f32_32x32x16_bf16 v[24:39], v[136:139], v[20:23], 0
    s_nop 11
    v_max3_f32 v56, v24, v25, v56
    v_max3_f32 v56, v26, v27, v56
    v_max3_f32 v56, v28, v29, v56
    v_max3_f32 v56, v30, v31, v56
    v_max3_f32 v56, v32, v33, v56
    v_max3_f32 v56, v34, v35, v56
    v_max3_f32 v56, v36, v37, v56
    v_max3_f32 v56, v38, v39, v56
    s_add_u32 s24, s24, 2048
    s_cmp_lt_u32 s24, s25
    s_cbranch_scc1 FB1_55
    v_mov_b32 v57, v56
    s_nop 1
    v_permlane32_swap_b32 v56, v57
    v_max_f32 v56, v56, v57
    v_sub_f32 v80, 0, v56
    v_mov_b32 v112, 0
    v_sub_f32 v81, 0, v56
    v_mov_b32 v113, 0
    v_sub_f32 v82, 0, v56
    v_mov_b32 v114, 0
    v_sub_f32 v83, 0, v56
    v_mov_b32 v115, 0
    v_sub_f32 v84, 0, v56
    v_mov_b32 v116, 0
    v_sub_f32 v85, 0, v56
    v_mov_b32 v117, 0
    v_sub_f32 v86, 0, v56
    v_mov_b32 v118, 0
    v_sub_f32 v87, 0, v56
    v_mov_b32 v119, 0
    v_sub_f32 v88, 0, v56
    v_mov_b32 v120, 0
    v_sub_f32 v89, 0, v56
    v_mov_b32 v121, 0
    v_sub_f32 v90, 0, v56
    v_mov_b32 v122, 0
    v_sub_f32 v91, 0, v56
    v_mov_b32 v123, 0
    v_sub_f32 v92, 0, v56
    v_mov_b32 v124, 0
    v_sub_f32 v93, 0, v56
    v_mov_b32 v125, 0
    v_sub_f32 v94, 0, v56
    v_mov_b32 v126, 0
    v_sub_f32 v95, 0, v56
    v_mov_b32 v127, 0
    s_mov_b32 s24, s17
FB2_56:
    buffer_load_dwordx4 v[136:139], v1, s[4:7], s24 offen
    s_mov_b64 exec, s[20:21]
    buffer_load_dwordx4 v[140:143], v7, s[4:7], s24 offen offset:1024
    buffer_load_dwordx4 v[144:147], v7, s[4:7], s24 offen offset:1536
    s_mov_b64 exec, -1
    s_waitcnt vmcnt(0) lgkmcnt(0)
    v_mfma_f32_32x32x16_bf16 v[24:39], v[136:139], v[20:23], v[80:95]
    s_nop 11
    v_exp_f32 v24, v24
    v_exp_f32 v25, v25
    v_exp_f32 v26, v26
    v_exp_f32 v27, v27
    v_exp_f32 v28, v28
    v_exp_f32 v29, v29
    v_exp_f32 v30, v30
    v_exp_f32 v31, v31
    v_exp_f32 v32, v32
    v_exp_f32 v33, v33
    v_exp_f32 v34, v34
    v_exp_f32 v35, v35
    v_exp_f32 v36, v36
    v_exp_f32 v37, v37
    v_exp_f32 v38, v38
    v_exp_f32 v39, v39
    v_cvt_pk_bf16_f32 v56, v24, v25
    v_cvt_pk_bf16_f32 v57, v26, v27
    v_cvt_pk_bf16_f32 v58, v28, v29
    v_cvt_pk_bf16_f32 v59, v30, v31
    v_cvt_pk_bf16_f32 v60, v32, v33
    v_cvt_pk_bf16_f32 v61, v34, v35
    v_cvt_pk_bf16_f32 v62, v36, v37
    v_cvt_pk_bf16_f32 v63, v38, v39
    v_mfma_f32_32x32x16_bf16 v[112:127], v[140:143], v[56:59], v[112:127]
    s_nop 0
    v_mfma_f32_32x32x16_bf16 v[112:127], v[144:147], v[60:63], v[112:127]
    s_add_u32 s24, s24, 2048
    s_cmp_lt_u32 s24, s25
    s_nop 15
    s_cbranch_scc1 FB2_56
    s_nop 15
    v_rcp_f32 v122, v120
FBS_57:
    s_nop 3
    s_branch ATT_NORM
TAG_SLOW:
    s_mov_b32 s24, 0
TAG_LOOP:
    buffer_load_dword v254, off, s[88:91], 0 sc1
    s_add_u32 s24, s24, 1
    s_waitcnt vmcnt(0)
    v_readfirstlane_b32 s43, v254
    s_cmp_gt_u32 s24, 400000
    s_cbranch_scc1 TAG_OK
    s_cmp_eq_u32 s43, 0
    s_cbranch_scc1 TAG_LOOP
    s_branch TAG_OK
XL0_SLOW:
    s_mov_b32 s25, 0
XL0_POLL:
    buffer_load_dword v27, v26, s[4:7], s39 offen sc1
    s_add_u32 s25, s25, 1
    s_waitcnt vmcnt(0)
    s_cmp_gt_u32 s25, 400000
    s_cbranch_scc1 XL0_OK
    v_cmp_ne_u32 vcc, s43, v27
    s_nop 1
    s_cbranch_vccz XL0_OK
    s_cmp_lt_u32 s25, 16
    s_cbranch_scc1 XL0_POLL
    s_cmp_lg_u32 s25, 16
    s_cbranch_scc1 XL0_NOST
    s_mov_b64 exec, 1
    buffer_store_dword v254, off, s[4:7], s90 sc1
    s_mov_b64 exec, -1
XL0_NOST:
    s_sleep 8
    s_and_b32 s24, s2, 7
    s_lshl_b32 s24, s24, 9
    s_add_u32 s24, s24, 4395008
    buffer_load_dword v27, v158, s[4:7], s24 offen sc1
    s_waitcnt vmcnt(0)
    v_and_b32 v27, -8, v27
    v_cmp_ne_u32 vcc, s43, v27
    s_nop 1
    s_cbranch_vccnz XL0_POLL
    s_branch XL0_OK
XG0_SLOW:
    s_mov_b32 s29, 0
XG0_LOOP:
    s_sleep 8
    buffer_load_dword v5, v6, s[4:7], s69 offen sc1
    s_add_u32 s29, s29, 1
    s_waitcnt vmcnt(0)
    s_cmp_gt_u32 s29, 400000
    s_cbranch_scc1 XG0_OK
    v_cmp_ne_u32 vcc, s43, v5
    s_nop 1
    s_cbranch_vccnz XG0_LOOP
    s_branch XG0_OK
PK0_SLOW:
    s_mov_b32 s29, 0
PK0_LOOP:
    s_sleep 24
    buffer_load_dwordx4 v[152:155], v156, s[4:7], s27 offen sc1
    s_add_u32 s29, s29, 1
    s_waitcnt vmcnt(0)
    s_cmp_gt_u32 s29, 400000
    s_cbranch_scc1 PK0_OK
    v_xor_b32 v152, s43, v152
    v_xor_b32 v153, s43, v153
    v_xor_b32 v154, s43, v154
    v_xor_b32 v155, s43, v155
    v_or3_b32 v152, v152, v153, v154
    v_or_b32 v152, v152, v155
    v_cmp_ne_u32 vcc, 0, v152
    s_nop 1
    s_cbranch_vccnz PK0_LOOP
    s_branch PK0_OK
DS_1:
    s_waitcnt vmcnt(0)
    buffer_store_dwordx4 v[76:79], v5, s[4:7], s28 offen sc1
    s_waitcnt vmcnt(0)
    s_branch DB_2
WS_3:
    buffer_store_dword v74, off, s[4:7], s29 offset:0 sc1
    s_branch WB_4
DS_5:
    s_waitcnt vmcnt(0)
    buffer_store_dwordx4 v[52:55], v5, s[4:7], s37 offen sc1
    s_waitcnt vmcnt(0)
    s_branch DB_6
WS_7:
    buffer_store_dword v7, off, s[4:7], s54 offset:896 sc1
    s_branch WB_8
WS_11:
    buffer_store_dword v7, off, s[4:7], s54 offset:896 sc1
    s_branch WB_12
DS_13:
    s_waitcnt vmcnt(0)
    buffer_store_dwordx4 v[24:27], v1, s[4:7], s52 offen offset:0 sc1
    buffer_store_dwordx4 v[28:31], v1, s[4:7], s52 offen offset:1024 sc1
    buffer_store_dword v32, v138, s[4:7], s53 offen sc1
    s_waitcnt vmcnt(0)
    s_branch DB_14
WS_15:
    buffer_store_dword v7, off, s[4:7], s54 offset:128 sc1
    s_branch WB_16
WS_19:
    buffer_store_dword v7, off, s[4:7], s54 offset:128 sc1
    s_branch WB_20
XS_21:
    s_mov_b32 s25, 0
WP_58:
    buffer_load_dword v4, v137, s[4:7], s22 offen offset:128 sc1
    s_add_u32 s25, s25, 1
    s_waitcnt vmcnt(0)
    s_cmp_gt_u32 s25, 400000
    s_cbranch_scc1 WD_59
    v_cmp_ne_u32 vcc, s43, v4
    s_nop 1
    s_cbranch_vccnz WP_58
WD_59:
    s_branch XO_22
WBL_23:
    buffer_wbl2 sc1
    s_branch WBL_24
FSS_26:
    s_mov_b64 exec, 1
    buffer_store_dword v7, off, s[4:7], s19 offset:256 sc1
    s_mov_b64 exec, -1
    s_branch FS_25
HSLOW_27:
    s_mov_b32 s24, 0
HLP_60:
    buffer_load_dword v4, v6, s[4:7], s22 offen offset:256 sc1
    s_add_u32 s24, s24, 1
    s_waitcnt vmcnt(0)
    s_cmp_gt_u32 s24, 400000
    s_cbranch_scc1 HOK_28
    v_cmp_ne_u32 vcc, s43, v4
    s_nop 1
    s_cbranch_vccnz HLP_60
    s_branch HOK_28
FSS_30:
    s_mov_b64 exec, 1
    buffer_store_dword v7, off, s[4:7], s19 offset:384 sc1
    s_mov_b64 exec, -1
    s_branch FS_29
HSLOW_31:
    s_mov_b32 s24, 0
HLP_61:
    buffer_load_dword v4, v6, s[4:7], s22 offen offset:384 sc1
    s_add_u32 s24, s24, 1
    s_waitcnt vmcnt(0)
    s_cmp_gt_u32 s24, 400000
    s_cbranch_scc1 HOK_32
    v_cmp_ne_u32 vcc, s43, v4
    s_nop 1
    s_cbranch_vccnz HLP_61
    s_branch HOK_32
FSS_34:
    s_mov_b64 exec, 1
    buffer_store_dword v7, off, s[4:7], s19 offset:512 sc1
    s_mov_b64 exec, -1
    s_branch FS_33
FSS_36:
    s_mov_b64 exec, 1
    buffer_store_dword v7, off, s[4:7], s19 offset:640 sc1
    s_mov_b64 exec, -1
    s_branch FS_35
HSLOW_37:
    s_mov_b32 s24, 0
HLP_62:
    buffer_load_dword v4, v6, s[4:7], s22 offen offset:512 sc1
    s_add_u32 s24, s24, 1
    s_waitcnt vmcnt(0)
    s_cmp_gt_u32 s24, 400000
    s_cbranch_scc1 HOK_38
    v_cmp_ne_u32 vcc, s43, v4
    s_nop 1
    s_cbranch_vccnz HLP_62
    s_branch HOK_38
HSLOW_39:
    s_mov_b32 s24, 0
HLP_63:
    buffer_load_dword v4, v6, s[4:7], s22 offen offset:640 sc1
    s_add_u32 s24, s24, 1
    s_waitcnt vmcnt(0)
    s_cmp_gt_u32 s24, 400000
    s_cbranch_scc1 HOK_40
    v_cmp_ne_u32 vcc, s43, v4
    s_nop 1
    s_cbranch_vccnz HLP_63
    s_branch HOK_40
DS_41:
    s_waitcnt vmcnt(0)
    buffer_store_dwordx4 v[24:27], v1, s[4:7], s52 offen offset:0 sc1
    buffer_store_dwordx4 v[28:31], v1, s[4:7], s52 offen offset:1024 sc1
    buffer_store_dword v120, v137, s[4:7], s53 offen sc1
    s_waitcnt vmcnt(0)
    s_branch DB_42
FSS_47:
    s_mov_b64 exec, 1
    buffer_store_dword v7, off, s[4:7], s19 offset:768 sc1
    s_mov_b64 exec, -1
    s_branch FS_46
FSS_49:
    s_mov_b64 exec, 1
    buffer_store_dword v28, off, s[4:7], s68 offset:0 sc1
    s_mov_b64 exec, -1
    s_branch FS_48
XG1_SLOW:
    s_mov_b32 s29, 0
XG1_LOOP:
    s_sleep 8
    buffer_load_dword v5, v6, s[4:7], s69 offen sc1
    s_add_u32 s29, s29, 1
    s_waitcnt vmcnt(0)
    s_cmp_gt_u32 s29, 400000
    s_cbranch_scc1 XG1_OK
    v_cmp_ne_u32 vcc, s43, v5
    s_nop 1
    s_cbranch_vccnz XG1_LOOP
    s_branch XG1_OK
WS_53:
    buffer_store_dword v74, off, s[4:7], s54 offset:0 sc1
    s_branch WB_54
CODE_END:
.section .rodata,"a"
.p2align 6
.amdhsa_kernel interleave_layers__grouped_kv_mqa__dense_activation_silu__prompt_kernel
  .amdhsa_next_free_vgpr 512
  .amdhsa_next_free_sgpr 102
  .amdhsa_accum_offset 256
  .amdhsa_group_segment_fixed_size 0
  .amdhsa_kernarg_size 88
  .amdhsa_user_sgpr_count 2
  .amdhsa_user_sgpr_kernarg_segment_ptr 1
  .amdhsa_system_sgpr_workgroup_id_x 1
.end_amdhsa_kernel
```
